```python
import torch

def _softmax(x, axis=-1):
    return torch.softmax(x, dim=axis)
def _gelu(x):
    return torch.nn.functional.gelu(x, approximate="tanh")
def _silu(x):
    return torch.nn.functional.silu(x)
def _sigmoid(x):
    return torch.sigmoid(x)
def _layernorm(x, axis=-1, eps=1e-5):
    m = x.mean(dim=axis, keepdim=True)
    v = x.var(dim=axis, keepdim=True, unbiased=False)
    return (x - m) / torch.sqrt(v + eps)
def _scatter_add(tgt, idx, src, axis=0):
    return tgt.clone().index_add_(axis, idx, src)
def _segment_sum(src, seg, n):
    out = torch.zeros((n,) + src.shape[1:], dtype=src.dtype)
    return out.index_add_(0, seg, src)
def _pad(x, pw):
    flat = tuple(v for pair in reversed(pw) for v in pair)
    return torch.nn.functional.pad(x, flat)

kernel_name = 'sequential_preLN__softmax_full_mha__glu_gated_reglu__prompt'

def setup_inputs():

    _w = (lambda a: (lambda t: t.to(torch.bfloat16) if t.is_floating_point() else t)(torch.as_tensor(a)))
    def _A_setup():
        B, S, D = 1, 2048, 576
        return {
            "x": _w((lambda *s: torch.randn(*s, dtype=torch.bfloat16) * 0.05)(B, S, D)),
            "wqkv": _w((lambda *s: torch.randn(*s, dtype=torch.bfloat16) * 0.05)(D, 3 * D)),
            "wo": _w((lambda *s: torch.randn(*s, dtype=torch.bfloat16) * 0.05)(D, D)),
        }
    _A_in = _A_setup()

    def _B_setup():
        B, S, D, F = 1, 2048, 576, 4608
        return {
            "x": _w((lambda *s: torch.randn(*s, dtype=torch.bfloat16) * 0.05)(B, S, D)),
            "W_gate": _w((lambda *s: torch.randn(*s, dtype=torch.bfloat16) * 0.4)(D, F) * (2.0 / D) ** 0.5),
            "W_up": _w((lambda *s: torch.randn(*s, dtype=torch.bfloat16) * 0.4)(D, F) * (2.0 / D) ** 0.5),
            "W_down": _w((lambda *s: torch.randn(*s, dtype=torch.bfloat16) * 0.4)(F, D) * (1.0 / F) ** 0.5),
        }
    _B_in = _B_setup()

    return {
        "A_x": _A_in["x"],
        "A_wqkv": _A_in["wqkv"],
        "A_wo": _A_in["wo"],
        "B_x": _B_in["x"],
        "B_W_gate": _B_in["W_gate"],
        "B_W_up": _B_in["W_up"],
        "B_W_down": _B_in["W_down"],
    }

def reference(A_x, A_wqkv, A_wo, B_x, B_W_gate, B_W_up, B_W_down):
    def _A_ref(x, wqkv, wo):
        B, S, D = x.shape
        H = 32; Dh = D // H
        qkv = (lambda x, *d: x.permute(*d))((x @ wqkv).reshape(B, S, 3, H, Dh), 2, 0, 3, 1, 4)
        q, k, v = qkv[0], qkv[1], qkv[2]
        scale = Dh ** -0.5
        scores = torch.einsum("bhqd,bhkd->bhqk", q, k) * scale
        p = _softmax(scores, axis=-1)
        o = torch.einsum("bhqk,bhkd->bhqd", p, v)
        return (lambda x, *d: x.permute(*d))(o, 0, 2, 1, 3).reshape(B, S, D) @ wo

    def _B_ref(x, W_gate, W_up, W_down):
        gate = torch.einsum("bsd,df->bsf", x, W_gate)
        up = torch.einsum("bsd,df->bsf", x, W_up)
        gate = gate * (lambda x, dt: x.to(dt))(gate > 0, gate.dtype)
        h = gate * up
        return torch.einsum("bsf,fd->bsd", h, W_down)

    x = A_x
    h = x + _A_ref(_layernorm(x, axis=-1), A_wqkv, A_wo)
    h2 = h + _B_ref(_layernorm(h, axis=-1), B_W_gate, B_W_up, B_W_down)
    return h2
```

```asm
; @launch grid=(256,1,1) block=(512,1,1) lds=163840
.amdgcn_target "amdgcn-amd-amdhsa--gfx950"
.text

.globl sequential_preLN__softmax_full_mha__glu_gated_reglu__prompt_kernel
.p2align 8
.type sequential_preLN__softmax_full_mha__glu_gated_reglu__prompt_kernel,@function
sequential_preLN__softmax_full_mha__glu_gated_reglu__prompt_kernel:
    s_cmp_ge_u32 s2, 256
    s_cbranch_scc0 START
    s_endpgm
START:
    s_load_dwordx16 s[76:91], s[0:1], 0
    s_load_dwordx4 s[92:95], s[0:1], 64
    v_lshrrev_b32 v2, 6, v0
    s_nop 0
    v_readfirstlane_b32 s3, v2
    s_cmp_eq_u32 s3, 3
    s_cbranch_scc0 SKIP_1
    s_getpc_b64 s[4:5]
PC_2:
    s_add_u32 s4, s4, PH_A-PC_2
    s_addc_u32 s5, s5, 0
    v_and_b32 v252, 63, v0
    v_min_u32 v252, 19, v252
    s_bfe_u32 s58, s2, 0x40003
    s_mul_i32 s58, s58, 2560
    v_lshl_add_u32 v252, v252, 7, s58
    v_min_u32 v252, PH_C-PH_A-4, v252
    v_mov_b32 v253, s5
    v_add_co_u32 v252, vcc, s4, v252
    s_nop 1
    v_addc_co_u32 v253, vcc, 0, v253, vcc
    global_load_dword v254, v[252:253], off
SKIP_1:
    s_cmp_ge_u32 s2, 192
    s_cbranch_scc1 PH_H
    s_bfe_u32 s56, s2, 0x20001
    s_mul_i32 s56, s56, 24
    s_lshr_b32 s57, s2, 3
    s_add_u32 s56, s56, s57
    s_mul_i32 s56, s56, 24576
    v_min_u32 v244, 191, v0
    v_lshlrev_b32 v244, 7, v244
    s_mul_i32 s57, s57, 82944
    s_and_b32 s58, s2, 1
    s_mul_i32 s58, s58, 1664
    s_add_u32 s57, s57, s58
    v_min_u32 v245, 167, v0
    v_mul_u32_u24 v246, 0x12493, v245
    v_lshrrev_b32 v246, 20, v246
    v_mul_u32_u24 v247, 14, v246
    v_sub_u32 v247, v245, v247
    v_mul_u32_u24 v246, 3456, v246
    v_lshl_add_u32 v246, v247, 7, v246
    s_add_u32 s58, s57, 41472
    s_mov_b32 s10, 0x240000
    s_mov_b32 s11, 0x00020000
    s_mov_b32 s14, 0x1e6000
    s_mov_b32 s15, 0x00020000
    s_cmp_lt_u32 s3, 3
    s_cbranch_scc0 PFE_END
    s_waitcnt lgkmcnt(0)
    s_mov_b64 s[8:9], s[76:77]
    s_mov_b64 s[12:13], s[78:79]
    buffer_load_dword v250, v244, s[8:11], s56 offen
    buffer_load_dword v251, v246, s[12:15], s57 offen
    buffer_load_dword v251, v246, s[12:15], s58 offen
PFE_END:
PH_A:
    v_and_b32 v1, 63, v0
    s_and_b32 s30, s2, 7
    s_lshr_b32 s31, s2, 3
    s_lshr_b32 s32, s30, 1
    s_lshl_b32 s32, s32, 2
    s_and_b32 s33, s31, 3
    s_add_u32 s32, s32, s33
    s_and_b32 s33, s30, 1
    s_mul_i32 s33, s33, 6
    s_lshr_b32 s34, s31, 2
    s_add_u32 s33, s33, s34
    s_and_b32 s34, s3, 3
    s_lshl_b32 s35, s32, 2
    s_add_u32 s35, s35, s34
    s_cmp_ge_u32 s3, 4
    s_cbranch_scc0 A_CONS
    v_lshrrev_b32 v4, 3, v1
    v_and_b32 v5, 7, v1
    s_cmp_ge_u32 s33, 8
    s_cselect_b32 s36, 16, 8
    s_cselect_b32 s37, 8, 16
    v_add_u32 v6, 0, v4
    v_bfe_u32 v6, v6, 1, 3
    v_xor_b32 v6, v6, v5
    v_add_u32 v7, 0, v4
    v_mul_u32_u24 v7, 1152, v7
    v_lshl_add_u32 v16, v6, 4, v7
    v_add_u32 v6, 8, v4
    v_bfe_u32 v6, v6, 1, 3
    v_xor_b32 v6, v6, v5
    v_add_u32 v7, s36, v4
    v_mul_u32_u24 v7, 1152, v7
    v_lshl_add_u32 v17, v6, 4, v7
    v_add_u32 v6, 16, v4
    v_bfe_u32 v6, v6, 1, 3
    v_xor_b32 v6, v6, v5
    v_add_u32 v7, s37, v4
    v_mul_u32_u24 v7, 1152, v7
    v_lshl_add_u32 v18, v6, 4, v7
    v_add_u32 v6, 24, v4
    v_bfe_u32 v6, v6, 1, 3
    v_xor_b32 v6, v6, v5
    v_add_u32 v7, 24, v4
    v_mul_u32_u24 v7, 1152, v7
    v_lshl_add_u32 v19, v6, 4, v7
    v_add_u32 v4, 0, v1
    v_mul_u32_u24 v5, 0xe38f, v4
    v_lshrrev_b32 v5, 20, v5
    v_mul_u32_u24 v6, 18, v5
    v_sub_u32 v6, v4, v6
    v_lshrrev_b32 v7, 1, v5
    v_xor_b32 v7, v7, v5
    v_and_b32 v7, 4, v7
    v_mul_u32_u24 v7, 3, v7
    v_xor_b32 v5, v5, v7
    v_mul_u32_u24 v5, 3456, v5
    v_lshl_add_u32 v10, v6, 4, v5
    v_add_u32 v4, 64, v1
    v_mul_u32_u24 v5, 0xe38f, v4
    v_lshrrev_b32 v5, 20, v5
    v_mul_u32_u24 v6, 18, v5
    v_sub_u32 v6, v4, v6
    v_lshrrev_b32 v7, 1, v5
    v_xor_b32 v7, v7, v5
    v_and_b32 v7, 4, v7
    v_mul_u32_u24 v7, 3, v7
    v_xor_b32 v5, v5, v7
    v_mul_u32_u24 v5, 3456, v5
    v_lshl_add_u32 v11, v6, 4, v5
    v_add_u32 v4, 128, v1
    v_mul_u32_u24 v5, 0xe38f, v4
    v_lshrrev_b32 v5, 20, v5
    v_mul_u32_u24 v6, 18, v5
    v_sub_u32 v6, v4, v6
    v_lshrrev_b32 v7, 1, v5
    v_xor_b32 v7, v7, v5
    v_and_b32 v7, 4, v7
    v_mul_u32_u24 v7, 3, v7
    v_xor_b32 v5, v5, v7
    v_mul_u32_u24 v5, 3456, v5
    v_lshl_add_u32 v12, v6, 4, v5
    v_add_u32 v4, 192, v1
    v_mul_u32_u24 v5, 0xe38f, v4
    v_lshrrev_b32 v5, 20, v5
    v_mul_u32_u24 v6, 18, v5
    v_sub_u32 v6, v4, v6
    v_lshrrev_b32 v7, 1, v5
    v_xor_b32 v7, v7, v5
    v_and_b32 v7, 4, v7
    v_mul_u32_u24 v7, 3, v7
    v_xor_b32 v5, v5, v7
    v_mul_u32_u24 v5, 3456, v5
    v_lshl_add_u32 v13, v6, 4, v5
    v_add_u32 v4, 256, v1
    v_mul_u32_u24 v5, 0xe38f, v4
    v_lshrrev_b32 v5, 20, v5
    v_mul_u32_u24 v6, 18, v5
    v_sub_u32 v6, v4, v6
    v_lshrrev_b32 v7, 1, v5
    v_xor_b32 v7, v7, v5
    v_and_b32 v7, 4, v7
    v_mul_u32_u24 v7, 3, v7
    v_xor_b32 v5, v5, v7
    v_mul_u32_u24 v5, 3456, v5
    v_lshl_add_u32 v14, v6, 4, v5
    s_mul_i32 s40, s33, 288
    s_mul_i32 s41, s34, 55296
    s_add_u32 s40, s40, s41
    s_mul_i32 s41, s35, 36864
    s_mul_i32 s42, s34, 4608
    s_lshl_b32 s43, s34, 12
    s_add_u32 s43, s43, 73728
    v_mov_b32 v20, 0
    v_mov_b32 v21, 1
    s_mov_b32 s59, 128
    v_writelane_b32 v20, s59, 1
    v_writelane_b32 v21, 64, 1
    s_waitcnt lgkmcnt(0)
    s_mov_b32 s8, s76
    s_mov_b32 s9, s77
    s_mov_b32 s10, 0x240000
    s_mov_b32 s11, 0x00020000
    s_mov_b32 s12, s78
    s_mov_b32 s13, s79
    s_mov_b32 s14, 0x1e6000
    s_mov_b32 s15, 0x00020000
    s_mov_b32 s16, s92
    s_mov_b32 s17, s93
    s_mov_b32 s18, 0x100
    s_mov_b32 s19, 0x00020000
    s_mov_b32 s20, s94
    s_mov_b32 s21, s95
    s_mov_b32 s22, 0x10000000
    s_mov_b32 s23, 0x00020000
    s_add_u32 m0, s43, 0
    s_nop 0
    buffer_load_dwordx4 v16, s[8:11], s41 offen lds
    s_add_u32 m0, s43, 1024
    s_nop 0
    buffer_load_dwordx4 v17, s[8:11], s41 offen lds
    s_add_u32 m0, s43, 2048
    s_nop 0
    buffer_load_dwordx4 v18, s[8:11], s41 offen lds
    s_add_u32 m0, s43, 3072
    s_nop 0
    buffer_load_dwordx4 v19, s[8:11], s41 offen lds
    s_add_u32 m0, s42, 0
    s_nop 0
    buffer_load_dwordx4 v10, s[12:15], s40 offen lds
    s_add_u32 m0, s42, 1024
    s_nop 0
    buffer_load_dwordx4 v11, s[12:15], s40 offen lds
    s_add_u32 m0, s42, 2048
    s_nop 0
    buffer_load_dwordx4 v12, s[12:15], s40 offen lds
    s_add_u32 m0, s42, 3072
    s_nop 0
    buffer_load_dwordx4 v13, s[12:15], s40 offen lds
    s_add_u32 m0, s42, 4096
    s_mov_b32 exec_hi, 0
    buffer_load_dwordx4 v14, s[12:15], s40 offen lds
    s_mov_b32 exec_hi, -1
    s_add_u32 s40, s40, 221184
    s_add_u32 s41, s41, 128
    s_add_u32 m0, s43, 16384
    s_nop 0
    buffer_load_dwordx4 v16, s[8:11], s41 offen lds
    s_add_u32 m0, s43, 17408
    s_nop 0
    buffer_load_dwordx4 v17, s[8:11], s41 offen lds
    s_add_u32 m0, s43, 18432
    s_nop 0
    buffer_load_dwordx4 v18, s[8:11], s41 offen lds
    s_add_u32 m0, s43, 19456
    s_nop 0
    buffer_load_dwordx4 v19, s[8:11], s41 offen lds
    s_add_u32 m0, s42, 18432
    s_nop 0
    buffer_load_dwordx4 v10, s[12:15], s40 offen lds
    s_add_u32 m0, s42, 19456
    s_nop 0
    buffer_load_dwordx4 v11, s[12:15], s40 offen lds
    s_add_u32 m0, s42, 20480
    s_nop 0
    buffer_load_dwordx4 v12, s[12:15], s40 offen lds
    s_add_u32 m0, s42, 21504
    s_nop 0
    buffer_load_dwordx4 v13, s[12:15], s40 offen lds
    s_add_u32 m0, s42, 22528
    s_mov_b32 exec_hi, 0
    buffer_load_dwordx4 v14, s[12:15], s40 offen lds
    s_mov_b32 exec_hi, -1
    s_add_u32 s40, s40, 221184
    s_add_u32 s41, s41, 128
    v_and_b32 v4, 31, v1
    v_lshrrev_b32 v5, 1, v4
    v_xor_b32 v5, v5, v4
    v_and_b32 v5, 8, v5
    s_cmp_ge_u32 s33, 8
    s_cselect_b32 s36, 3, 0
    v_mul_u32_u24 v5, s36, v5
    v_xor_b32 v5, v5, v4
    v_lshrrev_b32 v6, 5, v1
    v_lshlrev_b32 v24, 13, v6
    v_lshl_add_u32 v24, v5, 2, v24
    v_lshlrev_b32 v25, 9, v6
    v_lshl_add_u32 v25, v4, 2, v25
    s_lshl_b32 s36, s34, 7
    s_add_u32 s36, s36, 140288
    v_add_u32 v25, s36, v25
    v_min_u32 v26, 35, v1
    v_lshlrev_b32 v26, 2, v26
    s_mul_i32 s36, s34, 144
    v_add_u32 v26, s36, v26
    v_add_u32 v27, 139264, v26
    s_lshl_b32 s44, s35, 7
    s_add_u32 s44, s44, 147456
    s_mul_i32 s45, s33, 576
    s_add_u32 s45, s45, 180224
    s_add_u32 s46, s45, 8192
    s_waitcnt vmcnt(9)
    s_barrier
    s_add_u32 m0, s43, 32768
    s_nop 0
    buffer_load_dwordx4 v16, s[8:11], s41 offen lds
    s_add_u32 m0, s43, 33792
    s_nop 0
    buffer_load_dwordx4 v17, s[8:11], s41 offen lds
    s_add_u32 m0, s43, 34816
    s_nop 0
    buffer_load_dwordx4 v18, s[8:11], s41 offen lds
    s_add_u32 m0, s43, 35840
    s_nop 0
    buffer_load_dwordx4 v19, s[8:11], s41 offen lds
    s_add_u32 m0, s42, 36864
    s_nop 0
    buffer_load_dwordx4 v10, s[12:15], s40 offen lds
    s_add_u32 m0, s42, 37888
    s_nop 0
    buffer_load_dwordx4 v11, s[12:15], s40 offen lds
    s_add_u32 m0, s42, 38912
    s_nop 0
    buffer_load_dwordx4 v12, s[12:15], s40 offen lds
    s_add_u32 m0, s42, 39936
    s_nop 0
    buffer_load_dwordx4 v13, s[12:15], s40 offen lds
    s_add_u32 m0, s42, 40960
    s_mov_b32 exec_hi, 0
    buffer_load_dwordx4 v14, s[12:15], s40 offen lds
    s_mov_b32 exec_hi, -1
    s_add_u32 s40, s40, 221184
    s_add_u32 s41, s41, 128
    s_add_u32 m0, s43, 49152
    s_nop 0
    buffer_load_dwordx4 v16, s[8:11], s41 offen lds
    s_add_u32 m0, s43, 50176
    s_nop 0
    buffer_load_dwordx4 v17, s[8:11], s41 offen lds
    s_add_u32 m0, s43, 51200
    s_nop 0
    buffer_load_dwordx4 v18, s[8:11], s41 offen lds
    s_add_u32 m0, s43, 52224
    s_nop 0
    buffer_load_dwordx4 v19, s[8:11], s41 offen lds
    s_add_u32 m0, s42, 55296
    s_nop 0
    buffer_load_dwordx4 v10, s[12:15], s40 offen lds
    s_add_u32 m0, s42, 56320
    s_nop 0
    buffer_load_dwordx4 v11, s[12:15], s40 offen lds
    s_add_u32 m0, s42, 57344
    s_nop 0
    buffer_load_dwordx4 v12, s[12:15], s40 offen lds
    s_add_u32 m0, s42, 58368
    s_nop 0
    buffer_load_dwordx4 v13, s[12:15], s40 offen lds
    s_add_u32 m0, s42, 59392
    s_mov_b32 exec_hi, 0
    buffer_load_dwordx4 v14, s[12:15], s40 offen lds
    s_mov_b32 exec_hi, -1
    s_add_u32 s40, s40, 221184
    s_add_u32 s41, s41, 128
    s_waitcnt vmcnt(18)
    s_barrier
    s_add_u32 m0, s43, 0
    s_nop 0
    buffer_load_dwordx4 v16, s[8:11], s41 offen lds
    s_add_u32 m0, s43, 1024
    s_nop 0
    buffer_load_dwordx4 v17, s[8:11], s41 offen lds
    s_add_u32 m0, s43, 2048
    s_nop 0
    buffer_load_dwordx4 v18, s[8:11], s41 offen lds
    s_add_u32 m0, s43, 3072
    s_nop 0
    buffer_load_dwordx4 v19, s[8:11], s41 offen lds
    s_add_u32 m0, s42, 0
    s_nop 0
    buffer_load_dwordx4 v10, s[12:15], s40 offen lds
    s_add_u32 m0, s42, 1024
    s_nop 0
    buffer_load_dwordx4 v11, s[12:15], s40 offen lds
    s_add_u32 m0, s42, 2048
    s_nop 0
    buffer_load_dwordx4 v12, s[12:15], s40 offen lds
    s_add_u32 m0, s42, 3072
    s_nop 0
    buffer_load_dwordx4 v13, s[12:15], s40 offen lds
    s_add_u32 m0, s42, 4096
    s_mov_b32 exec_hi, 0
    buffer_load_dwordx4 v14, s[12:15], s40 offen lds
    s_mov_b32 exec_hi, -1
    s_add_u32 s40, s40, 221184
    s_add_u32 s41, s41, 128
    s_waitcnt vmcnt(18)
    s_barrier
    s_add_u32 m0, s43, 16384
    s_nop 0
    buffer_load_dwordx4 v16, s[8:11], s41 offen lds
    s_add_u32 m0, s43, 17408
    s_nop 0
    buffer_load_dwordx4 v17, s[8:11], s41 offen lds
    s_add_u32 m0, s43, 18432
    s_nop 0
    buffer_load_dwordx4 v18, s[8:11], s41 offen lds
    s_add_u32 m0, s43, 19456
    s_nop 0
    buffer_load_dwordx4 v19, s[8:11], s41 offen lds
    s_add_u32 m0, s42, 18432
    s_nop 0
    buffer_load_dwordx4 v10, s[12:15], s40 offen lds
    s_add_u32 m0, s42, 19456
    s_nop 0
    buffer_load_dwordx4 v11, s[12:15], s40 offen lds
    s_add_u32 m0, s42, 20480
    s_nop 0
    buffer_load_dwordx4 v12, s[12:15], s40 offen lds
    s_add_u32 m0, s42, 21504
    s_nop 0
    buffer_load_dwordx4 v13, s[12:15], s40 offen lds
    s_add_u32 m0, s42, 22528
    s_mov_b32 exec_hi, 0
    buffer_load_dwordx4 v14, s[12:15], s40 offen lds
    s_mov_b32 exec_hi, -1
    s_add_u32 s40, s40, 221184
    s_add_u32 s41, s41, 128
    s_waitcnt vmcnt(18)
    s_barrier
    s_add_u32 m0, s43, 32768
    s_nop 0
    buffer_load_dwordx4 v16, s[8:11], s41 offen lds
    s_add_u32 m0, s43, 33792
    s_nop 0
    buffer_load_dwordx4 v17, s[8:11], s41 offen lds
    s_add_u32 m0, s43, 34816
    s_nop 0
    buffer_load_dwordx4 v18, s[8:11], s41 offen lds
    s_add_u32 m0, s43, 35840
    s_nop 0
    buffer_load_dwordx4 v19, s[8:11], s41 offen lds
    s_add_u32 m0, s42, 36864
    s_nop 0
    buffer_load_dwordx4 v10, s[12:15], s40 offen lds
    s_add_u32 m0, s42, 37888
    s_nop 0
    buffer_load_dwordx4 v11, s[12:15], s40 offen lds
    s_add_u32 m0, s42, 38912
    s_nop 0
    buffer_load_dwordx4 v12, s[12:15], s40 offen lds
    s_add_u32 m0, s42, 39936
    s_nop 0
    buffer_load_dwordx4 v13, s[12:15], s40 offen lds
    s_add_u32 m0, s42, 40960
    s_mov_b32 exec_hi, 0
    buffer_load_dwordx4 v14, s[12:15], s40 offen lds
    s_mov_b32 exec_hi, -1
    s_add_u32 s40, s40, 221184
    s_add_u32 s41, s41, 128
    s_waitcnt vmcnt(18)
    s_barrier
    s_add_u32 m0, s43, 49152
    s_nop 0
    buffer_load_dwordx4 v16, s[8:11], s41 offen lds
    s_add_u32 m0, s43, 50176
    s_nop 0
    buffer_load_dwordx4 v17, s[8:11], s41 offen lds
    s_add_u32 m0, s43, 51200
    s_nop 0
    buffer_load_dwordx4 v18, s[8:11], s41 offen lds
    s_add_u32 m0, s43, 52224
    s_nop 0
    buffer_load_dwordx4 v19, s[8:11], s41 offen lds
    s_add_u32 m0, s42, 55296
    s_nop 0
    buffer_load_dwordx4 v10, s[12:15], s40 offen lds
    s_add_u32 m0, s42, 56320
    s_nop 0
    buffer_load_dwordx4 v11, s[12:15], s40 offen lds
    s_add_u32 m0, s42, 57344
    s_nop 0
    buffer_load_dwordx4 v12, s[12:15], s40 offen lds
    s_add_u32 m0, s42, 58368
    s_nop 0
    buffer_load_dwordx4 v13, s[12:15], s40 offen lds
    s_add_u32 m0, s42, 59392
    s_mov_b32 exec_hi, 0
    buffer_load_dwordx4 v14, s[12:15], s40 offen lds
    s_mov_b32 exec_hi, -1
    s_add_u32 s40, s40, 221184
    s_add_u32 s41, s41, 128
    s_waitcnt vmcnt(18)
    s_barrier
    buffer_load_dword v22, v20, s[16:19], 0 offen sc1
    s_add_u32 m0, s43, 0
    s_nop 0
    buffer_load_dwordx4 v16, s[8:11], s41 offen lds
    s_add_u32 m0, s43, 1024
    s_nop 0
    buffer_load_dwordx4 v17, s[8:11], s41 offen lds
    s_add_u32 m0, s43, 2048
    s_nop 0
    buffer_load_dwordx4 v18, s[8:11], s41 offen lds
    s_add_u32 m0, s43, 3072
    s_nop 0
    buffer_load_dwordx4 v19, s[8:11], s41 offen lds
    s_add_u32 m0, s42, 0
    s_nop 0
    buffer_load_dwordx4 v10, s[12:15], s40 offen lds
    s_add_u32 m0, s42, 1024
    s_nop 0
    buffer_load_dwordx4 v11, s[12:15], s40 offen lds
    s_add_u32 m0, s42, 2048
    s_nop 0
    buffer_load_dwordx4 v12, s[12:15], s40 offen lds
    s_add_u32 m0, s42, 3072
    s_nop 0
    buffer_load_dwordx4 v13, s[12:15], s40 offen lds
    s_add_u32 m0, s42, 4096
    s_mov_b32 exec_hi, 0
    buffer_load_dwordx4 v14, s[12:15], s40 offen lds
    s_mov_b32 exec_hi, -1
    s_add_u32 s40, s40, 221184
    s_add_u32 s41, s41, 128
    s_waitcnt vmcnt(19)
    s_waitcnt vmcnt(9)
    s_cmp_eq_u32 s3, 4
    s_cbranch_scc0 SKIP_3
    s_mov_b32 s59, 0
    s_branch POLLC_6
POLL_4:
    buffer_load_dword v22, v20, s[16:19], 0 offen sc1
    s_waitcnt vmcnt(0)
POLLC_6:
    v_cmp_lt_u32 vcc, v22, v21
    s_add_u32 s59, s59, 1
    s_cbranch_vccz POLLD_5
    s_sleep 1
    s_cmp_lt_u32 s59, 2000000
    s_cbranch_scc1 POLL_4
POLLD_5:
SKIP_3:
    s_barrier
    buffer_load_dword v32, v24, s[20:23], s44 offen sc1
    buffer_load_dword v33, v26, s[20:23], s45 offen sc1
    buffer_load_dword v34, v26, s[20:23], s46 offen sc1
    s_barrier
    s_waitcnt vmcnt(3)
    s_waitcnt vmcnt(0)
    v_add_f32 v33, v33, v34
    ds_write_b32 v25, v32
    ds_write_b32 v27, v33
    s_waitcnt lgkmcnt(0)
    s_barrier
    s_branch A_JOIN
A_CONS:
    v_and_b32 v1, 63, v0
    v_and_b32 v3, 15, v1
    v_lshrrev_b32 v4, 4, v1
    v_and_b32 v5, 3, v1
    v_lshrrev_b32 v6, 2, v3
    v_and_b32 v7, 1, v4
    v_lshl_add_u32 v6, v7, 2, v6
    v_lshrrev_b32 v7, 1, v4
    v_lshl_add_u32 v6, v7, 4, v6
    v_mul_u32_u24 v6, 288, v6
    v_lshrrev_b32 v7, 1, v3
    v_xor_b32 v7, v7, v4
    v_lshlrev_b32 v8, 7, v3
    s_lshl_b32 s36, s34, 12
    s_add_u32 s36, s36, 73728
    v_add_u32 v8, s36, v8
    v_lshl_add_u32 v16, v7, 4, v8
    v_xor_b32 v17, 64, v16
    s_lshl_b32 s38, s34, 7
    s_add_u32 s38, s38, 140288
    s_and_b32 s40, s33, 3
    s_lshl_b32 s40, s40, 3
    s_waitcnt lgkmcnt(0)
    s_mov_b32 s20, s94
    s_mov_b32 s21, s95
    s_mov_b32 s22, 0x10000000
    s_mov_b32 s23, 0x00020000
    s_cmp_ge_u32 s33, 8
    s_cbranch_scc1 A_V
    s_mov_b32 s44, 0x7610
    s_mov_b32 s45, 0x8532
    v_lshlrev_b32 v7, 2, v5
    v_bfe_u32 v8, s44, v7, 4
    v_lshl_add_u32 v10, v8, 3, v6
    v_bfe_u32 v8, s45, v7, 4
    v_lshl_add_u32 v12, v8, 3, v6
    v_mul_u32_u24 v8, 72, v5
    v_add3_u32 v14, v8, v6, 32
    v_add_u32 v11, 36864, v10
    v_add_u32 v13, 36864, v12
    v_add_u32 v15, 36864, v14
    v_lshlrev_b32 v7, 2, v4
    v_bfe_u32 v8, s44, v7, 4
    v_lshlrev_b32 v18, 4, v8
    v_bfe_u32 v8, s45, v7, 4
    v_lshlrev_b32 v19, 4, v8
    v_mul_u32_u24 v20, 144, v4
    v_lshl_add_u32 v21, v3, 2, s38
    v_add_u32 v18, 139264, v18
    v_add_u32 v19, 139264, v19
    v_add_u32 v20, 139264, v20
    s_cmp_lt_u32 s33, 4
    s_mov_b32 s46, 151552
    s_cmov_b32 s46, 65536
    s_mov_b32 s47, 2555904
    s_cmov_b32 s47, 196608
    s_mov_b32 s48, 151552
    s_cmov_b32 s48, 8192
    s_mov_b32 s49, 2621440
    s_cmov_b32 s49, 2293760
    s_cselect_b32 s50, 0x3eae1a93, 1.0
    s_mul_i32 s51, s40, s46
    s_add_u32 s47, s47, s51
    s_lshl_b32 s51, s35, 10
    s_add_u32 s47, s47, s51
    s_mul_i32 s51, s40, s48
    s_add_u32 s49, s49, s51
    s_lshl_b32 s51, s35, 7
    s_add_u32 s49, s49, s51
    v_lshrrev_b32 v7, 1, v4
    v_mul_lo_u32 v22, v7, s46
    v_and_b32 v7, 1, v4
    v_lshl_add_u32 v22, v7, 9, v22
    v_lshl_add_u32 v22, v3, 4, v22
    v_and_b32 v7, 2, v4
    v_lshlrev_b32 v7, 1, v7
    v_mul_lo_u32 v23, v7, s48
    v_and_b32 v7, 31, v1
    v_lshl_add_u32 v23, v7, 2, v23
    s_lshl_b32 s46, s46, 1
    s_barrier
    ds_read_b128 v[176:179], v16 offset:0
    ds_read_b128 v[180:183], v16 offset:2048
    ds_read_b64_tr_b16 v[104:105], v10 offset:0
    ds_read_b64_tr_b16 v[106:107], v10 offset:2304
    ds_read_b64_tr_b16 v[108:109], v12 offset:0
    ds_read_b64_tr_b16 v[110:111], v12 offset:2304
    ds_read_b64_tr_b16 v[112:113], v10 offset:72
    ds_read_b64_tr_b16 v[114:115], v10 offset:2376
    ds_read_b64_tr_b16 v[116:117], v12 offset:72
    ds_read_b64_tr_b16 v[118:119], v12 offset:2376
    ds_read_b64_tr_b16 v[120:121], v10 offset:144
    ds_read_b64_tr_b16 v[122:123], v10 offset:2448
    ds_read_b64_tr_b16 v[124:125], v12 offset:144
    ds_read_b64_tr_b16 v[126:127], v12 offset:2448
    ds_read_b64_tr_b16 v[128:129], v10 offset:216
    ds_read_b64_tr_b16 v[130:131], v10 offset:2520
    ds_read_b64_tr_b16 v[132:133], v12 offset:216
    ds_read_b64_tr_b16 v[134:135], v12 offset:2520
    ds_read_b64_tr_b16 v[136:137], v14 offset:0
    ds_read_b64_tr_b16 v[138:139], v14 offset:2304
    s_waitcnt lgkmcnt(12)
    v_mfma_f32_16x16x32_bf16 v[32:35], v[104:107], v[176:179], 0
    ds_read_b128 v[184:187], v17 offset:0
    v_mfma_f32_16x16x32_bf16 v[36:39], v[104:107], v[180:183], 0
    ds_read_b128 v[188:191], v17 offset:2048
    ds_read_b64_tr_b16 v[140:141], v10 offset:9216
    v_mfma_f32_16x16x32_bf16 v[40:43], v[108:111], v[176:179], 0
    ds_read_b64_tr_b16 v[142:143], v10 offset:11520
    v_mfma_f32_16x16x32_bf16 v[44:47], v[108:111], v[180:183], 0
    ds_read_b64_tr_b16 v[144:145], v12 offset:9216
    v_mfma_f32_16x16x32_bf16 v[48:51], v[112:115], v[176:179], 0
    ds_read_b64_tr_b16 v[146:147], v12 offset:11520
    ds_read_b64_tr_b16 v[148:149], v10 offset:9288
    v_mfma_f32_16x16x32_bf16 v[52:55], v[112:115], v[180:183], 0
    ds_read_b64_tr_b16 v[150:151], v10 offset:11592
    s_waitcnt lgkmcnt(14)
    v_mfma_f32_16x16x32_bf16 v[56:59], v[116:119], v[176:179], 0
    ds_read_b64_tr_b16 v[152:153], v12 offset:9288
    v_mfma_f32_16x16x32_bf16 v[60:63], v[116:119], v[180:183], 0
    ds_read_b64_tr_b16 v[154:155], v12 offset:11592
    ds_read_b64_tr_b16 v[156:157], v10 offset:9360
    v_mfma_f32_16x16x32_bf16 v[64:67], v[120:123], v[176:179], 0
    ds_read_b64_tr_b16 v[158:159], v10 offset:11664
    v_mfma_f32_16x16x32_bf16 v[68:71], v[120:123], v[180:183], 0
    ds_read_b64_tr_b16 v[160:161], v12 offset:9360
    v_mfma_f32_16x16x32_bf16 v[72:75], v[124:127], v[176:179], 0
    ds_read_b64_tr_b16 v[162:163], v12 offset:11664
    v_mfma_f32_16x16x32_bf16 v[76:79], v[124:127], v[180:183], 0
    ds_read_b64_tr_b16 v[164:165], v10 offset:9432
    s_waitcnt lgkmcnt(14)
    v_mfma_f32_16x16x32_bf16 v[80:83], v[128:131], v[176:179], 0
    ds_read_b64_tr_b16 v[166:167], v10 offset:11736
    v_mfma_f32_16x16x32_bf16 v[84:87], v[128:131], v[180:183], 0
    ds_read_b64_tr_b16 v[168:169], v12 offset:9432
    v_mfma_f32_16x16x32_bf16 v[88:91], v[132:135], v[176:179], 0
    ds_read_b64_tr_b16 v[170:171], v12 offset:11736
    v_mfma_f32_16x16x32_bf16 v[92:95], v[132:135], v[180:183], 0
    ds_read_b64_tr_b16 v[172:173], v14 offset:9216
    v_mfma_f32_16x16x32_bf16 v[96:99], v[136:139], v[176:179], 0
    ds_read_b64_tr_b16 v[174:175], v14 offset:11520
    v_mfma_f32_16x16x32_bf16 v[100:103], v[136:139], v[180:183], 0
    s_waitcnt lgkmcnt(12)
    v_mfma_f32_16x16x32_bf16 v[32:35], v[140:143], v[184:187], v[32:35]
    v_mfma_f32_16x16x32_bf16 v[36:39], v[140:143], v[188:191], v[36:39]
    v_mfma_f32_16x16x32_bf16 v[40:43], v[144:147], v[184:187], v[40:43]
    v_mfma_f32_16x16x32_bf16 v[44:47], v[144:147], v[188:191], v[44:47]
    s_waitcnt lgkmcnt(0)
    s_barrier
    ds_read_b128 v[176:179], v16 offset:16384
    v_mfma_f32_16x16x32_bf16 v[48:51], v[148:151], v[184:187], v[48:51]
    ds_read_b128 v[180:183], v16 offset:18432
    ds_read_b64_tr_b16 v[104:105], v10 offset:18432
    v_mfma_f32_16x16x32_bf16 v[52:55], v[148:151], v[188:191], v[52:55]
    ds_read_b64_tr_b16 v[106:107], v10 offset:20736
    ds_read_b64_tr_b16 v[108:109], v12 offset:18432
    v_mfma_f32_16x16x32_bf16 v[56:59], v[152:155], v[184:187], v[56:59]
    ds_read_b64_tr_b16 v[110:111], v12 offset:20736
    v_mfma_f32_16x16x32_bf16 v[60:63], v[152:155], v[188:191], v[60:63]
    ds_read_b64_tr_b16 v[112:113], v10 offset:18504
    ds_read_b64_tr_b16 v[114:115], v10 offset:20808
    v_mfma_f32_16x16x32_bf16 v[64:67], v[156:159], v[184:187], v[64:67]
    ds_read_b64_tr_b16 v[116:117], v12 offset:18504
    v_mfma_f32_16x16x32_bf16 v[68:71], v[156:159], v[188:191], v[68:71]
    ds_read_b64_tr_b16 v[118:119], v12 offset:20808
    v_mfma_f32_16x16x32_bf16 v[72:75], v[160:163], v[184:187], v[72:75]
    ds_read_b64_tr_b16 v[120:121], v10 offset:18576
    ds_read_b64_tr_b16 v[122:123], v10 offset:20880
    v_mfma_f32_16x16x32_bf16 v[76:79], v[160:163], v[188:191], v[76:79]
    ds_read_b64_tr_b16 v[124:125], v12 offset:18576
    v_mfma_f32_16x16x32_bf16 v[80:83], v[164:167], v[184:187], v[80:83]
    ds_read_b64_tr_b16 v[126:127], v12 offset:20880
    v_mfma_f32_16x16x32_bf16 v[84:87], v[164:167], v[188:191], v[84:87]
    ds_read_b64_tr_b16 v[128:129], v10 offset:18648
    ds_read_b64_tr_b16 v[130:131], v10 offset:20952
    v_mfma_f32_16x16x32_bf16 v[88:91], v[168:171], v[184:187], v[88:91]
    ds_read_b64_tr_b16 v[132:133], v12 offset:18648
    v_mfma_f32_16x16x32_bf16 v[92:95], v[168:171], v[188:191], v[92:95]
    ds_read_b64_tr_b16 v[134:135], v12 offset:20952
    v_mfma_f32_16x16x32_bf16 v[96:99], v[172:175], v[184:187], v[96:99]
    ds_read_b64_tr_b16 v[136:137], v14 offset:18432
    ds_read_b64_tr_b16 v[138:139], v14 offset:20736
    v_mfma_f32_16x16x32_bf16 v[100:103], v[172:175], v[188:191], v[100:103]
    s_waitcnt lgkmcnt(12)
    v_mfma_f32_16x16x32_bf16 v[32:35], v[104:107], v[176:179], v[32:35]
    ds_read_b128 v[184:187], v17 offset:16384
    v_mfma_f32_16x16x32_bf16 v[36:39], v[104:107], v[180:183], v[36:39]
    ds_read_b128 v[188:191], v17 offset:18432
    ds_read_b64_tr_b16 v[140:141], v10 offset:27648
    v_mfma_f32_16x16x32_bf16 v[40:43], v[108:111], v[176:179], v[40:43]
    ds_read_b64_tr_b16 v[142:143], v10 offset:29952
    v_mfma_f32_16x16x32_bf16 v[44:47], v[108:111], v[180:183], v[44:47]
    ds_read_b64_tr_b16 v[144:145], v12 offset:27648
    v_mfma_f32_16x16x32_bf16 v[48:51], v[112:115], v[176:179], v[48:51]
    ds_read_b64_tr_b16 v[146:147], v12 offset:29952
    ds_read_b64_tr_b16 v[148:149], v10 offset:27720
    v_mfma_f32_16x16x32_bf16 v[52:55], v[112:115], v[180:183], v[52:55]
    ds_read_b64_tr_b16 v[150:151], v10 offset:30024
    s_waitcnt lgkmcnt(14)
    v_mfma_f32_16x16x32_bf16 v[56:59], v[116:119], v[176:179], v[56:59]
    ds_read_b64_tr_b16 v[152:153], v12 offset:27720
    v_mfma_f32_16x16x32_bf16 v[60:63], v[116:119], v[180:183], v[60:63]
    ds_read_b64_tr_b16 v[154:155], v12 offset:30024
    ds_read_b64_tr_b16 v[156:157], v10 offset:27792
    v_mfma_f32_16x16x32_bf16 v[64:67], v[120:123], v[176:179], v[64:67]
    ds_read_b64_tr_b16 v[158:159], v10 offset:30096
    v_mfma_f32_16x16x32_bf16 v[68:71], v[120:123], v[180:183], v[68:71]
    ds_read_b64_tr_b16 v[160:161], v12 offset:27792
    v_mfma_f32_16x16x32_bf16 v[72:75], v[124:127], v[176:179], v[72:75]
    ds_read_b64_tr_b16 v[162:163], v12 offset:30096
    v_mfma_f32_16x16x32_bf16 v[76:79], v[124:127], v[180:183], v[76:79]
    ds_read_b64_tr_b16 v[164:165], v10 offset:27864
    s_waitcnt lgkmcnt(14)
    v_mfma_f32_16x16x32_bf16 v[80:83], v[128:131], v[176:179], v[80:83]
    ds_read_b64_tr_b16 v[166:167], v10 offset:30168
    v_mfma_f32_16x16x32_bf16 v[84:87], v[128:131], v[180:183], v[84:87]
    ds_read_b64_tr_b16 v[168:169], v12 offset:27864
    v_mfma_f32_16x16x32_bf16 v[88:91], v[132:135], v[176:179], v[88:91]
    ds_read_b64_tr_b16 v[170:171], v12 offset:30168
    v_mfma_f32_16x16x32_bf16 v[92:95], v[132:135], v[180:183], v[92:95]
    ds_read_b64_tr_b16 v[172:173], v14 offset:27648
    v_mfma_f32_16x16x32_bf16 v[96:99], v[136:139], v[176:179], v[96:99]
    ds_read_b64_tr_b16 v[174:175], v14 offset:29952
    v_mfma_f32_16x16x32_bf16 v[100:103], v[136:139], v[180:183], v[100:103]
    s_waitcnt lgkmcnt(12)
    v_mfma_f32_16x16x32_bf16 v[32:35], v[140:143], v[184:187], v[32:35]
    v_mfma_f32_16x16x32_bf16 v[36:39], v[140:143], v[188:191], v[36:39]
    v_mfma_f32_16x16x32_bf16 v[40:43], v[144:147], v[184:187], v[40:43]
    v_mfma_f32_16x16x32_bf16 v[44:47], v[144:147], v[188:191], v[44:47]
    s_waitcnt lgkmcnt(0)
    s_barrier
    ds_read_b128 v[176:179], v16 offset:32768
    v_mfma_f32_16x16x32_bf16 v[48:51], v[148:151], v[184:187], v[48:51]
    ds_read_b128 v[180:183], v16 offset:34816
    ds_read_b64_tr_b16 v[104:105], v10 offset:36864
    v_mfma_f32_16x16x32_bf16 v[52:55], v[148:151], v[188:191], v[52:55]
    ds_read_b64_tr_b16 v[106:107], v10 offset:39168
    ds_read_b64_tr_b16 v[108:109], v12 offset:36864
    v_mfma_f32_16x16x32_bf16 v[56:59], v[152:155], v[184:187], v[56:59]
    ds_read_b64_tr_b16 v[110:111], v12 offset:39168
    v_mfma_f32_16x16x32_bf16 v[60:63], v[152:155], v[188:191], v[60:63]
    ds_read_b64_tr_b16 v[112:113], v10 offset:36936
    ds_read_b64_tr_b16 v[114:115], v10 offset:39240
    v_mfma_f32_16x16x32_bf16 v[64:67], v[156:159], v[184:187], v[64:67]
    ds_read_b64_tr_b16 v[116:117], v12 offset:36936
    v_mfma_f32_16x16x32_bf16 v[68:71], v[156:159], v[188:191], v[68:71]
    ds_read_b64_tr_b16 v[118:119], v12 offset:39240
    v_mfma_f32_16x16x32_bf16 v[72:75], v[160:163], v[184:187], v[72:75]
    ds_read_b64_tr_b16 v[120:121], v10 offset:37008
    ds_read_b64_tr_b16 v[122:123], v10 offset:39312
    v_mfma_f32_16x16x32_bf16 v[76:79], v[160:163], v[188:191], v[76:79]
    ds_read_b64_tr_b16 v[124:125], v12 offset:37008
    v_mfma_f32_16x16x32_bf16 v[80:83], v[164:167], v[184:187], v[80:83]
    ds_read_b64_tr_b16 v[126:127], v12 offset:39312
    v_mfma_f32_16x16x32_bf16 v[84:87], v[164:167], v[188:191], v[84:87]
    ds_read_b64_tr_b16 v[128:129], v10 offset:37080
    ds_read_b64_tr_b16 v[130:131], v10 offset:39384
    v_mfma_f32_16x16x32_bf16 v[88:91], v[168:171], v[184:187], v[88:91]
    ds_read_b64_tr_b16 v[132:133], v12 offset:37080
    v_mfma_f32_16x16x32_bf16 v[92:95], v[168:171], v[188:191], v[92:95]
    ds_read_b64_tr_b16 v[134:135], v12 offset:39384
    v_mfma_f32_16x16x32_bf16 v[96:99], v[172:175], v[184:187], v[96:99]
    ds_read_b64_tr_b16 v[136:137], v14 offset:36864
    ds_read_b64_tr_b16 v[138:139], v14 offset:39168
    v_mfma_f32_16x16x32_bf16 v[100:103], v[172:175], v[188:191], v[100:103]
    s_waitcnt lgkmcnt(12)
    v_mfma_f32_16x16x32_bf16 v[32:35], v[104:107], v[176:179], v[32:35]
    ds_read_b128 v[184:187], v17 offset:32768
    v_mfma_f32_16x16x32_bf16 v[36:39], v[104:107], v[180:183], v[36:39]
    ds_read_b128 v[188:191], v17 offset:34816
    ds_read_b64_tr_b16 v[140:141], v10 offset:46080
    v_mfma_f32_16x16x32_bf16 v[40:43], v[108:111], v[176:179], v[40:43]
    ds_read_b64_tr_b16 v[142:143], v10 offset:48384
    v_mfma_f32_16x16x32_bf16 v[44:47], v[108:111], v[180:183], v[44:47]
    ds_read_b64_tr_b16 v[144:145], v12 offset:46080
    v_mfma_f32_16x16x32_bf16 v[48:51], v[112:115], v[176:179], v[48:51]
    ds_read_b64_tr_b16 v[146:147], v12 offset:48384
    ds_read_b64_tr_b16 v[148:149], v10 offset:46152
    v_mfma_f32_16x16x32_bf16 v[52:55], v[112:115], v[180:183], v[52:55]
    ds_read_b64_tr_b16 v[150:151], v10 offset:48456
    s_waitcnt lgkmcnt(14)
    v_mfma_f32_16x16x32_bf16 v[56:59], v[116:119], v[176:179], v[56:59]
    ds_read_b64_tr_b16 v[152:153], v12 offset:46152
    v_mfma_f32_16x16x32_bf16 v[60:63], v[116:119], v[180:183], v[60:63]
    ds_read_b64_tr_b16 v[154:155], v12 offset:48456
    ds_read_b64_tr_b16 v[156:157], v10 offset:46224
    v_mfma_f32_16x16x32_bf16 v[64:67], v[120:123], v[176:179], v[64:67]
    ds_read_b64_tr_b16 v[158:159], v10 offset:48528
    v_mfma_f32_16x16x32_bf16 v[68:71], v[120:123], v[180:183], v[68:71]
    ds_read_b64_tr_b16 v[160:161], v12 offset:46224
    v_mfma_f32_16x16x32_bf16 v[72:75], v[124:127], v[176:179], v[72:75]
    ds_read_b64_tr_b16 v[162:163], v12 offset:48528
    v_mfma_f32_16x16x32_bf16 v[76:79], v[124:127], v[180:183], v[76:79]
    ds_read_b64_tr_b16 v[164:165], v10 offset:46296
    s_waitcnt lgkmcnt(14)
    v_mfma_f32_16x16x32_bf16 v[80:83], v[128:131], v[176:179], v[80:83]
    ds_read_b64_tr_b16 v[166:167], v10 offset:48600
    v_mfma_f32_16x16x32_bf16 v[84:87], v[128:131], v[180:183], v[84:87]
    ds_read_b64_tr_b16 v[168:169], v12 offset:46296
    v_mfma_f32_16x16x32_bf16 v[88:91], v[132:135], v[176:179], v[88:91]
    ds_read_b64_tr_b16 v[170:171], v12 offset:48600
    v_mfma_f32_16x16x32_bf16 v[92:95], v[132:135], v[180:183], v[92:95]
    ds_read_b64_tr_b16 v[172:173], v14 offset:46080
    v_mfma_f32_16x16x32_bf16 v[96:99], v[136:139], v[176:179], v[96:99]
    ds_read_b64_tr_b16 v[174:175], v14 offset:48384
    v_mfma_f32_16x16x32_bf16 v[100:103], v[136:139], v[180:183], v[100:103]
    s_waitcnt lgkmcnt(12)
    v_mfma_f32_16x16x32_bf16 v[32:35], v[140:143], v[184:187], v[32:35]
    v_mfma_f32_16x16x32_bf16 v[36:39], v[140:143], v[188:191], v[36:39]
    v_mfma_f32_16x16x32_bf16 v[40:43], v[144:147], v[184:187], v[40:43]
    v_mfma_f32_16x16x32_bf16 v[44:47], v[144:147], v[188:191], v[44:47]
    s_waitcnt lgkmcnt(0)
    s_barrier
    ds_read_b128 v[176:179], v16 offset:49152
    v_mfma_f32_16x16x32_bf16 v[48:51], v[148:151], v[184:187], v[48:51]
    ds_read_b128 v[180:183], v16 offset:51200
    ds_read_b64_tr_b16 v[104:105], v10 offset:55296
    v_mfma_f32_16x16x32_bf16 v[52:55], v[148:151], v[188:191], v[52:55]
    ds_read_b64_tr_b16 v[106:107], v10 offset:57600
    ds_read_b64_tr_b16 v[108:109], v12 offset:55296
    v_mfma_f32_16x16x32_bf16 v[56:59], v[152:155], v[184:187], v[56:59]
    ds_read_b64_tr_b16 v[110:111], v12 offset:57600
    v_mfma_f32_16x16x32_bf16 v[60:63], v[152:155], v[188:191], v[60:63]
    ds_read_b64_tr_b16 v[112:113], v10 offset:55368
    ds_read_b64_tr_b16 v[114:115], v10 offset:57672
    v_mfma_f32_16x16x32_bf16 v[64:67], v[156:159], v[184:187], v[64:67]
    ds_read_b64_tr_b16 v[116:117], v12 offset:55368
    v_mfma_f32_16x16x32_bf16 v[68:71], v[156:159], v[188:191], v[68:71]
    ds_read_b64_tr_b16 v[118:119], v12 offset:57672
    v_mfma_f32_16x16x32_bf16 v[72:75], v[160:163], v[184:187], v[72:75]
    ds_read_b64_tr_b16 v[120:121], v10 offset:55440
    ds_read_b64_tr_b16 v[122:123], v10 offset:57744
    v_mfma_f32_16x16x32_bf16 v[76:79], v[160:163], v[188:191], v[76:79]
    ds_read_b64_tr_b16 v[124:125], v12 offset:55440
    v_mfma_f32_16x16x32_bf16 v[80:83], v[164:167], v[184:187], v[80:83]
    ds_read_b64_tr_b16 v[126:127], v12 offset:57744
    v_mfma_f32_16x16x32_bf16 v[84:87], v[164:167], v[188:191], v[84:87]
    ds_read_b64_tr_b16 v[128:129], v10 offset:55512
    ds_read_b64_tr_b16 v[130:131], v10 offset:57816
    v_mfma_f32_16x16x32_bf16 v[88:91], v[168:171], v[184:187], v[88:91]
    ds_read_b64_tr_b16 v[132:133], v12 offset:55512
    v_mfma_f32_16x16x32_bf16 v[92:95], v[168:171], v[188:191], v[92:95]
    ds_read_b64_tr_b16 v[134:135], v12 offset:57816
    v_mfma_f32_16x16x32_bf16 v[96:99], v[172:175], v[184:187], v[96:99]
    ds_read_b64_tr_b16 v[136:137], v14 offset:55296
    ds_read_b64_tr_b16 v[138:139], v14 offset:57600
    v_mfma_f32_16x16x32_bf16 v[100:103], v[172:175], v[188:191], v[100:103]
    s_waitcnt lgkmcnt(12)
    v_mfma_f32_16x16x32_bf16 v[32:35], v[104:107], v[176:179], v[32:35]
    ds_read_b128 v[184:187], v17 offset:49152
    v_mfma_f32_16x16x32_bf16 v[36:39], v[104:107], v[180:183], v[36:39]
    ds_read_b128 v[188:191], v17 offset:51200
    ds_read_b64_tr_b16 v[140:141], v10 offset:64512
    v_mfma_f32_16x16x32_bf16 v[40:43], v[108:111], v[176:179], v[40:43]
    ds_read_b64_tr_b16 v[142:143], v11 offset:29952
    v_mfma_f32_16x16x32_bf16 v[44:47], v[108:111], v[180:183], v[44:47]
    ds_read_b64_tr_b16 v[144:145], v12 offset:64512
    v_mfma_f32_16x16x32_bf16 v[48:51], v[112:115], v[176:179], v[48:51]
    ds_read_b64_tr_b16 v[146:147], v13 offset:29952
    ds_read_b64_tr_b16 v[148:149], v10 offset:64584
    v_mfma_f32_16x16x32_bf16 v[52:55], v[112:115], v[180:183], v[52:55]
    ds_read_b64_tr_b16 v[150:151], v11 offset:30024
    s_waitcnt lgkmcnt(14)
    v_mfma_f32_16x16x32_bf16 v[56:59], v[116:119], v[176:179], v[56:59]
    ds_read_b64_tr_b16 v[152:153], v12 offset:64584
    v_mfma_f32_16x16x32_bf16 v[60:63], v[116:119], v[180:183], v[60:63]
    ds_read_b64_tr_b16 v[154:155], v13 offset:30024
    ds_read_b64_tr_b16 v[156:157], v10 offset:64656
    v_mfma_f32_16x16x32_bf16 v[64:67], v[120:123], v[176:179], v[64:67]
    ds_read_b64_tr_b16 v[158:159], v11 offset:30096
    v_mfma_f32_16x16x32_bf16 v[68:71], v[120:123], v[180:183], v[68:71]
    ds_read_b64_tr_b16 v[160:161], v12 offset:64656
    v_mfma_f32_16x16x32_bf16 v[72:75], v[124:127], v[176:179], v[72:75]
    ds_read_b64_tr_b16 v[162:163], v13 offset:30096
    v_mfma_f32_16x16x32_bf16 v[76:79], v[124:127], v[180:183], v[76:79]
    ds_read_b64_tr_b16 v[164:165], v10 offset:64728
    s_waitcnt lgkmcnt(14)
    v_mfma_f32_16x16x32_bf16 v[80:83], v[128:131], v[176:179], v[80:83]
    ds_read_b64_tr_b16 v[166:167], v11 offset:30168
    v_mfma_f32_16x16x32_bf16 v[84:87], v[128:131], v[180:183], v[84:87]
    ds_read_b64_tr_b16 v[168:169], v12 offset:64728
    v_mfma_f32_16x16x32_bf16 v[88:91], v[132:135], v[176:179], v[88:91]
    ds_read_b64_tr_b16 v[170:171], v13 offset:30168
    v_mfma_f32_16x16x32_bf16 v[92:95], v[132:135], v[180:183], v[92:95]
    ds_read_b64_tr_b16 v[172:173], v14 offset:64512
    v_mfma_f32_16x16x32_bf16 v[96:99], v[136:139], v[176:179], v[96:99]
    ds_read_b64_tr_b16 v[174:175], v15 offset:29952
    v_mfma_f32_16x16x32_bf16 v[100:103], v[136:139], v[180:183], v[100:103]
    s_waitcnt lgkmcnt(12)
    v_mfma_f32_16x16x32_bf16 v[32:35], v[140:143], v[184:187], v[32:35]
    v_mfma_f32_16x16x32_bf16 v[36:39], v[140:143], v[188:191], v[36:39]
    v_mfma_f32_16x16x32_bf16 v[40:43], v[144:147], v[184:187], v[40:43]
    v_mfma_f32_16x16x32_bf16 v[44:47], v[144:147], v[188:191], v[44:47]
    s_waitcnt lgkmcnt(0)
    s_barrier
    ds_read_b128 v[176:179], v16 offset:0
    v_mfma_f32_16x16x32_bf16 v[48:51], v[148:151], v[184:187], v[48:51]
    ds_read_b128 v[180:183], v16 offset:2048
    ds_read_b64_tr_b16 v[104:105], v10 offset:0
    v_mfma_f32_16x16x32_bf16 v[52:55], v[148:151], v[188:191], v[52:55]
    ds_read_b64_tr_b16 v[106:107], v10 offset:2304
    ds_read_b64_tr_b16 v[108:109], v12 offset:0
    v_mfma_f32_16x16x32_bf16 v[56:59], v[152:155], v[184:187], v[56:59]
    ds_read_b64_tr_b16 v[110:111], v12 offset:2304
    v_mfma_f32_16x16x32_bf16 v[60:63], v[152:155], v[188:191], v[60:63]
    ds_read_b64_tr_b16 v[112:113], v10 offset:72
    ds_read_b64_tr_b16 v[114:115], v10 offset:2376
    v_mfma_f32_16x16x32_bf16 v[64:67], v[156:159], v[184:187], v[64:67]
    ds_read_b64_tr_b16 v[116:117], v12 offset:72
    v_mfma_f32_16x16x32_bf16 v[68:71], v[156:159], v[188:191], v[68:71]
    ds_read_b64_tr_b16 v[118:119], v12 offset:2376
    v_mfma_f32_16x16x32_bf16 v[72:75], v[160:163], v[184:187], v[72:75]
    ds_read_b64_tr_b16 v[120:121], v10 offset:144
    ds_read_b64_tr_b16 v[122:123], v10 offset:2448
    v_mfma_f32_16x16x32_bf16 v[76:79], v[160:163], v[188:191], v[76:79]
    ds_read_b64_tr_b16 v[124:125], v12 offset:144
    v_mfma_f32_16x16x32_bf16 v[80:83], v[164:167], v[184:187], v[80:83]
    ds_read_b64_tr_b16 v[126:127], v12 offset:2448
    v_mfma_f32_16x16x32_bf16 v[84:87], v[164:167], v[188:191], v[84:87]
    ds_read_b64_tr_b16 v[128:129], v10 offset:216
    ds_read_b64_tr_b16 v[130:131], v10 offset:2520
    v_mfma_f32_16x16x32_bf16 v[88:91], v[168:171], v[184:187], v[88:91]
    ds_read_b64_tr_b16 v[132:133], v12 offset:216
    v_mfma_f32_16x16x32_bf16 v[92:95], v[168:171], v[188:191], v[92:95]
    ds_read_b64_tr_b16 v[134:135], v12 offset:2520
    v_mfma_f32_16x16x32_bf16 v[96:99], v[172:175], v[184:187], v[96:99]
    ds_read_b64_tr_b16 v[136:137], v14 offset:0
    ds_read_b64_tr_b16 v[138:139], v14 offset:2304
    v_mfma_f32_16x16x32_bf16 v[100:103], v[172:175], v[188:191], v[100:103]
    s_waitcnt lgkmcnt(12)
    v_mfma_f32_16x16x32_bf16 v[32:35], v[104:107], v[176:179], v[32:35]
    ds_read_b128 v[184:187], v17 offset:0
    v_mfma_f32_16x16x32_bf16 v[36:39], v[104:107], v[180:183], v[36:39]
    ds_read_b128 v[188:191], v17 offset:2048
    ds_read_b64_tr_b16 v[140:141], v10 offset:9216
    v_mfma_f32_16x16x32_bf16 v[40:43], v[108:111], v[176:179], v[40:43]
    ds_read_b64_tr_b16 v[142:143], v10 offset:11520
    v_mfma_f32_16x16x32_bf16 v[44:47], v[108:111], v[180:183], v[44:47]
    ds_read_b64_tr_b16 v[144:145], v12 offset:9216
    v_mfma_f32_16x16x32_bf16 v[48:51], v[112:115], v[176:179], v[48:51]
    ds_read_b64_tr_b16 v[146:147], v12 offset:11520
    ds_read_b64_tr_b16 v[148:149], v10 offset:9288
    v_mfma_f32_16x16x32_bf16 v[52:55], v[112:115], v[180:183], v[52:55]
    ds_read_b64_tr_b16 v[150:151], v10 offset:11592
    s_waitcnt lgkmcnt(14)
    v_mfma_f32_16x16x32_bf16 v[56:59], v[116:119], v[176:179], v[56:59]
    ds_read_b64_tr_b16 v[152:153], v12 offset:9288
    v_mfma_f32_16x16x32_bf16 v[60:63], v[116:119], v[180:183], v[60:63]
    ds_read_b64_tr_b16 v[154:155], v12 offset:11592
    ds_read_b64_tr_b16 v[156:157], v10 offset:9360
    v_mfma_f32_16x16x32_bf16 v[64:67], v[120:123], v[176:179], v[64:67]
    ds_read_b64_tr_b16 v[158:159], v10 offset:11664
    v_mfma_f32_16x16x32_bf16 v[68:71], v[120:123], v[180:183], v[68:71]
    ds_read_b64_tr_b16 v[160:161], v12 offset:9360
    v_mfma_f32_16x16x32_bf16 v[72:75], v[124:127], v[176:179], v[72:75]
    ds_read_b64_tr_b16 v[162:163], v12 offset:11664
    v_mfma_f32_16x16x32_bf16 v[76:79], v[124:127], v[180:183], v[76:79]
    ds_read_b64_tr_b16 v[164:165], v10 offset:9432
    s_waitcnt lgkmcnt(14)
    v_mfma_f32_16x16x32_bf16 v[80:83], v[128:131], v[176:179], v[80:83]
    ds_read_b64_tr_b16 v[166:167], v10 offset:11736
    v_mfma_f32_16x16x32_bf16 v[84:87], v[128:131], v[180:183], v[84:87]
    ds_read_b64_tr_b16 v[168:169], v12 offset:9432
    v_mfma_f32_16x16x32_bf16 v[88:91], v[132:135], v[176:179], v[88:91]
    ds_read_b64_tr_b16 v[170:171], v12 offset:11736
    v_mfma_f32_16x16x32_bf16 v[92:95], v[132:135], v[180:183], v[92:95]
    ds_read_b64_tr_b16 v[172:173], v14 offset:9216
    v_mfma_f32_16x16x32_bf16 v[96:99], v[136:139], v[176:179], v[96:99]
    ds_read_b64_tr_b16 v[174:175], v14 offset:11520
    v_mfma_f32_16x16x32_bf16 v[100:103], v[136:139], v[180:183], v[100:103]
    s_waitcnt lgkmcnt(12)
    v_mfma_f32_16x16x32_bf16 v[32:35], v[140:143], v[184:187], v[32:35]
    v_mfma_f32_16x16x32_bf16 v[36:39], v[140:143], v[188:191], v[36:39]
    v_mfma_f32_16x16x32_bf16 v[40:43], v[144:147], v[184:187], v[40:43]
    v_mfma_f32_16x16x32_bf16 v[44:47], v[144:147], v[188:191], v[44:47]
    s_waitcnt lgkmcnt(0)
    s_barrier
    ds_read_b128 v[176:179], v16 offset:16384
    v_mfma_f32_16x16x32_bf16 v[48:51], v[148:151], v[184:187], v[48:51]
    ds_read_b128 v[180:183], v16 offset:18432
    ds_read_b64_tr_b16 v[104:105], v10 offset:18432
    v_mfma_f32_16x16x32_bf16 v[52:55], v[148:151], v[188:191], v[52:55]
    ds_read_b64_tr_b16 v[106:107], v10 offset:20736
    ds_read_b64_tr_b16 v[108:109], v12 offset:18432
    v_mfma_f32_16x16x32_bf16 v[56:59], v[152:155], v[184:187], v[56:59]
    ds_read_b64_tr_b16 v[110:111], v12 offset:20736
    v_mfma_f32_16x16x32_bf16 v[60:63], v[152:155], v[188:191], v[60:63]
    ds_read_b64_tr_b16 v[112:113], v10 offset:18504
    ds_read_b64_tr_b16 v[114:115], v10 offset:20808
    v_mfma_f32_16x16x32_bf16 v[64:67], v[156:159], v[184:187], v[64:67]
    ds_read_b64_tr_b16 v[116:117], v12 offset:18504
    v_mfma_f32_16x16x32_bf16 v[68:71], v[156:159], v[188:191], v[68:71]
    ds_read_b64_tr_b16 v[118:119], v12 offset:20808
    v_mfma_f32_16x16x32_bf16 v[72:75], v[160:163], v[184:187], v[72:75]
    ds_read_b64_tr_b16 v[120:121], v10 offset:18576
    ds_read_b64_tr_b16 v[122:123], v10 offset:20880
    v_mfma_f32_16x16x32_bf16 v[76:79], v[160:163], v[188:191], v[76:79]
    ds_read_b64_tr_b16 v[124:125], v12 offset:18576
    v_mfma_f32_16x16x32_bf16 v[80:83], v[164:167], v[184:187], v[80:83]
    ds_read_b64_tr_b16 v[126:127], v12 offset:20880
    v_mfma_f32_16x16x32_bf16 v[84:87], v[164:167], v[188:191], v[84:87]
    ds_read_b64_tr_b16 v[128:129], v10 offset:18648
    ds_read_b64_tr_b16 v[130:131], v10 offset:20952
    v_mfma_f32_16x16x32_bf16 v[88:91], v[168:171], v[184:187], v[88:91]
    ds_read_b64_tr_b16 v[132:133], v12 offset:18648
    v_mfma_f32_16x16x32_bf16 v[92:95], v[168:171], v[188:191], v[92:95]
    ds_read_b64_tr_b16 v[134:135], v12 offset:20952
    v_mfma_f32_16x16x32_bf16 v[96:99], v[172:175], v[184:187], v[96:99]
    ds_read_b64_tr_b16 v[136:137], v14 offset:18432
    ds_read_b64_tr_b16 v[138:139], v14 offset:20736
    v_mfma_f32_16x16x32_bf16 v[100:103], v[172:175], v[188:191], v[100:103]
    s_waitcnt lgkmcnt(12)
    v_mfma_f32_16x16x32_bf16 v[32:35], v[104:107], v[176:179], v[32:35]
    ds_read_b128 v[184:187], v17 offset:16384
    v_mfma_f32_16x16x32_bf16 v[36:39], v[104:107], v[180:183], v[36:39]
    ds_read_b128 v[188:191], v17 offset:18432
    ds_read_b64_tr_b16 v[140:141], v10 offset:27648
    v_mfma_f32_16x16x32_bf16 v[40:43], v[108:111], v[176:179], v[40:43]
    ds_read_b64_tr_b16 v[142:143], v10 offset:29952
    v_mfma_f32_16x16x32_bf16 v[44:47], v[108:111], v[180:183], v[44:47]
    ds_read_b64_tr_b16 v[144:145], v12 offset:27648
    v_mfma_f32_16x16x32_bf16 v[48:51], v[112:115], v[176:179], v[48:51]
    ds_read_b64_tr_b16 v[146:147], v12 offset:29952
    ds_read_b64_tr_b16 v[148:149], v10 offset:27720
    v_mfma_f32_16x16x32_bf16 v[52:55], v[112:115], v[180:183], v[52:55]
    ds_read_b64_tr_b16 v[150:151], v10 offset:30024
    s_waitcnt lgkmcnt(14)
    v_mfma_f32_16x16x32_bf16 v[56:59], v[116:119], v[176:179], v[56:59]
    ds_read_b64_tr_b16 v[152:153], v12 offset:27720
    v_mfma_f32_16x16x32_bf16 v[60:63], v[116:119], v[180:183], v[60:63]
    ds_read_b64_tr_b16 v[154:155], v12 offset:30024
    ds_read_b64_tr_b16 v[156:157], v10 offset:27792
    v_mfma_f32_16x16x32_bf16 v[64:67], v[120:123], v[176:179], v[64:67]
    ds_read_b64_tr_b16 v[158:159], v10 offset:30096
    v_mfma_f32_16x16x32_bf16 v[68:71], v[120:123], v[180:183], v[68:71]
    ds_read_b64_tr_b16 v[160:161], v12 offset:27792
    v_mfma_f32_16x16x32_bf16 v[72:75], v[124:127], v[176:179], v[72:75]
    ds_read_b64_tr_b16 v[162:163], v12 offset:30096
    v_mfma_f32_16x16x32_bf16 v[76:79], v[124:127], v[180:183], v[76:79]
    ds_read_b64_tr_b16 v[164:165], v10 offset:27864
    s_waitcnt lgkmcnt(14)
    v_mfma_f32_16x16x32_bf16 v[80:83], v[128:131], v[176:179], v[80:83]
    ds_read_b64_tr_b16 v[166:167], v10 offset:30168
    v_mfma_f32_16x16x32_bf16 v[84:87], v[128:131], v[180:183], v[84:87]
    ds_read_b64_tr_b16 v[168:169], v12 offset:27864
    v_mfma_f32_16x16x32_bf16 v[88:91], v[132:135], v[176:179], v[88:91]
    ds_read_b64_tr_b16 v[170:171], v12 offset:30168
    v_mfma_f32_16x16x32_bf16 v[92:95], v[132:135], v[180:183], v[92:95]
    ds_read_b64_tr_b16 v[172:173], v14 offset:27648
    v_mfma_f32_16x16x32_bf16 v[96:99], v[136:139], v[176:179], v[96:99]
    ds_read_b64_tr_b16 v[174:175], v14 offset:29952
    v_mfma_f32_16x16x32_bf16 v[100:103], v[136:139], v[180:183], v[100:103]
    s_waitcnt lgkmcnt(12)
    v_mfma_f32_16x16x32_bf16 v[32:35], v[140:143], v[184:187], v[32:35]
    v_mfma_f32_16x16x32_bf16 v[36:39], v[140:143], v[188:191], v[36:39]
    v_mfma_f32_16x16x32_bf16 v[40:43], v[144:147], v[184:187], v[40:43]
    v_mfma_f32_16x16x32_bf16 v[44:47], v[144:147], v[188:191], v[44:47]
    s_waitcnt lgkmcnt(0)
    s_barrier
    ds_read_b128 v[176:179], v16 offset:32768
    v_mfma_f32_16x16x32_bf16 v[48:51], v[148:151], v[184:187], v[48:51]
    ds_read_b128 v[180:183], v16 offset:34816
    ds_read_b64_tr_b16 v[104:105], v10 offset:36864
    v_mfma_f32_16x16x32_bf16 v[52:55], v[148:151], v[188:191], v[52:55]
    ds_read_b64_tr_b16 v[106:107], v10 offset:39168
    ds_read_b64_tr_b16 v[108:109], v12 offset:36864
    v_mfma_f32_16x16x32_bf16 v[56:59], v[152:155], v[184:187], v[56:59]
    ds_read_b64_tr_b16 v[110:111], v12 offset:39168
    v_mfma_f32_16x16x32_bf16 v[60:63], v[152:155], v[188:191], v[60:63]
    ds_read_b64_tr_b16 v[112:113], v10 offset:36936
    ds_read_b64_tr_b16 v[114:115], v10 offset:39240
    v_mfma_f32_16x16x32_bf16 v[64:67], v[156:159], v[184:187], v[64:67]
    ds_read_b64_tr_b16 v[116:117], v12 offset:36936
    v_mfma_f32_16x16x32_bf16 v[68:71], v[156:159], v[188:191], v[68:71]
    ds_read_b64_tr_b16 v[118:119], v12 offset:39240
    v_mfma_f32_16x16x32_bf16 v[72:75], v[160:163], v[184:187], v[72:75]
    ds_read_b64_tr_b16 v[120:121], v10 offset:37008
    ds_read_b64_tr_b16 v[122:123], v10 offset:39312
    v_mfma_f32_16x16x32_bf16 v[76:79], v[160:163], v[188:191], v[76:79]
    ds_read_b64_tr_b16 v[124:125], v12 offset:37008
    v_mfma_f32_16x16x32_bf16 v[80:83], v[164:167], v[184:187], v[80:83]
    ds_read_b64_tr_b16 v[126:127], v12 offset:39312
    v_mfma_f32_16x16x32_bf16 v[84:87], v[164:167], v[188:191], v[84:87]
    ds_read_b64_tr_b16 v[128:129], v10 offset:37080
    ds_read_b64_tr_b16 v[130:131], v10 offset:39384
    v_mfma_f32_16x16x32_bf16 v[88:91], v[168:171], v[184:187], v[88:91]
    ds_read_b64_tr_b16 v[132:133], v12 offset:37080
    v_mfma_f32_16x16x32_bf16 v[92:95], v[168:171], v[188:191], v[92:95]
    ds_read_b64_tr_b16 v[134:135], v12 offset:39384
    v_mfma_f32_16x16x32_bf16 v[96:99], v[172:175], v[184:187], v[96:99]
    ds_read_b64_tr_b16 v[136:137], v14 offset:36864
    ds_read_b64_tr_b16 v[138:139], v14 offset:39168
    v_mfma_f32_16x16x32_bf16 v[100:103], v[172:175], v[188:191], v[100:103]
    s_waitcnt lgkmcnt(12)
    v_mfma_f32_16x16x32_bf16 v[32:35], v[104:107], v[176:179], v[32:35]
    ds_read_b128 v[184:187], v17 offset:32768
    v_mfma_f32_16x16x32_bf16 v[36:39], v[104:107], v[180:183], v[36:39]
    ds_read_b128 v[188:191], v17 offset:34816
    ds_read_b64_tr_b16 v[140:141], v10 offset:46080
    v_mfma_f32_16x16x32_bf16 v[40:43], v[108:111], v[176:179], v[40:43]
    ds_read_b64_tr_b16 v[142:143], v10 offset:48384
    v_mfma_f32_16x16x32_bf16 v[44:47], v[108:111], v[180:183], v[44:47]
    ds_read_b64_tr_b16 v[144:145], v12 offset:46080
    v_mfma_f32_16x16x32_bf16 v[48:51], v[112:115], v[176:179], v[48:51]
    ds_read_b64_tr_b16 v[146:147], v12 offset:48384
    ds_read_b64_tr_b16 v[148:149], v10 offset:46152
    v_mfma_f32_16x16x32_bf16 v[52:55], v[112:115], v[180:183], v[52:55]
    ds_read_b64_tr_b16 v[150:151], v10 offset:48456
    s_waitcnt lgkmcnt(14)
    v_mfma_f32_16x16x32_bf16 v[56:59], v[116:119], v[176:179], v[56:59]
    ds_read_b64_tr_b16 v[152:153], v12 offset:46152
    v_mfma_f32_16x16x32_bf16 v[60:63], v[116:119], v[180:183], v[60:63]
    ds_read_b64_tr_b16 v[154:155], v12 offset:48456
    ds_read_b64_tr_b16 v[156:157], v10 offset:46224
    v_mfma_f32_16x16x32_bf16 v[64:67], v[120:123], v[176:179], v[64:67]
    ds_read_b64_tr_b16 v[158:159], v10 offset:48528
    v_mfma_f32_16x16x32_bf16 v[68:71], v[120:123], v[180:183], v[68:71]
    ds_read_b64_tr_b16 v[160:161], v12 offset:46224
    v_mfma_f32_16x16x32_bf16 v[72:75], v[124:127], v[176:179], v[72:75]
    ds_read_b64_tr_b16 v[162:163], v12 offset:48528
    v_mfma_f32_16x16x32_bf16 v[76:79], v[124:127], v[180:183], v[76:79]
    ds_read_b64_tr_b16 v[164:165], v10 offset:46296
    s_waitcnt lgkmcnt(14)
    v_mfma_f32_16x16x32_bf16 v[80:83], v[128:131], v[176:179], v[80:83]
    ds_read_b64_tr_b16 v[166:167], v10 offset:48600
    v_mfma_f32_16x16x32_bf16 v[84:87], v[128:131], v[180:183], v[84:87]
    ds_read_b64_tr_b16 v[168:169], v12 offset:46296
    v_mfma_f32_16x16x32_bf16 v[88:91], v[132:135], v[176:179], v[88:91]
    ds_read_b64_tr_b16 v[170:171], v12 offset:48600
    v_mfma_f32_16x16x32_bf16 v[92:95], v[132:135], v[180:183], v[92:95]
    ds_read_b64_tr_b16 v[172:173], v14 offset:46080
    v_mfma_f32_16x16x32_bf16 v[96:99], v[136:139], v[176:179], v[96:99]
    ds_read_b64_tr_b16 v[174:175], v14 offset:48384
    v_mfma_f32_16x16x32_bf16 v[100:103], v[136:139], v[180:183], v[100:103]
    s_waitcnt lgkmcnt(12)
    v_mfma_f32_16x16x32_bf16 v[32:35], v[140:143], v[184:187], v[32:35]
    v_mfma_f32_16x16x32_bf16 v[36:39], v[140:143], v[188:191], v[36:39]
    v_mfma_f32_16x16x32_bf16 v[40:43], v[144:147], v[184:187], v[40:43]
    v_mfma_f32_16x16x32_bf16 v[44:47], v[144:147], v[188:191], v[44:47]
    s_waitcnt lgkmcnt(0)
    s_barrier
    ds_read_b128 v[176:179], v16 offset:49152
    v_mfma_f32_16x16x32_bf16 v[48:51], v[148:151], v[184:187], v[48:51]
    ds_read_b128 v[180:183], v16 offset:51200
    ds_read_b64_tr_b16 v[104:105], v10 offset:55296
    v_mfma_f32_16x16x32_bf16 v[52:55], v[148:151], v[188:191], v[52:55]
    ds_read_b64_tr_b16 v[106:107], v10 offset:57600
    ds_read_b64_tr_b16 v[108:109], v12 offset:55296
    v_mfma_f32_16x16x32_bf16 v[56:59], v[152:155], v[184:187], v[56:59]
    ds_read_b64_tr_b16 v[110:111], v12 offset:57600
    v_mfma_f32_16x16x32_bf16 v[60:63], v[152:155], v[188:191], v[60:63]
    ds_read_b64_tr_b16 v[112:113], v10 offset:55368
    ds_read_b64_tr_b16 v[114:115], v10 offset:57672
    v_mfma_f32_16x16x32_bf16 v[64:67], v[156:159], v[184:187], v[64:67]
    ds_read_b64_tr_b16 v[116:117], v12 offset:55368
    v_mfma_f32_16x16x32_bf16 v[68:71], v[156:159], v[188:191], v[68:71]
    ds_read_b64_tr_b16 v[118:119], v12 offset:57672
    v_mfma_f32_16x16x32_bf16 v[72:75], v[160:163], v[184:187], v[72:75]
    ds_read_b64_tr_b16 v[120:121], v10 offset:55440
    ds_read_b64_tr_b16 v[122:123], v10 offset:57744
    v_mfma_f32_16x16x32_bf16 v[76:79], v[160:163], v[188:191], v[76:79]
    ds_read_b64_tr_b16 v[124:125], v12 offset:55440
    v_mfma_f32_16x16x32_bf16 v[80:83], v[164:167], v[184:187], v[80:83]
    ds_read_b64_tr_b16 v[126:127], v12 offset:57744
    v_mfma_f32_16x16x32_bf16 v[84:87], v[164:167], v[188:191], v[84:87]
    ds_read_b64_tr_b16 v[128:129], v10 offset:55512
    ds_read_b64_tr_b16 v[130:131], v10 offset:57816
    v_mfma_f32_16x16x32_bf16 v[88:91], v[168:171], v[184:187], v[88:91]
    ds_read_b64_tr_b16 v[132:133], v12 offset:55512
    v_mfma_f32_16x16x32_bf16 v[92:95], v[168:171], v[188:191], v[92:95]
    ds_read_b64_tr_b16 v[134:135], v12 offset:57816
    v_mfma_f32_16x16x32_bf16 v[96:99], v[172:175], v[184:187], v[96:99]
    ds_read_b64_tr_b16 v[136:137], v14 offset:55296
    ds_read_b64_tr_b16 v[138:139], v14 offset:57600
    v_mfma_f32_16x16x32_bf16 v[100:103], v[172:175], v[188:191], v[100:103]
    s_waitcnt lgkmcnt(12)
    v_mfma_f32_16x16x32_bf16 v[32:35], v[104:107], v[176:179], v[32:35]
    ds_read_b128 v[184:187], v17 offset:49152
    v_mfma_f32_16x16x32_bf16 v[36:39], v[104:107], v[180:183], v[36:39]
    ds_read_b128 v[188:191], v17 offset:51200
    ds_read_b64_tr_b16 v[140:141], v10 offset:64512
    v_mfma_f32_16x16x32_bf16 v[40:43], v[108:111], v[176:179], v[40:43]
    ds_read_b64_tr_b16 v[142:143], v11 offset:29952
    v_mfma_f32_16x16x32_bf16 v[44:47], v[108:111], v[180:183], v[44:47]
    ds_read_b64_tr_b16 v[144:145], v12 offset:64512
    v_mfma_f32_16x16x32_bf16 v[48:51], v[112:115], v[176:179], v[48:51]
    ds_read_b64_tr_b16 v[146:147], v13 offset:29952
    ds_read_b64_tr_b16 v[148:149], v10 offset:64584
    v_mfma_f32_16x16x32_bf16 v[52:55], v[112:115], v[180:183], v[52:55]
    ds_read_b64_tr_b16 v[150:151], v11 offset:30024
    s_waitcnt lgkmcnt(14)
    v_mfma_f32_16x16x32_bf16 v[56:59], v[116:119], v[176:179], v[56:59]
    ds_read_b64_tr_b16 v[152:153], v12 offset:64584
    v_mfma_f32_16x16x32_bf16 v[60:63], v[116:119], v[180:183], v[60:63]
    ds_read_b64_tr_b16 v[154:155], v13 offset:30024
    ds_read_b64_tr_b16 v[156:157], v10 offset:64656
    v_mfma_f32_16x16x32_bf16 v[64:67], v[120:123], v[176:179], v[64:67]
    ds_read_b64_tr_b16 v[158:159], v11 offset:30096
    v_mfma_f32_16x16x32_bf16 v[68:71], v[120:123], v[180:183], v[68:71]
    ds_read_b64_tr_b16 v[160:161], v12 offset:64656
    v_mfma_f32_16x16x32_bf16 v[72:75], v[124:127], v[176:179], v[72:75]
    ds_read_b64_tr_b16 v[162:163], v13 offset:30096
    v_mfma_f32_16x16x32_bf16 v[76:79], v[124:127], v[180:183], v[76:79]
    ds_read_b64_tr_b16 v[164:165], v10 offset:64728
    s_waitcnt lgkmcnt(14)
    v_mfma_f32_16x16x32_bf16 v[80:83], v[128:131], v[176:179], v[80:83]
    ds_read_b64_tr_b16 v[166:167], v11 offset:30168
    v_mfma_f32_16x16x32_bf16 v[84:87], v[128:131], v[180:183], v[84:87]
    ds_read_b64_tr_b16 v[168:169], v12 offset:64728
    v_mfma_f32_16x16x32_bf16 v[88:91], v[132:135], v[176:179], v[88:91]
    ds_read_b64_tr_b16 v[170:171], v13 offset:30168
    v_mfma_f32_16x16x32_bf16 v[92:95], v[132:135], v[180:183], v[92:95]
    ds_read_b64_tr_b16 v[172:173], v14 offset:64512
    v_mfma_f32_16x16x32_bf16 v[96:99], v[136:139], v[176:179], v[96:99]
    ds_read_b64_tr_b16 v[174:175], v15 offset:29952
    v_mfma_f32_16x16x32_bf16 v[100:103], v[136:139], v[180:183], v[100:103]
    s_waitcnt lgkmcnt(12)
    v_mfma_f32_16x16x32_bf16 v[32:35], v[140:143], v[184:187], v[32:35]
    v_mfma_f32_16x16x32_bf16 v[36:39], v[140:143], v[188:191], v[36:39]
    v_mfma_f32_16x16x32_bf16 v[40:43], v[144:147], v[184:187], v[40:43]
    v_mfma_f32_16x16x32_bf16 v[44:47], v[144:147], v[188:191], v[44:47]
    s_waitcnt lgkmcnt(0)
    s_barrier
    ds_read_b128 v[176:179], v16 offset:0
    v_mfma_f32_16x16x32_bf16 v[48:51], v[148:151], v[184:187], v[48:51]
    ds_read_b128 v[180:183], v16 offset:2048
    ds_read_b64_tr_b16 v[104:105], v10 offset:0
    v_mfma_f32_16x16x32_bf16 v[52:55], v[148:151], v[188:191], v[52:55]
    ds_read_b64_tr_b16 v[106:107], v10 offset:2304
    ds_read_b64_tr_b16 v[108:109], v12 offset:0
    v_mfma_f32_16x16x32_bf16 v[56:59], v[152:155], v[184:187], v[56:59]
    ds_read_b64_tr_b16 v[110:111], v12 offset:2304
    v_mfma_f32_16x16x32_bf16 v[60:63], v[152:155], v[188:191], v[60:63]
    ds_read_b64_tr_b16 v[112:113], v10 offset:72
    ds_read_b64_tr_b16 v[114:115], v10 offset:2376
    v_mfma_f32_16x16x32_bf16 v[64:67], v[156:159], v[184:187], v[64:67]
    ds_read_b64_tr_b16 v[116:117], v12 offset:72
    v_mfma_f32_16x16x32_bf16 v[68:71], v[156:159], v[188:191], v[68:71]
    ds_read_b64_tr_b16 v[118:119], v12 offset:2376
    v_mfma_f32_16x16x32_bf16 v[72:75], v[160:163], v[184:187], v[72:75]
    ds_read_b64_tr_b16 v[120:121], v10 offset:144
    ds_read_b64_tr_b16 v[122:123], v10 offset:2448
    v_mfma_f32_16x16x32_bf16 v[76:79], v[160:163], v[188:191], v[76:79]
    ds_read_b64_tr_b16 v[124:125], v12 offset:144
    v_mfma_f32_16x16x32_bf16 v[80:83], v[164:167], v[184:187], v[80:83]
    ds_read_b64_tr_b16 v[126:127], v12 offset:2448
    v_mfma_f32_16x16x32_bf16 v[84:87], v[164:167], v[188:191], v[84:87]
    ds_read_b64_tr_b16 v[128:129], v10 offset:216
    ds_read_b64_tr_b16 v[130:131], v10 offset:2520
    v_mfma_f32_16x16x32_bf16 v[88:91], v[168:171], v[184:187], v[88:91]
    ds_read_b64_tr_b16 v[132:133], v12 offset:216
    v_mfma_f32_16x16x32_bf16 v[92:95], v[168:171], v[188:191], v[92:95]
    ds_read_b64_tr_b16 v[134:135], v12 offset:2520
    v_mfma_f32_16x16x32_bf16 v[96:99], v[172:175], v[184:187], v[96:99]
    ds_read_b64_tr_b16 v[136:137], v14 offset:0
    ds_read_b64_tr_b16 v[138:139], v14 offset:2304
    v_mfma_f32_16x16x32_bf16 v[100:103], v[172:175], v[188:191], v[100:103]
    s_waitcnt lgkmcnt(12)
    v_mfma_f32_16x16x32_bf16 v[32:35], v[104:107], v[176:179], v[32:35]
    ds_read_b128 v[184:187], v17 offset:0
    ds_read_b128 v[188:191], v17 offset:2048
    v_mfma_f32_16x16x32_bf16 v[36:39], v[104:107], v[180:183], v[36:39]
    ds_read_b64_tr_b16 v[140:141], v10 offset:9216
    ds_read_b64_tr_b16 v[142:143], v10 offset:11520
    ds_read_b64_tr_b16 v[144:145], v12 offset:9216
    v_mfma_f32_16x16x32_bf16 v[40:43], v[108:111], v[176:179], v[40:43]
    ds_read_b64_tr_b16 v[146:147], v12 offset:11520
    ds_read_b64_tr_b16 v[148:149], v10 offset:9288
    v_mfma_f32_16x16x32_bf16 v[44:47], v[108:111], v[180:183], v[44:47]
    ds_read_b64_tr_b16 v[150:151], v10 offset:11592
    ds_read_b64_tr_b16 v[152:153], v12 offset:9288
    v_mfma_f32_16x16x32_bf16 v[48:51], v[112:115], v[176:179], v[48:51]
    ds_read_b64_tr_b16 v[154:155], v12 offset:11592
    ds_read_b64_tr_b16 v[156:157], v10 offset:9360
    v_mfma_f32_16x16x32_bf16 v[52:55], v[112:115], v[180:183], v[52:55]
    ds_read_b64_tr_b16 v[158:159], v10 offset:11664
    s_waitcnt lgkmcnt(14)
    v_mfma_f32_16x16x32_bf16 v[56:59], v[116:119], v[176:179], v[56:59]
    ds_read_b64_tr_b16 v[160:161], v12 offset:9360
    ds_read_b64_tr_b16 v[162:163], v12 offset:11664
    v_mfma_f32_16x16x32_bf16 v[60:63], v[116:119], v[180:183], v[60:63]
    ds_read_b64_tr_b16 v[164:165], v10 offset:9432
    ds_read_b64_tr_b16 v[166:167], v10 offset:11736
    v_mfma_f32_16x16x32_bf16 v[64:67], v[120:123], v[176:179], v[64:67]
    ds_read_b64_tr_b16 v[168:169], v12 offset:9432
    ds_read_b64_tr_b16 v[170:171], v12 offset:11736
    v_mfma_f32_16x16x32_bf16 v[68:71], v[120:123], v[180:183], v[68:71]
    ds_read_b64_tr_b16 v[172:173], v14 offset:9216
    ds_read_b64_tr_b16 v[174:175], v14 offset:11520
    v_mfma_f32_16x16x32_bf16 v[72:75], v[124:127], v[176:179], v[72:75]
    ds_read_b32 v228, v21 offset:0
    ds_read_b32 v230, v21 offset:512
    v_mfma_f32_16x16x32_bf16 v[76:79], v[124:127], v[180:183], v[76:79]
    ds_read_b32 v229, v21 offset:64
    s_waitcnt lgkmcnt(14)
    v_mfma_f32_16x16x32_bf16 v[80:83], v[128:131], v[176:179], v[80:83]
    ds_read_b32 v231, v21 offset:576
    ds_read_b128 v[192:195], v18 offset:0
    v_mfma_f32_16x16x32_bf16 v[84:87], v[128:131], v[180:183], v[84:87]
    ds_read_b128 v[196:199], v19 offset:0
    ds_read_b128 v[200:203], v18 offset:144
    v_mfma_f32_16x16x32_bf16 v[88:91], v[132:135], v[176:179], v[88:91]
    ds_read_b128 v[204:207], v19 offset:144
    ds_read_b128 v[208:211], v18 offset:288
    v_mfma_f32_16x16x32_bf16 v[92:95], v[132:135], v[180:183], v[92:95]
    ds_read_b128 v[212:215], v19 offset:288
    ds_read_b128 v[216:219], v18 offset:432
    v_mfma_f32_16x16x32_bf16 v[96:99], v[136:139], v[176:179], v[96:99]
    ds_read_b128 v[220:223], v19 offset:432
    ds_read_b128 v[224:227], v20 offset:64
    v_mfma_f32_16x16x32_bf16 v[100:103], v[136:139], v[180:183], v[100:103]
    v_mfma_f32_16x16x32_bf16 v[32:35], v[140:143], v[184:187], v[32:35]
    v_mfma_f32_16x16x32_bf16 v[36:39], v[140:143], v[188:191], v[36:39]
    v_mfma_f32_16x16x32_bf16 v[40:43], v[144:147], v[184:187], v[40:43]
    v_mfma_f32_16x16x32_bf16 v[44:47], v[144:147], v[188:191], v[44:47]
    v_mfma_f32_16x16x32_bf16 v[48:51], v[148:151], v[184:187], v[48:51]
    v_mfma_f32_16x16x32_bf16 v[52:55], v[148:151], v[188:191], v[52:55]
    s_waitcnt lgkmcnt(14)
    v_mfma_f32_16x16x32_bf16 v[56:59], v[152:155], v[184:187], v[56:59]
    v_mfma_f32_16x16x32_bf16 v[60:63], v[152:155], v[188:191], v[60:63]
    s_waitcnt lgkmcnt(0)
    v_mul_f32 v230, s50, v230
    v_mul_f32 v231, s50, v231
    v_mfma_f32_16x16x32_bf16 v[64:67], v[156:159], v[184:187], v[64:67]
    v_mfma_f32_16x16x32_bf16 v[68:71], v[156:159], v[188:191], v[68:71]
    v_mfma_f32_16x16x32_bf16 v[72:75], v[160:163], v[184:187], v[72:75]
    v_mfma_f32_16x16x32_bf16 v[76:79], v[160:163], v[188:191], v[76:79]
    v_mfma_f32_16x16x32_bf16 v[80:83], v[164:167], v[184:187], v[80:83]
    v_mfma_f32_16x16x32_bf16 v[84:87], v[164:167], v[188:191], v[84:87]
    v_mfma_f32_16x16x32_bf16 v[88:91], v[168:171], v[184:187], v[88:91]
    v_mfma_f32_16x16x32_bf16 v[92:95], v[168:171], v[188:191], v[92:95]
    v_mfma_f32_16x16x32_bf16 v[96:99], v[172:175], v[184:187], v[96:99]
    v_mfma_f32_16x16x32_bf16 v[100:103], v[172:175], v[188:191], v[100:103]
    s_nop 7
    v_pk_fma_f32 v[32:33], v[192:193], v[228:229], v[32:33] op_sel:[0,0,0] op_sel_hi:[1,0,1] neg_lo:[0,1,0] neg_hi:[0,1,0]
    v_pk_fma_f32 v[34:35], v[194:195], v[228:229], v[34:35] op_sel:[0,0,0] op_sel_hi:[1,0,1] neg_lo:[0,1,0] neg_hi:[0,1,0]
    v_pk_mul_f32 v[32:33], v[32:33], v[230:231] op_sel:[0,0] op_sel_hi:[1,0]
    v_pk_mul_f32 v[34:35], v[34:35], v[230:231] op_sel:[0,0] op_sel_hi:[1,0]
    v_cvt_pk_bf16_f32 v104, v32, v33
    v_cvt_pk_bf16_f32 v105, v34, v35
    v_pk_fma_f32 v[40:41], v[196:197], v[228:229], v[40:41] op_sel:[0,0,0] op_sel_hi:[1,0,1] neg_lo:[0,1,0] neg_hi:[0,1,0]
    v_pk_fma_f32 v[42:43], v[198:199], v[228:229], v[42:43] op_sel:[0,0,0] op_sel_hi:[1,0,1] neg_lo:[0,1,0] neg_hi:[0,1,0]
    v_pk_mul_f32 v[40:41], v[40:41], v[230:231] op_sel:[0,0] op_sel_hi:[1,0]
    v_pk_mul_f32 v[42:43], v[42:43], v[230:231] op_sel:[0,0] op_sel_hi:[1,0]
    v_cvt_pk_bf16_f32 v106, v40, v41
    v_cvt_pk_bf16_f32 v107, v42, v43
    buffer_store_dwordx4 v[104:107], v22, s[20:23], s47 offen offset:0 sc1
    v_pk_fma_f32 v[36:37], v[192:193], v[228:229], v[36:37] op_sel:[0,1,0] op_sel_hi:[1,1,1] neg_lo:[0,1,0] neg_hi:[0,1,0]
    v_pk_fma_f32 v[38:39], v[194:195], v[228:229], v[38:39] op_sel:[0,1,0] op_sel_hi:[1,1,1] neg_lo:[0,1,0] neg_hi:[0,1,0]
    v_pk_mul_f32 v[36:37], v[36:37], v[230:231] op_sel:[0,1] op_sel_hi:[1,1]
    v_pk_mul_f32 v[38:39], v[38:39], v[230:231] op_sel:[0,1] op_sel_hi:[1,1]
    v_cvt_pk_bf16_f32 v108, v36, v37
    v_cvt_pk_bf16_f32 v109, v38, v39
    v_pk_fma_f32 v[44:45], v[196:197], v[228:229], v[44:45] op_sel:[0,1,0] op_sel_hi:[1,1,1] neg_lo:[0,1,0] neg_hi:[0,1,0]
    v_pk_fma_f32 v[46:47], v[198:199], v[228:229], v[46:47] op_sel:[0,1,0] op_sel_hi:[1,1,1] neg_lo:[0,1,0] neg_hi:[0,1,0]
    v_pk_mul_f32 v[44:45], v[44:45], v[230:231] op_sel:[0,1] op_sel_hi:[1,1]
    v_pk_mul_f32 v[46:47], v[46:47], v[230:231] op_sel:[0,1] op_sel_hi:[1,1]
    v_cvt_pk_bf16_f32 v110, v44, v45
    v_cvt_pk_bf16_f32 v111, v46, v47
    buffer_store_dwordx4 v[108:111], v22, s[20:23], s47 offen offset:256 sc1
    s_add_u32 s47, s47, s46
    v_pk_fma_f32 v[48:49], v[200:201], v[228:229], v[48:49] op_sel:[0,0,0] op_sel_hi:[1,0,1] neg_lo:[0,1,0] neg_hi:[0,1,0]
    v_pk_fma_f32 v[50:51], v[202:203], v[228:229], v[50:51] op_sel:[0,0,0] op_sel_hi:[1,0,1] neg_lo:[0,1,0] neg_hi:[0,1,0]
    v_pk_mul_f32 v[48:49], v[48:49], v[230:231] op_sel:[0,0] op_sel_hi:[1,0]
    v_pk_mul_f32 v[50:51], v[50:51], v[230:231] op_sel:[0,0] op_sel_hi:[1,0]
    v_cvt_pk_bf16_f32 v112, v48, v49
    v_cvt_pk_bf16_f32 v113, v50, v51
    v_pk_fma_f32 v[56:57], v[204:205], v[228:229], v[56:57] op_sel:[0,0,0] op_sel_hi:[1,0,1] neg_lo:[0,1,0] neg_hi:[0,1,0]
    v_pk_fma_f32 v[58:59], v[206:207], v[228:229], v[58:59] op_sel:[0,0,0] op_sel_hi:[1,0,1] neg_lo:[0,1,0] neg_hi:[0,1,0]
    v_pk_mul_f32 v[56:57], v[56:57], v[230:231] op_sel:[0,0] op_sel_hi:[1,0]
    v_pk_mul_f32 v[58:59], v[58:59], v[230:231] op_sel:[0,0] op_sel_hi:[1,0]
    v_cvt_pk_bf16_f32 v114, v56, v57
    v_cvt_pk_bf16_f32 v115, v58, v59
    buffer_store_dwordx4 v[112:115], v22, s[20:23], s47 offen offset:0 sc1
    v_pk_fma_f32 v[52:53], v[200:201], v[228:229], v[52:53] op_sel:[0,1,0] op_sel_hi:[1,1,1] neg_lo:[0,1,0] neg_hi:[0,1,0]
    v_pk_fma_f32 v[54:55], v[202:203], v[228:229], v[54:55] op_sel:[0,1,0] op_sel_hi:[1,1,1] neg_lo:[0,1,0] neg_hi:[0,1,0]
    v_pk_mul_f32 v[52:53], v[52:53], v[230:231] op_sel:[0,1] op_sel_hi:[1,1]
    v_pk_mul_f32 v[54:55], v[54:55], v[230:231] op_sel:[0,1] op_sel_hi:[1,1]
    v_cvt_pk_bf16_f32 v116, v52, v53
    v_cvt_pk_bf16_f32 v117, v54, v55
    v_pk_fma_f32 v[60:61], v[204:205], v[228:229], v[60:61] op_sel:[0,1,0] op_sel_hi:[1,1,1] neg_lo:[0,1,0] neg_hi:[0,1,0]
    v_pk_fma_f32 v[62:63], v[206:207], v[228:229], v[62:63] op_sel:[0,1,0] op_sel_hi:[1,1,1] neg_lo:[0,1,0] neg_hi:[0,1,0]
    v_pk_mul_f32 v[60:61], v[60:61], v[230:231] op_sel:[0,1] op_sel_hi:[1,1]
    v_pk_mul_f32 v[62:63], v[62:63], v[230:231] op_sel:[0,1] op_sel_hi:[1,1]
    v_cvt_pk_bf16_f32 v118, v60, v61
    v_cvt_pk_bf16_f32 v119, v62, v63
    buffer_store_dwordx4 v[116:119], v22, s[20:23], s47 offen offset:256 sc1
    s_add_u32 s47, s47, s46
    v_pk_fma_f32 v[64:65], v[208:209], v[228:229], v[64:65] op_sel:[0,0,0] op_sel_hi:[1,0,1] neg_lo:[0,1,0] neg_hi:[0,1,0]
    v_pk_fma_f32 v[66:67], v[210:211], v[228:229], v[66:67] op_sel:[0,0,0] op_sel_hi:[1,0,1] neg_lo:[0,1,0] neg_hi:[0,1,0]
    v_pk_mul_f32 v[64:65], v[64:65], v[230:231] op_sel:[0,0] op_sel_hi:[1,0]
    v_pk_mul_f32 v[66:67], v[66:67], v[230:231] op_sel:[0,0] op_sel_hi:[1,0]
    v_cvt_pk_bf16_f32 v120, v64, v65
    v_cvt_pk_bf16_f32 v121, v66, v67
    v_pk_fma_f32 v[72:73], v[212:213], v[228:229], v[72:73] op_sel:[0,0,0] op_sel_hi:[1,0,1] neg_lo:[0,1,0] neg_hi:[0,1,0]
    v_pk_fma_f32 v[74:75], v[214:215], v[228:229], v[74:75] op_sel:[0,0,0] op_sel_hi:[1,0,1] neg_lo:[0,1,0] neg_hi:[0,1,0]
    v_pk_mul_f32 v[72:73], v[72:73], v[230:231] op_sel:[0,0] op_sel_hi:[1,0]
    v_pk_mul_f32 v[74:75], v[74:75], v[230:231] op_sel:[0,0] op_sel_hi:[1,0]
    v_cvt_pk_bf16_f32 v122, v72, v73
    v_cvt_pk_bf16_f32 v123, v74, v75
    buffer_store_dwordx4 v[120:123], v22, s[20:23], s47 offen offset:0 sc1
    v_pk_fma_f32 v[68:69], v[208:209], v[228:229], v[68:69] op_sel:[0,1,0] op_sel_hi:[1,1,1] neg_lo:[0,1,0] neg_hi:[0,1,0]
    v_pk_fma_f32 v[70:71], v[210:211], v[228:229], v[70:71] op_sel:[0,1,0] op_sel_hi:[1,1,1] neg_lo:[0,1,0] neg_hi:[0,1,0]
    v_pk_mul_f32 v[68:69], v[68:69], v[230:231] op_sel:[0,1] op_sel_hi:[1,1]
    v_pk_mul_f32 v[70:71], v[70:71], v[230:231] op_sel:[0,1] op_sel_hi:[1,1]
    v_cvt_pk_bf16_f32 v124, v68, v69
    v_cvt_pk_bf16_f32 v125, v70, v71
    v_pk_fma_f32 v[76:77], v[212:213], v[228:229], v[76:77] op_sel:[0,1,0] op_sel_hi:[1,1,1] neg_lo:[0,1,0] neg_hi:[0,1,0]
    v_pk_fma_f32 v[78:79], v[214:215], v[228:229], v[78:79] op_sel:[0,1,0] op_sel_hi:[1,1,1] neg_lo:[0,1,0] neg_hi:[0,1,0]
    v_pk_mul_f32 v[76:77], v[76:77], v[230:231] op_sel:[0,1] op_sel_hi:[1,1]
    v_pk_mul_f32 v[78:79], v[78:79], v[230:231] op_sel:[0,1] op_sel_hi:[1,1]
    v_cvt_pk_bf16_f32 v126, v76, v77
    v_cvt_pk_bf16_f32 v127, v78, v79
    buffer_store_dwordx4 v[124:127], v22, s[20:23], s47 offen offset:256 sc1
    s_add_u32 s47, s47, s46
    v_pk_fma_f32 v[80:81], v[216:217], v[228:229], v[80:81] op_sel:[0,0,0] op_sel_hi:[1,0,1] neg_lo:[0,1,0] neg_hi:[0,1,0]
    v_pk_fma_f32 v[82:83], v[218:219], v[228:229], v[82:83] op_sel:[0,0,0] op_sel_hi:[1,0,1] neg_lo:[0,1,0] neg_hi:[0,1,0]
    v_pk_mul_f32 v[80:81], v[80:81], v[230:231] op_sel:[0,0] op_sel_hi:[1,0]
    v_pk_mul_f32 v[82:83], v[82:83], v[230:231] op_sel:[0,0] op_sel_hi:[1,0]
    v_cvt_pk_bf16_f32 v128, v80, v81
    v_cvt_pk_bf16_f32 v129, v82, v83
    v_pk_fma_f32 v[88:89], v[220:221], v[228:229], v[88:89] op_sel:[0,0,0] op_sel_hi:[1,0,1] neg_lo:[0,1,0] neg_hi:[0,1,0]
    v_pk_fma_f32 v[90:91], v[222:223], v[228:229], v[90:91] op_sel:[0,0,0] op_sel_hi:[1,0,1] neg_lo:[0,1,0] neg_hi:[0,1,0]
    v_pk_mul_f32 v[88:89], v[88:89], v[230:231] op_sel:[0,0] op_sel_hi:[1,0]
    v_pk_mul_f32 v[90:91], v[90:91], v[230:231] op_sel:[0,0] op_sel_hi:[1,0]
    v_cvt_pk_bf16_f32 v130, v88, v89
    v_cvt_pk_bf16_f32 v131, v90, v91
    buffer_store_dwordx4 v[128:131], v22, s[20:23], s47 offen offset:0 sc1
    v_pk_fma_f32 v[84:85], v[216:217], v[228:229], v[84:85] op_sel:[0,1,0] op_sel_hi:[1,1,1] neg_lo:[0,1,0] neg_hi:[0,1,0]
    v_pk_fma_f32 v[86:87], v[218:219], v[228:229], v[86:87] op_sel:[0,1,0] op_sel_hi:[1,1,1] neg_lo:[0,1,0] neg_hi:[0,1,0]
    v_pk_mul_f32 v[84:85], v[84:85], v[230:231] op_sel:[0,1] op_sel_hi:[1,1]
    v_pk_mul_f32 v[86:87], v[86:87], v[230:231] op_sel:[0,1] op_sel_hi:[1,1]
    v_cvt_pk_bf16_f32 v132, v84, v85
    v_cvt_pk_bf16_f32 v133, v86, v87
    v_pk_fma_f32 v[92:93], v[220:221], v[228:229], v[92:93] op_sel:[0,1,0] op_sel_hi:[1,1,1] neg_lo:[0,1,0] neg_hi:[0,1,0]
    v_pk_fma_f32 v[94:95], v[222:223], v[228:229], v[94:95] op_sel:[0,1,0] op_sel_hi:[1,1,1] neg_lo:[0,1,0] neg_hi:[0,1,0]
    v_pk_mul_f32 v[92:93], v[92:93], v[230:231] op_sel:[0,1] op_sel_hi:[1,1]
    v_pk_mul_f32 v[94:95], v[94:95], v[230:231] op_sel:[0,1] op_sel_hi:[1,1]
    v_cvt_pk_bf16_f32 v134, v92, v93
    v_cvt_pk_bf16_f32 v135, v94, v95
    buffer_store_dwordx4 v[132:135], v22, s[20:23], s47 offen offset:256 sc1
    s_add_u32 s47, s47, s46
    v_pk_fma_f32 v[96:97], v[224:225], v[228:229], v[96:97] op_sel:[0,0,0] op_sel_hi:[1,0,1] neg_lo:[0,1,0] neg_hi:[0,1,0]
    v_pk_fma_f32 v[98:99], v[226:227], v[228:229], v[98:99] op_sel:[0,0,0] op_sel_hi:[1,0,1] neg_lo:[0,1,0] neg_hi:[0,1,0]
    v_pk_mul_f32 v[96:97], v[96:97], v[230:231] op_sel:[0,0] op_sel_hi:[1,0]
    v_pk_mul_f32 v[98:99], v[98:99], v[230:231] op_sel:[0,0] op_sel_hi:[1,0]
    v_cvt_pk_bf16_f32 v136, v96, v97
    v_cvt_pk_bf16_f32 v137, v98, v99
    v_pk_fma_f32 v[100:101], v[224:225], v[228:229], v[100:101] op_sel:[0,1,0] op_sel_hi:[1,1,1] neg_lo:[0,1,0] neg_hi:[0,1,0]
    v_pk_fma_f32 v[102:103], v[226:227], v[228:229], v[102:103] op_sel:[0,1,0] op_sel_hi:[1,1,1] neg_lo:[0,1,0] neg_hi:[0,1,0]
    v_pk_mul_f32 v[100:101], v[100:101], v[230:231] op_sel:[0,1] op_sel_hi:[1,1]
    v_pk_mul_f32 v[102:103], v[102:103], v[230:231] op_sel:[0,1] op_sel_hi:[1,1]
    v_cvt_pk_bf16_f32 v138, v100, v101
    v_cvt_pk_bf16_f32 v139, v102, v103
    s_nop 1
    v_permlane16_swap_b32 v136, v138
    v_permlane16_swap_b32 v137, v139
    buffer_store_dword v136, v23, s[20:23], s49 offen sc1
    s_add_u32 s49, s49, s48
    buffer_store_dword v137, v23, s[20:23], s49 offen sc1
    s_add_u32 s49, s49, s48
    buffer_store_dword v138, v23, s[20:23], s49 offen sc1
    s_add_u32 s49, s49, s48
    buffer_store_dword v139, v23, s[20:23], s49 offen sc1
    s_branch A_JOIN
A_V:
    v_lshl_add_u32 v10, v5, 3, v6
    v_add_u32 v11, 36864, v10
    v_lshrrev_b32 v7, 1, v4
    v_and_b32 v8, 1, v4
    v_lshl_add_u32 v18, v4, 4, s38
    v_lshlrev_b32 v21, 2, v3
    v_add_u32 v21, 139264, v21
    v_mul_u32_u24 v19, 608, v7
    v_mul_u32_u24 v20, 304, v8
    s_mul_i32 s51, s34, 1216
    v_add3_u32 v19, v19, v20, s51
    v_add_u32 v24, 0, v3
    v_mul_u32_u24 v25, 0xe38f, v24
    v_lshrrev_b32 v25, 20, v25
    v_mul_u32_u24 v26, 18, v25
    v_sub_u32 v26, v24, v26
    v_mul_u32_u24 v25, 4864, v25
    v_lshl_add_u32 v25, v26, 4, v25
    v_add_u32 v204, v25, v19
    v_add_u32 v24, 16, v3
    v_mul_u32_u24 v25, 0xe38f, v24
    v_lshrrev_b32 v25, 20, v25
    v_mul_u32_u24 v26, 18, v25
    v_sub_u32 v26, v24, v26
    v_mul_u32_u24 v25, 4864, v25
    v_lshl_add_u32 v25, v26, 4, v25
    v_add_u32 v205, v25, v19
    v_add_u32 v24, 32, v3
    v_mul_u32_u24 v25, 0xe38f, v24
    v_lshrrev_b32 v25, 20, v25
    v_mul_u32_u24 v26, 18, v25
    v_sub_u32 v26, v24, v26
    v_mul_u32_u24 v25, 4864, v25
    v_lshl_add_u32 v25, v26, 4, v25
    v_add_u32 v206, v25, v19
    v_add_u32 v24, 48, v3
    v_mul_u32_u24 v25, 0xe38f, v24
    v_lshrrev_b32 v25, 20, v25
    v_mul_u32_u24 v26, 18, v25
    v_sub_u32 v26, v24, v26
    v_mul_u32_u24 v25, 4864, v25
    v_lshl_add_u32 v25, v26, 4, v25
    v_add_u32 v207, v25, v19
    v_add_u32 v24, 64, v3
    v_mul_u32_u24 v25, 0xe38f, v24
    v_lshrrev_b32 v25, 20, v25
    v_mul_u32_u24 v26, 18, v25
    v_sub_u32 v26, v24, v26
    v_mul_u32_u24 v25, 4864, v25
    v_lshl_add_u32 v25, v26, 4, v25
    v_add_u32 v208, v25, v19
    v_add_u32 v24, 80, v3
    v_mul_u32_u24 v25, 0xe38f, v24
    v_lshrrev_b32 v25, 20, v25
    v_mul_u32_u24 v26, 18, v25
    v_sub_u32 v26, v24, v26
    v_mul_u32_u24 v25, 4864, v25
    v_lshl_add_u32 v25, v26, 4, v25
    v_add_u32 v209, v25, v19
    v_add_u32 v24, 96, v3
    v_mul_u32_u24 v25, 0xe38f, v24
    v_lshrrev_b32 v25, 20, v25
    v_mul_u32_u24 v26, 18, v25
    v_sub_u32 v26, v24, v26
    v_mul_u32_u24 v25, 4864, v25
    v_lshl_add_u32 v25, v26, 4, v25
    v_add_u32 v210, v25, v19
    v_add_u32 v24, 112, v3
    v_mul_u32_u24 v25, 0xe38f, v24
    v_lshrrev_b32 v25, 20, v25
    v_mul_u32_u24 v26, 18, v25
    v_sub_u32 v26, v24, v26
    v_mul_u32_u24 v25, 4864, v25
    v_lshl_add_u32 v25, v26, 4, v25
    v_add_u32 v211, v25, v19
    v_add_u32 v24, 128, v3
    v_mul_u32_u24 v25, 0xe38f, v24
    v_lshrrev_b32 v25, 20, v25
    v_mul_u32_u24 v26, 18, v25
    v_sub_u32 v26, v24, v26
    v_mul_u32_u24 v25, 4864, v25
    v_lshl_add_u32 v25, v26, 4, v25
    v_add_u32 v212, v25, v19
    v_and_b32 v25, 7, v3
    v_mul_u32_u24 v25, 4864, v25
    v_add_u32 v213, v25, v19
    v_mov_b32 v24, 0x3f803f80
    v_mov_b32 v25, 0x3f803f80
    v_mov_b32 v26, 0x3f803f80
    v_mov_b32 v27, 0x3f803f80
    s_barrier
    ds_read_b128 v[176:179], v16 offset:0
    ds_read_b128 v[180:183], v16 offset:2048
    ds_read_b64_tr_b16 v[104:105], v10 offset:0
    ds_read_b64_tr_b16 v[106:107], v10 offset:2304
    ds_read_b64_tr_b16 v[108:109], v10 offset:32
    ds_read_b64_tr_b16 v[110:111], v10 offset:2336
    ds_read_b64_tr_b16 v[112:113], v10 offset:64
    ds_read_b64_tr_b16 v[114:115], v10 offset:2368
    ds_read_b64_tr_b16 v[116:117], v10 offset:96
    ds_read_b64_tr_b16 v[118:119], v10 offset:2400
    ds_read_b64_tr_b16 v[120:121], v10 offset:128
    ds_read_b64_tr_b16 v[122:123], v10 offset:2432
    ds_read_b64_tr_b16 v[124:125], v10 offset:160
    ds_read_b64_tr_b16 v[126:127], v10 offset:2464
    ds_read_b64_tr_b16 v[128:129], v10 offset:192
    ds_read_b64_tr_b16 v[130:131], v10 offset:2496
    ds_read_b64_tr_b16 v[132:133], v10 offset:224
    ds_read_b64_tr_b16 v[134:135], v10 offset:2528
    ds_read_b64_tr_b16 v[136:137], v10 offset:256
    ds_read_b64_tr_b16 v[138:139], v10 offset:2560
    s_waitcnt lgkmcnt(12)
    v_mfma_f32_16x16x32_bf16 v[32:35], v[176:179], v[104:107], 0
    ds_read_b128 v[184:187], v17 offset:0
    v_mfma_f32_16x16x32_bf16 v[36:39], v[180:183], v[104:107], 0
    ds_read_b128 v[188:191], v17 offset:2048
    ds_read_b64_tr_b16 v[140:141], v10 offset:9216
    v_mfma_f32_16x16x32_bf16 v[40:43], v[176:179], v[108:111], 0
    ds_read_b64_tr_b16 v[142:143], v10 offset:11520
    v_mfma_f32_16x16x32_bf16 v[44:47], v[180:183], v[108:111], 0
    ds_read_b64_tr_b16 v[144:145], v10 offset:9248
    v_mfma_f32_16x16x32_bf16 v[48:51], v[176:179], v[112:115], 0
    ds_read_b64_tr_b16 v[146:147], v10 offset:11552
    ds_read_b64_tr_b16 v[148:149], v10 offset:9280
    v_mfma_f32_16x16x32_bf16 v[52:55], v[180:183], v[112:115], 0
    ds_read_b64_tr_b16 v[150:151], v10 offset:11584
    s_waitcnt lgkmcnt(14)
    v_mfma_f32_16x16x32_bf16 v[56:59], v[176:179], v[116:119], 0
    ds_read_b64_tr_b16 v[152:153], v10 offset:9312
    v_mfma_f32_16x16x32_bf16 v[60:63], v[180:183], v[116:119], 0
    ds_read_b64_tr_b16 v[154:155], v10 offset:11616
    ds_read_b64_tr_b16 v[156:157], v10 offset:9344
    v_mfma_f32_16x16x32_bf16 v[64:67], v[176:179], v[120:123], 0
    ds_read_b64_tr_b16 v[158:159], v10 offset:11648
    v_mfma_f32_16x16x32_bf16 v[68:71], v[180:183], v[120:123], 0
    ds_read_b64_tr_b16 v[160:161], v10 offset:9376
    v_mfma_f32_16x16x32_bf16 v[72:75], v[176:179], v[124:127], 0
    ds_read_b64_tr_b16 v[162:163], v10 offset:11680
    v_mfma_f32_16x16x32_bf16 v[76:79], v[180:183], v[124:127], 0
    ds_read_b64_tr_b16 v[164:165], v10 offset:9408
    s_waitcnt lgkmcnt(14)
    v_mfma_f32_16x16x32_bf16 v[80:83], v[176:179], v[128:131], 0
    ds_read_b64_tr_b16 v[166:167], v10 offset:11712
    v_mfma_f32_16x16x32_bf16 v[84:87], v[180:183], v[128:131], 0
    ds_read_b64_tr_b16 v[168:169], v10 offset:9440
    v_mfma_f32_16x16x32_bf16 v[88:91], v[176:179], v[132:135], 0
    ds_read_b64_tr_b16 v[170:171], v10 offset:11744
    v_mfma_f32_16x16x32_bf16 v[92:95], v[180:183], v[132:135], 0
    ds_read_b64_tr_b16 v[172:173], v10 offset:9472
    v_mfma_f32_16x16x32_bf16 v[96:99], v[176:179], v[136:139], 0
    ds_read_b64_tr_b16 v[174:175], v10 offset:11776
    v_mfma_f32_16x16x32_bf16 v[100:103], v[180:183], v[136:139], 0
    s_waitcnt lgkmcnt(12)
    v_mfma_f32_16x16x32_bf16 v[32:35], v[184:187], v[140:143], v[32:35]
    v_mfma_f32_16x16x32_bf16 v[36:39], v[188:191], v[140:143], v[36:39]
    v_mfma_f32_16x16x32_bf16 v[40:43], v[184:187], v[144:147], v[40:43]
    v_mfma_f32_16x16x32_bf16 v[44:47], v[188:191], v[144:147], v[44:47]
    s_waitcnt lgkmcnt(0)
    s_barrier
    ds_read_b128 v[176:179], v16 offset:16384
    v_mfma_f32_16x16x32_bf16 v[48:51], v[184:187], v[148:151], v[48:51]
    ds_read_b128 v[180:183], v16 offset:18432
    ds_read_b64_tr_b16 v[104:105], v10 offset:18432
    v_mfma_f32_16x16x32_bf16 v[52:55], v[188:191], v[148:151], v[52:55]
    ds_read_b64_tr_b16 v[106:107], v10 offset:20736
    ds_read_b64_tr_b16 v[108:109], v10 offset:18464
    v_mfma_f32_16x16x32_bf16 v[56:59], v[184:187], v[152:155], v[56:59]
    ds_read_b64_tr_b16 v[110:111], v10 offset:20768
    v_mfma_f32_16x16x32_bf16 v[60:63], v[188:191], v[152:155], v[60:63]
    ds_read_b64_tr_b16 v[112:113], v10 offset:18496
    ds_read_b64_tr_b16 v[114:115], v10 offset:20800
    v_mfma_f32_16x16x32_bf16 v[64:67], v[184:187], v[156:159], v[64:67]
    ds_read_b64_tr_b16 v[116:117], v10 offset:18528
    v_mfma_f32_16x16x32_bf16 v[68:71], v[188:191], v[156:159], v[68:71]
    ds_read_b64_tr_b16 v[118:119], v10 offset:20832
    v_mfma_f32_16x16x32_bf16 v[72:75], v[184:187], v[160:163], v[72:75]
    ds_read_b64_tr_b16 v[120:121], v10 offset:18560
    ds_read_b64_tr_b16 v[122:123], v10 offset:20864
    v_mfma_f32_16x16x32_bf16 v[76:79], v[188:191], v[160:163], v[76:79]
    ds_read_b64_tr_b16 v[124:125], v10 offset:18592
    v_mfma_f32_16x16x32_bf16 v[80:83], v[184:187], v[164:167], v[80:83]
    ds_read_b64_tr_b16 v[126:127], v10 offset:20896
    v_mfma_f32_16x16x32_bf16 v[84:87], v[188:191], v[164:167], v[84:87]
    ds_read_b64_tr_b16 v[128:129], v10 offset:18624
    ds_read_b64_tr_b16 v[130:131], v10 offset:20928
    v_mfma_f32_16x16x32_bf16 v[88:91], v[184:187], v[168:171], v[88:91]
    ds_read_b64_tr_b16 v[132:133], v10 offset:18656
    v_mfma_f32_16x16x32_bf16 v[92:95], v[188:191], v[168:171], v[92:95]
    ds_read_b64_tr_b16 v[134:135], v10 offset:20960
    v_mfma_f32_16x16x32_bf16 v[96:99], v[184:187], v[172:175], v[96:99]
    ds_read_b64_tr_b16 v[136:137], v10 offset:18688
    ds_read_b64_tr_b16 v[138:139], v10 offset:20992
    v_mfma_f32_16x16x32_bf16 v[100:103], v[188:191], v[172:175], v[100:103]
    s_waitcnt lgkmcnt(12)
    v_mfma_f32_16x16x32_bf16 v[32:35], v[176:179], v[104:107], v[32:35]
    ds_read_b128 v[184:187], v17 offset:16384
    v_mfma_f32_16x16x32_bf16 v[36:39], v[180:183], v[104:107], v[36:39]
    ds_read_b128 v[188:191], v17 offset:18432
    ds_read_b64_tr_b16 v[140:141], v10 offset:27648
    v_mfma_f32_16x16x32_bf16 v[40:43], v[176:179], v[108:111], v[40:43]
    ds_read_b64_tr_b16 v[142:143], v10 offset:29952
    v_mfma_f32_16x16x32_bf16 v[44:47], v[180:183], v[108:111], v[44:47]
    ds_read_b64_tr_b16 v[144:145], v10 offset:27680
    v_mfma_f32_16x16x32_bf16 v[48:51], v[176:179], v[112:115], v[48:51]
    ds_read_b64_tr_b16 v[146:147], v10 offset:29984
    ds_read_b64_tr_b16 v[148:149], v10 offset:27712
    v_mfma_f32_16x16x32_bf16 v[52:55], v[180:183], v[112:115], v[52:55]
    ds_read_b64_tr_b16 v[150:151], v10 offset:30016
    s_waitcnt lgkmcnt(14)
    v_mfma_f32_16x16x32_bf16 v[56:59], v[176:179], v[116:119], v[56:59]
    ds_read_b64_tr_b16 v[152:153], v10 offset:27744
    v_mfma_f32_16x16x32_bf16 v[60:63], v[180:183], v[116:119], v[60:63]
    ds_read_b64_tr_b16 v[154:155], v10 offset:30048
    ds_read_b64_tr_b16 v[156:157], v10 offset:27776
    v_mfma_f32_16x16x32_bf16 v[64:67], v[176:179], v[120:123], v[64:67]
    ds_read_b64_tr_b16 v[158:159], v10 offset:30080
    v_mfma_f32_16x16x32_bf16 v[68:71], v[180:183], v[120:123], v[68:71]
    ds_read_b64_tr_b16 v[160:161], v10 offset:27808
    v_mfma_f32_16x16x32_bf16 v[72:75], v[176:179], v[124:127], v[72:75]
    ds_read_b64_tr_b16 v[162:163], v10 offset:30112
    v_mfma_f32_16x16x32_bf16 v[76:79], v[180:183], v[124:127], v[76:79]
    ds_read_b64_tr_b16 v[164:165], v10 offset:27840
    s_waitcnt lgkmcnt(14)
    v_mfma_f32_16x16x32_bf16 v[80:83], v[176:179], v[128:131], v[80:83]
    ds_read_b64_tr_b16 v[166:167], v10 offset:30144
    v_mfma_f32_16x16x32_bf16 v[84:87], v[180:183], v[128:131], v[84:87]
    ds_read_b64_tr_b16 v[168:169], v10 offset:27872
    v_mfma_f32_16x16x32_bf16 v[88:91], v[176:179], v[132:135], v[88:91]
    ds_read_b64_tr_b16 v[170:171], v10 offset:30176
    v_mfma_f32_16x16x32_bf16 v[92:95], v[180:183], v[132:135], v[92:95]
    ds_read_b64_tr_b16 v[172:173], v10 offset:27904
    v_mfma_f32_16x16x32_bf16 v[96:99], v[176:179], v[136:139], v[96:99]
    ds_read_b64_tr_b16 v[174:175], v10 offset:30208
    v_mfma_f32_16x16x32_bf16 v[100:103], v[180:183], v[136:139], v[100:103]
    s_waitcnt lgkmcnt(12)
    v_mfma_f32_16x16x32_bf16 v[32:35], v[184:187], v[140:143], v[32:35]
    v_mfma_f32_16x16x32_bf16 v[36:39], v[188:191], v[140:143], v[36:39]
    v_mfma_f32_16x16x32_bf16 v[40:43], v[184:187], v[144:147], v[40:43]
    v_mfma_f32_16x16x32_bf16 v[44:47], v[188:191], v[144:147], v[44:47]
    s_waitcnt lgkmcnt(0)
    s_barrier
    ds_read_b128 v[176:179], v16 offset:32768
    v_mfma_f32_16x16x32_bf16 v[48:51], v[184:187], v[148:151], v[48:51]
    ds_read_b128 v[180:183], v16 offset:34816
    ds_read_b64_tr_b16 v[104:105], v10 offset:36864
    v_mfma_f32_16x16x32_bf16 v[52:55], v[188:191], v[148:151], v[52:55]
    ds_read_b64_tr_b16 v[106:107], v10 offset:39168
    ds_read_b64_tr_b16 v[108:109], v10 offset:36896
    v_mfma_f32_16x16x32_bf16 v[56:59], v[184:187], v[152:155], v[56:59]
    ds_read_b64_tr_b16 v[110:111], v10 offset:39200
    v_mfma_f32_16x16x32_bf16 v[60:63], v[188:191], v[152:155], v[60:63]
    ds_read_b64_tr_b16 v[112:113], v10 offset:36928
    ds_read_b64_tr_b16 v[114:115], v10 offset:39232
    v_mfma_f32_16x16x32_bf16 v[64:67], v[184:187], v[156:159], v[64:67]
    ds_read_b64_tr_b16 v[116:117], v10 offset:36960
    v_mfma_f32_16x16x32_bf16 v[68:71], v[188:191], v[156:159], v[68:71]
    ds_read_b64_tr_b16 v[118:119], v10 offset:39264
    v_mfma_f32_16x16x32_bf16 v[72:75], v[184:187], v[160:163], v[72:75]
    ds_read_b64_tr_b16 v[120:121], v10 offset:36992
    ds_read_b64_tr_b16 v[122:123], v10 offset:39296
    v_mfma_f32_16x16x32_bf16 v[76:79], v[188:191], v[160:163], v[76:79]
    ds_read_b64_tr_b16 v[124:125], v10 offset:37024
    v_mfma_f32_16x16x32_bf16 v[80:83], v[184:187], v[164:167], v[80:83]
    ds_read_b64_tr_b16 v[126:127], v10 offset:39328
    v_mfma_f32_16x16x32_bf16 v[84:87], v[188:191], v[164:167], v[84:87]
    ds_read_b64_tr_b16 v[128:129], v10 offset:37056
    ds_read_b64_tr_b16 v[130:131], v10 offset:39360
    v_mfma_f32_16x16x32_bf16 v[88:91], v[184:187], v[168:171], v[88:91]
    ds_read_b64_tr_b16 v[132:133], v10 offset:37088
    v_mfma_f32_16x16x32_bf16 v[92:95], v[188:191], v[168:171], v[92:95]
    ds_read_b64_tr_b16 v[134:135], v10 offset:39392
    v_mfma_f32_16x16x32_bf16 v[96:99], v[184:187], v[172:175], v[96:99]
    ds_read_b64_tr_b16 v[136:137], v10 offset:37120
    ds_read_b64_tr_b16 v[138:139], v10 offset:39424
    v_mfma_f32_16x16x32_bf16 v[100:103], v[188:191], v[172:175], v[100:103]
    s_waitcnt lgkmcnt(12)
    v_mfma_f32_16x16x32_bf16 v[32:35], v[176:179], v[104:107], v[32:35]
    ds_read_b128 v[184:187], v17 offset:32768
    v_mfma_f32_16x16x32_bf16 v[36:39], v[180:183], v[104:107], v[36:39]
    ds_read_b128 v[188:191], v17 offset:34816
    ds_read_b64_tr_b16 v[140:141], v10 offset:46080
    v_mfma_f32_16x16x32_bf16 v[40:43], v[176:179], v[108:111], v[40:43]
    ds_read_b64_tr_b16 v[142:143], v10 offset:48384
    v_mfma_f32_16x16x32_bf16 v[44:47], v[180:183], v[108:111], v[44:47]
    ds_read_b64_tr_b16 v[144:145], v10 offset:46112
    v_mfma_f32_16x16x32_bf16 v[48:51], v[176:179], v[112:115], v[48:51]
    ds_read_b64_tr_b16 v[146:147], v10 offset:48416
    ds_read_b64_tr_b16 v[148:149], v10 offset:46144
    v_mfma_f32_16x16x32_bf16 v[52:55], v[180:183], v[112:115], v[52:55]
    ds_read_b64_tr_b16 v[150:151], v10 offset:48448
    s_waitcnt lgkmcnt(14)
    v_mfma_f32_16x16x32_bf16 v[56:59], v[176:179], v[116:119], v[56:59]
    ds_read_b64_tr_b16 v[152:153], v10 offset:46176
    v_mfma_f32_16x16x32_bf16 v[60:63], v[180:183], v[116:119], v[60:63]
    ds_read_b64_tr_b16 v[154:155], v10 offset:48480
    ds_read_b64_tr_b16 v[156:157], v10 offset:46208
    v_mfma_f32_16x16x32_bf16 v[64:67], v[176:179], v[120:123], v[64:67]
    ds_read_b64_tr_b16 v[158:159], v10 offset:48512
    v_mfma_f32_16x16x32_bf16 v[68:71], v[180:183], v[120:123], v[68:71]
    ds_read_b64_tr_b16 v[160:161], v10 offset:46240
    v_mfma_f32_16x16x32_bf16 v[72:75], v[176:179], v[124:127], v[72:75]
    ds_read_b64_tr_b16 v[162:163], v10 offset:48544
    v_mfma_f32_16x16x32_bf16 v[76:79], v[180:183], v[124:127], v[76:79]
    ds_read_b64_tr_b16 v[164:165], v10 offset:46272
    s_waitcnt lgkmcnt(14)
    v_mfma_f32_16x16x32_bf16 v[80:83], v[176:179], v[128:131], v[80:83]
    ds_read_b64_tr_b16 v[166:167], v10 offset:48576
    v_mfma_f32_16x16x32_bf16 v[84:87], v[180:183], v[128:131], v[84:87]
    ds_read_b64_tr_b16 v[168:169], v10 offset:46304
    v_mfma_f32_16x16x32_bf16 v[88:91], v[176:179], v[132:135], v[88:91]
    ds_read_b64_tr_b16 v[170:171], v10 offset:48608
    v_mfma_f32_16x16x32_bf16 v[92:95], v[180:183], v[132:135], v[92:95]
    ds_read_b64_tr_b16 v[172:173], v10 offset:46336
    v_mfma_f32_16x16x32_bf16 v[96:99], v[176:179], v[136:139], v[96:99]
    ds_read_b64_tr_b16 v[174:175], v10 offset:48640
    v_mfma_f32_16x16x32_bf16 v[100:103], v[180:183], v[136:139], v[100:103]
    s_waitcnt lgkmcnt(12)
    v_mfma_f32_16x16x32_bf16 v[32:35], v[184:187], v[140:143], v[32:35]
    v_mfma_f32_16x16x32_bf16 v[36:39], v[188:191], v[140:143], v[36:39]
    v_mfma_f32_16x16x32_bf16 v[40:43], v[184:187], v[144:147], v[40:43]
    v_mfma_f32_16x16x32_bf16 v[44:47], v[188:191], v[144:147], v[44:47]
    s_waitcnt lgkmcnt(0)
    s_barrier
    ds_read_b128 v[176:179], v16 offset:49152
    v_mfma_f32_16x16x32_bf16 v[48:51], v[184:187], v[148:151], v[48:51]
    ds_read_b128 v[180:183], v16 offset:51200
    ds_read_b64_tr_b16 v[104:105], v10 offset:55296
    v_mfma_f32_16x16x32_bf16 v[52:55], v[188:191], v[148:151], v[52:55]
    ds_read_b64_tr_b16 v[106:107], v10 offset:57600
    ds_read_b64_tr_b16 v[108:109], v10 offset:55328
    v_mfma_f32_16x16x32_bf16 v[56:59], v[184:187], v[152:155], v[56:59]
    ds_read_b64_tr_b16 v[110:111], v10 offset:57632
    v_mfma_f32_16x16x32_bf16 v[60:63], v[188:191], v[152:155], v[60:63]
    ds_read_b64_tr_b16 v[112:113], v10 offset:55360
    ds_read_b64_tr_b16 v[114:115], v10 offset:57664
    v_mfma_f32_16x16x32_bf16 v[64:67], v[184:187], v[156:159], v[64:67]
    ds_read_b64_tr_b16 v[116:117], v10 offset:55392
    v_mfma_f32_16x16x32_bf16 v[68:71], v[188:191], v[156:159], v[68:71]
    ds_read_b64_tr_b16 v[118:119], v10 offset:57696
    v_mfma_f32_16x16x32_bf16 v[72:75], v[184:187], v[160:163], v[72:75]
    ds_read_b64_tr_b16 v[120:121], v10 offset:55424
    ds_read_b64_tr_b16 v[122:123], v10 offset:57728
    v_mfma_f32_16x16x32_bf16 v[76:79], v[188:191], v[160:163], v[76:79]
    ds_read_b64_tr_b16 v[124:125], v10 offset:55456
    v_mfma_f32_16x16x32_bf16 v[80:83], v[184:187], v[164:167], v[80:83]
    ds_read_b64_tr_b16 v[126:127], v10 offset:57760
    v_mfma_f32_16x16x32_bf16 v[84:87], v[188:191], v[164:167], v[84:87]
    ds_read_b64_tr_b16 v[128:129], v10 offset:55488
    ds_read_b64_tr_b16 v[130:131], v10 offset:57792
    v_mfma_f32_16x16x32_bf16 v[88:91], v[184:187], v[168:171], v[88:91]
    ds_read_b64_tr_b16 v[132:133], v10 offset:55520
    v_mfma_f32_16x16x32_bf16 v[92:95], v[188:191], v[168:171], v[92:95]
    ds_read_b64_tr_b16 v[134:135], v10 offset:57824
    v_mfma_f32_16x16x32_bf16 v[96:99], v[184:187], v[172:175], v[96:99]
    ds_read_b64_tr_b16 v[136:137], v10 offset:55552
    ds_read_b64_tr_b16 v[138:139], v10 offset:57856
    v_mfma_f32_16x16x32_bf16 v[100:103], v[188:191], v[172:175], v[100:103]
    s_waitcnt lgkmcnt(12)
    v_mfma_f32_16x16x32_bf16 v[32:35], v[176:179], v[104:107], v[32:35]
    ds_read_b128 v[184:187], v17 offset:49152
    v_mfma_f32_16x16x32_bf16 v[36:39], v[180:183], v[104:107], v[36:39]
    ds_read_b128 v[188:191], v17 offset:51200
    ds_read_b64_tr_b16 v[140:141], v10 offset:64512
    v_mfma_f32_16x16x32_bf16 v[40:43], v[176:179], v[108:111], v[40:43]
    ds_read_b64_tr_b16 v[142:143], v11 offset:29952
    v_mfma_f32_16x16x32_bf16 v[44:47], v[180:183], v[108:111], v[44:47]
    ds_read_b64_tr_b16 v[144:145], v10 offset:64544
    v_mfma_f32_16x16x32_bf16 v[48:51], v[176:179], v[112:115], v[48:51]
    ds_read_b64_tr_b16 v[146:147], v11 offset:29984
    ds_read_b64_tr_b16 v[148:149], v10 offset:64576
    v_mfma_f32_16x16x32_bf16 v[52:55], v[180:183], v[112:115], v[52:55]
    ds_read_b64_tr_b16 v[150:151], v11 offset:30016
    s_waitcnt lgkmcnt(14)
    v_mfma_f32_16x16x32_bf16 v[56:59], v[176:179], v[116:119], v[56:59]
    ds_read_b64_tr_b16 v[152:153], v10 offset:64608
    v_mfma_f32_16x16x32_bf16 v[60:63], v[180:183], v[116:119], v[60:63]
    ds_read_b64_tr_b16 v[154:155], v11 offset:30048
    ds_read_b64_tr_b16 v[156:157], v10 offset:64640
    v_mfma_f32_16x16x32_bf16 v[64:67], v[176:179], v[120:123], v[64:67]
    ds_read_b64_tr_b16 v[158:159], v11 offset:30080
    v_mfma_f32_16x16x32_bf16 v[68:71], v[180:183], v[120:123], v[68:71]
    ds_read_b64_tr_b16 v[160:161], v10 offset:64672
    v_mfma_f32_16x16x32_bf16 v[72:75], v[176:179], v[124:127], v[72:75]
    ds_read_b64_tr_b16 v[162:163], v11 offset:30112
    v_mfma_f32_16x16x32_bf16 v[76:79], v[180:183], v[124:127], v[76:79]
    ds_read_b64_tr_b16 v[164:165], v10 offset:64704
    s_waitcnt lgkmcnt(14)
    v_mfma_f32_16x16x32_bf16 v[80:83], v[176:179], v[128:131], v[80:83]
    ds_read_b64_tr_b16 v[166:167], v11 offset:30144
    v_mfma_f32_16x16x32_bf16 v[84:87], v[180:183], v[128:131], v[84:87]
    ds_read_b64_tr_b16 v[168:169], v10 offset:64736
    v_mfma_f32_16x16x32_bf16 v[88:91], v[176:179], v[132:135], v[88:91]
    ds_read_b64_tr_b16 v[170:171], v11 offset:30176
    v_mfma_f32_16x16x32_bf16 v[92:95], v[180:183], v[132:135], v[92:95]
    ds_read_b64_tr_b16 v[172:173], v10 offset:64768
    v_mfma_f32_16x16x32_bf16 v[96:99], v[176:179], v[136:139], v[96:99]
    ds_read_b64_tr_b16 v[174:175], v11 offset:30208
    v_mfma_f32_16x16x32_bf16 v[100:103], v[180:183], v[136:139], v[100:103]
    s_waitcnt lgkmcnt(12)
    v_mfma_f32_16x16x32_bf16 v[32:35], v[184:187], v[140:143], v[32:35]
    v_mfma_f32_16x16x32_bf16 v[36:39], v[188:191], v[140:143], v[36:39]
    v_mfma_f32_16x16x32_bf16 v[40:43], v[184:187], v[144:147], v[40:43]
    v_mfma_f32_16x16x32_bf16 v[44:47], v[188:191], v[144:147], v[44:47]
    s_waitcnt lgkmcnt(0)
    s_barrier
    ds_read_b128 v[176:179], v16 offset:0
    v_mfma_f32_16x16x32_bf16 v[48:51], v[184:187], v[148:151], v[48:51]
    ds_read_b128 v[180:183], v16 offset:2048
    ds_read_b64_tr_b16 v[104:105], v10 offset:0
    v_mfma_f32_16x16x32_bf16 v[52:55], v[188:191], v[148:151], v[52:55]
    ds_read_b64_tr_b16 v[106:107], v10 offset:2304
    ds_read_b64_tr_b16 v[108:109], v10 offset:32
    v_mfma_f32_16x16x32_bf16 v[56:59], v[184:187], v[152:155], v[56:59]
    ds_read_b64_tr_b16 v[110:111], v10 offset:2336
    v_mfma_f32_16x16x32_bf16 v[60:63], v[188:191], v[152:155], v[60:63]
    ds_read_b64_tr_b16 v[112:113], v10 offset:64
    ds_read_b64_tr_b16 v[114:115], v10 offset:2368
    v_mfma_f32_16x16x32_bf16 v[64:67], v[184:187], v[156:159], v[64:67]
    ds_read_b64_tr_b16 v[116:117], v10 offset:96
    v_mfma_f32_16x16x32_bf16 v[68:71], v[188:191], v[156:159], v[68:71]
    ds_read_b64_tr_b16 v[118:119], v10 offset:2400
    v_mfma_f32_16x16x32_bf16 v[72:75], v[184:187], v[160:163], v[72:75]
    ds_read_b64_tr_b16 v[120:121], v10 offset:128
    ds_read_b64_tr_b16 v[122:123], v10 offset:2432
    v_mfma_f32_16x16x32_bf16 v[76:79], v[188:191], v[160:163], v[76:79]
    ds_read_b64_tr_b16 v[124:125], v10 offset:160
    v_mfma_f32_16x16x32_bf16 v[80:83], v[184:187], v[164:167], v[80:83]
    ds_read_b64_tr_b16 v[126:127], v10 offset:2464
    v_mfma_f32_16x16x32_bf16 v[84:87], v[188:191], v[164:167], v[84:87]
    ds_read_b64_tr_b16 v[128:129], v10 offset:192
    ds_read_b64_tr_b16 v[130:131], v10 offset:2496
    v_mfma_f32_16x16x32_bf16 v[88:91], v[184:187], v[168:171], v[88:91]
    ds_read_b64_tr_b16 v[132:133], v10 offset:224
    v_mfma_f32_16x16x32_bf16 v[92:95], v[188:191], v[168:171], v[92:95]
    ds_read_b64_tr_b16 v[134:135], v10 offset:2528
    v_mfma_f32_16x16x32_bf16 v[96:99], v[184:187], v[172:175], v[96:99]
    ds_read_b64_tr_b16 v[136:137], v10 offset:256
    ds_read_b64_tr_b16 v[138:139], v10 offset:2560
    v_mfma_f32_16x16x32_bf16 v[100:103], v[188:191], v[172:175], v[100:103]
    s_waitcnt lgkmcnt(12)
    v_mfma_f32_16x16x32_bf16 v[32:35], v[176:179], v[104:107], v[32:35]
    ds_read_b128 v[184:187], v17 offset:0
    v_mfma_f32_16x16x32_bf16 v[36:39], v[180:183], v[104:107], v[36:39]
    ds_read_b128 v[188:191], v17 offset:2048
    ds_read_b64_tr_b16 v[140:141], v10 offset:9216
    v_mfma_f32_16x16x32_bf16 v[40:43], v[176:179], v[108:111], v[40:43]
    ds_read_b64_tr_b16 v[142:143], v10 offset:11520
    v_mfma_f32_16x16x32_bf16 v[44:47], v[180:183], v[108:111], v[44:47]
    ds_read_b64_tr_b16 v[144:145], v10 offset:9248
    v_mfma_f32_16x16x32_bf16 v[48:51], v[176:179], v[112:115], v[48:51]
    ds_read_b64_tr_b16 v[146:147], v10 offset:11552
    ds_read_b64_tr_b16 v[148:149], v10 offset:9280
    v_mfma_f32_16x16x32_bf16 v[52:55], v[180:183], v[112:115], v[52:55]
    ds_read_b64_tr_b16 v[150:151], v10 offset:11584
    s_waitcnt lgkmcnt(14)
    v_mfma_f32_16x16x32_bf16 v[56:59], v[176:179], v[116:119], v[56:59]
    ds_read_b64_tr_b16 v[152:153], v10 offset:9312
    v_mfma_f32_16x16x32_bf16 v[60:63], v[180:183], v[116:119], v[60:63]
    ds_read_b64_tr_b16 v[154:155], v10 offset:11616
    ds_read_b64_tr_b16 v[156:157], v10 offset:9344
    v_mfma_f32_16x16x32_bf16 v[64:67], v[176:179], v[120:123], v[64:67]
    ds_read_b64_tr_b16 v[158:159], v10 offset:11648
    v_mfma_f32_16x16x32_bf16 v[68:71], v[180:183], v[120:123], v[68:71]
    ds_read_b64_tr_b16 v[160:161], v10 offset:9376
    v_mfma_f32_16x16x32_bf16 v[72:75], v[176:179], v[124:127], v[72:75]
    ds_read_b64_tr_b16 v[162:163], v10 offset:11680
    v_mfma_f32_16x16x32_bf16 v[76:79], v[180:183], v[124:127], v[76:79]
    ds_read_b64_tr_b16 v[164:165], v10 offset:9408
    s_waitcnt lgkmcnt(14)
    v_mfma_f32_16x16x32_bf16 v[80:83], v[176:179], v[128:131], v[80:83]
    ds_read_b64_tr_b16 v[166:167], v10 offset:11712
    v_mfma_f32_16x16x32_bf16 v[84:87], v[180:183], v[128:131], v[84:87]
    ds_read_b64_tr_b16 v[168:169], v10 offset:9440
    v_mfma_f32_16x16x32_bf16 v[88:91], v[176:179], v[132:135], v[88:91]
    ds_read_b64_tr_b16 v[170:171], v10 offset:11744
    v_mfma_f32_16x16x32_bf16 v[92:95], v[180:183], v[132:135], v[92:95]
    ds_read_b64_tr_b16 v[172:173], v10 offset:9472
    v_mfma_f32_16x16x32_bf16 v[96:99], v[176:179], v[136:139], v[96:99]
    ds_read_b64_tr_b16 v[174:175], v10 offset:11776
    v_mfma_f32_16x16x32_bf16 v[100:103], v[180:183], v[136:139], v[100:103]
    s_waitcnt lgkmcnt(12)
    v_mfma_f32_16x16x32_bf16 v[32:35], v[184:187], v[140:143], v[32:35]
    v_mfma_f32_16x16x32_bf16 v[36:39], v[188:191], v[140:143], v[36:39]
    v_mfma_f32_16x16x32_bf16 v[40:43], v[184:187], v[144:147], v[40:43]
    v_mfma_f32_16x16x32_bf16 v[44:47], v[188:191], v[144:147], v[44:47]
    s_waitcnt lgkmcnt(0)
    s_barrier
    ds_read_b128 v[176:179], v16 offset:16384
    v_mfma_f32_16x16x32_bf16 v[48:51], v[184:187], v[148:151], v[48:51]
    ds_read_b128 v[180:183], v16 offset:18432
    ds_read_b64_tr_b16 v[104:105], v10 offset:18432
    v_mfma_f32_16x16x32_bf16 v[52:55], v[188:191], v[148:151], v[52:55]
    ds_read_b64_tr_b16 v[106:107], v10 offset:20736
    ds_read_b64_tr_b16 v[108:109], v10 offset:18464
    v_mfma_f32_16x16x32_bf16 v[56:59], v[184:187], v[152:155], v[56:59]
    ds_read_b64_tr_b16 v[110:111], v10 offset:20768
    v_mfma_f32_16x16x32_bf16 v[60:63], v[188:191], v[152:155], v[60:63]
    ds_read_b64_tr_b16 v[112:113], v10 offset:18496
    ds_read_b64_tr_b16 v[114:115], v10 offset:20800
    v_mfma_f32_16x16x32_bf16 v[64:67], v[184:187], v[156:159], v[64:67]
    ds_read_b64_tr_b16 v[116:117], v10 offset:18528
    v_mfma_f32_16x16x32_bf16 v[68:71], v[188:191], v[156:159], v[68:71]
    ds_read_b64_tr_b16 v[118:119], v10 offset:20832
    v_mfma_f32_16x16x32_bf16 v[72:75], v[184:187], v[160:163], v[72:75]
    ds_read_b64_tr_b16 v[120:121], v10 offset:18560
    ds_read_b64_tr_b16 v[122:123], v10 offset:20864
    v_mfma_f32_16x16x32_bf16 v[76:79], v[188:191], v[160:163], v[76:79]
    ds_read_b64_tr_b16 v[124:125], v10 offset:18592
    v_mfma_f32_16x16x32_bf16 v[80:83], v[184:187], v[164:167], v[80:83]
    ds_read_b64_tr_b16 v[126:127], v10 offset:20896
    v_mfma_f32_16x16x32_bf16 v[84:87], v[188:191], v[164:167], v[84:87]
    ds_read_b64_tr_b16 v[128:129], v10 offset:18624
    ds_read_b64_tr_b16 v[130:131], v10 offset:20928
    v_mfma_f32_16x16x32_bf16 v[88:91], v[184:187], v[168:171], v[88:91]
    ds_read_b64_tr_b16 v[132:133], v10 offset:18656
    v_mfma_f32_16x16x32_bf16 v[92:95], v[188:191], v[168:171], v[92:95]
    ds_read_b64_tr_b16 v[134:135], v10 offset:20960
    v_mfma_f32_16x16x32_bf16 v[96:99], v[184:187], v[172:175], v[96:99]
    ds_read_b64_tr_b16 v[136:137], v10 offset:18688
    ds_read_b64_tr_b16 v[138:139], v10 offset:20992
    v_mfma_f32_16x16x32_bf16 v[100:103], v[188:191], v[172:175], v[100:103]
    s_waitcnt lgkmcnt(12)
    v_mfma_f32_16x16x32_bf16 v[32:35], v[176:179], v[104:107], v[32:35]
    ds_read_b128 v[184:187], v17 offset:16384
    v_mfma_f32_16x16x32_bf16 v[36:39], v[180:183], v[104:107], v[36:39]
    ds_read_b128 v[188:191], v17 offset:18432
    ds_read_b64_tr_b16 v[140:141], v10 offset:27648
    v_mfma_f32_16x16x32_bf16 v[40:43], v[176:179], v[108:111], v[40:43]
    ds_read_b64_tr_b16 v[142:143], v10 offset:29952
    v_mfma_f32_16x16x32_bf16 v[44:47], v[180:183], v[108:111], v[44:47]
    ds_read_b64_tr_b16 v[144:145], v10 offset:27680
    v_mfma_f32_16x16x32_bf16 v[48:51], v[176:179], v[112:115], v[48:51]
    ds_read_b64_tr_b16 v[146:147], v10 offset:29984
    ds_read_b64_tr_b16 v[148:149], v10 offset:27712
    v_mfma_f32_16x16x32_bf16 v[52:55], v[180:183], v[112:115], v[52:55]
    ds_read_b64_tr_b16 v[150:151], v10 offset:30016
    s_waitcnt lgkmcnt(14)
    v_mfma_f32_16x16x32_bf16 v[56:59], v[176:179], v[116:119], v[56:59]
    ds_read_b64_tr_b16 v[152:153], v10 offset:27744
    v_mfma_f32_16x16x32_bf16 v[60:63], v[180:183], v[116:119], v[60:63]
    ds_read_b64_tr_b16 v[154:155], v10 offset:30048
    ds_read_b64_tr_b16 v[156:157], v10 offset:27776
    v_mfma_f32_16x16x32_bf16 v[64:67], v[176:179], v[120:123], v[64:67]
    ds_read_b64_tr_b16 v[158:159], v10 offset:30080
    v_mfma_f32_16x16x32_bf16 v[68:71], v[180:183], v[120:123], v[68:71]
    ds_read_b64_tr_b16 v[160:161], v10 offset:27808
    v_mfma_f32_16x16x32_bf16 v[72:75], v[176:179], v[124:127], v[72:75]
    ds_read_b64_tr_b16 v[162:163], v10 offset:30112
    v_mfma_f32_16x16x32_bf16 v[76:79], v[180:183], v[124:127], v[76:79]
    ds_read_b64_tr_b16 v[164:165], v10 offset:27840
    s_waitcnt lgkmcnt(14)
    v_mfma_f32_16x16x32_bf16 v[80:83], v[176:179], v[128:131], v[80:83]
    ds_read_b64_tr_b16 v[166:167], v10 offset:30144
    v_mfma_f32_16x16x32_bf16 v[84:87], v[180:183], v[128:131], v[84:87]
    ds_read_b64_tr_b16 v[168:169], v10 offset:27872
    v_mfma_f32_16x16x32_bf16 v[88:91], v[176:179], v[132:135], v[88:91]
    ds_read_b64_tr_b16 v[170:171], v10 offset:30176
    v_mfma_f32_16x16x32_bf16 v[92:95], v[180:183], v[132:135], v[92:95]
    ds_read_b64_tr_b16 v[172:173], v10 offset:27904
    v_mfma_f32_16x16x32_bf16 v[96:99], v[176:179], v[136:139], v[96:99]
    ds_read_b64_tr_b16 v[174:175], v10 offset:30208
    v_mfma_f32_16x16x32_bf16 v[100:103], v[180:183], v[136:139], v[100:103]
    s_waitcnt lgkmcnt(12)
    v_mfma_f32_16x16x32_bf16 v[32:35], v[184:187], v[140:143], v[32:35]
    v_mfma_f32_16x16x32_bf16 v[36:39], v[188:191], v[140:143], v[36:39]
    v_mfma_f32_16x16x32_bf16 v[40:43], v[184:187], v[144:147], v[40:43]
    v_mfma_f32_16x16x32_bf16 v[44:47], v[188:191], v[144:147], v[44:47]
    s_waitcnt lgkmcnt(0)
    s_barrier
    ds_read_b128 v[176:179], v16 offset:32768
    v_mfma_f32_16x16x32_bf16 v[48:51], v[184:187], v[148:151], v[48:51]
    ds_read_b128 v[180:183], v16 offset:34816
    ds_read_b64_tr_b16 v[104:105], v10 offset:36864
    v_mfma_f32_16x16x32_bf16 v[52:55], v[188:191], v[148:151], v[52:55]
    ds_read_b64_tr_b16 v[106:107], v10 offset:39168
    ds_read_b64_tr_b16 v[108:109], v10 offset:36896
    v_mfma_f32_16x16x32_bf16 v[56:59], v[184:187], v[152:155], v[56:59]
    ds_read_b64_tr_b16 v[110:111], v10 offset:39200
    v_mfma_f32_16x16x32_bf16 v[60:63], v[188:191], v[152:155], v[60:63]
    ds_read_b64_tr_b16 v[112:113], v10 offset:36928
    ds_read_b64_tr_b16 v[114:115], v10 offset:39232
    v_mfma_f32_16x16x32_bf16 v[64:67], v[184:187], v[156:159], v[64:67]
    ds_read_b64_tr_b16 v[116:117], v10 offset:36960
    v_mfma_f32_16x16x32_bf16 v[68:71], v[188:191], v[156:159], v[68:71]
    ds_read_b64_tr_b16 v[118:119], v10 offset:39264
    v_mfma_f32_16x16x32_bf16 v[72:75], v[184:187], v[160:163], v[72:75]
    ds_read_b64_tr_b16 v[120:121], v10 offset:36992
    ds_read_b64_tr_b16 v[122:123], v10 offset:39296
    v_mfma_f32_16x16x32_bf16 v[76:79], v[188:191], v[160:163], v[76:79]
    ds_read_b64_tr_b16 v[124:125], v10 offset:37024
    v_mfma_f32_16x16x32_bf16 v[80:83], v[184:187], v[164:167], v[80:83]
    ds_read_b64_tr_b16 v[126:127], v10 offset:39328
    v_mfma_f32_16x16x32_bf16 v[84:87], v[188:191], v[164:167], v[84:87]
    ds_read_b64_tr_b16 v[128:129], v10 offset:37056
    ds_read_b64_tr_b16 v[130:131], v10 offset:39360
    v_mfma_f32_16x16x32_bf16 v[88:91], v[184:187], v[168:171], v[88:91]
    ds_read_b64_tr_b16 v[132:133], v10 offset:37088
    v_mfma_f32_16x16x32_bf16 v[92:95], v[188:191], v[168:171], v[92:95]
    ds_read_b64_tr_b16 v[134:135], v10 offset:39392
    v_mfma_f32_16x16x32_bf16 v[96:99], v[184:187], v[172:175], v[96:99]
    ds_read_b64_tr_b16 v[136:137], v10 offset:37120
    ds_read_b64_tr_b16 v[138:139], v10 offset:39424
    v_mfma_f32_16x16x32_bf16 v[100:103], v[188:191], v[172:175], v[100:103]
    s_waitcnt lgkmcnt(12)
    v_mfma_f32_16x16x32_bf16 v[32:35], v[176:179], v[104:107], v[32:35]
    ds_read_b128 v[184:187], v17 offset:32768
    v_mfma_f32_16x16x32_bf16 v[36:39], v[180:183], v[104:107], v[36:39]
    ds_read_b128 v[188:191], v17 offset:34816
    ds_read_b64_tr_b16 v[140:141], v10 offset:46080
    v_mfma_f32_16x16x32_bf16 v[40:43], v[176:179], v[108:111], v[40:43]
    ds_read_b64_tr_b16 v[142:143], v10 offset:48384
    v_mfma_f32_16x16x32_bf16 v[44:47], v[180:183], v[108:111], v[44:47]
    ds_read_b64_tr_b16 v[144:145], v10 offset:46112
    v_mfma_f32_16x16x32_bf16 v[48:51], v[176:179], v[112:115], v[48:51]
    ds_read_b64_tr_b16 v[146:147], v10 offset:48416
    ds_read_b64_tr_b16 v[148:149], v10 offset:46144
    v_mfma_f32_16x16x32_bf16 v[52:55], v[180:183], v[112:115], v[52:55]
    ds_read_b64_tr_b16 v[150:151], v10 offset:48448
    s_waitcnt lgkmcnt(14)
    v_mfma_f32_16x16x32_bf16 v[56:59], v[176:179], v[116:119], v[56:59]
    ds_read_b64_tr_b16 v[152:153], v10 offset:46176
    v_mfma_f32_16x16x32_bf16 v[60:63], v[180:183], v[116:119], v[60:63]
    ds_read_b64_tr_b16 v[154:155], v10 offset:48480
    ds_read_b64_tr_b16 v[156:157], v10 offset:46208
    v_mfma_f32_16x16x32_bf16 v[64:67], v[176:179], v[120:123], v[64:67]
    ds_read_b64_tr_b16 v[158:159], v10 offset:48512
    v_mfma_f32_16x16x32_bf16 v[68:71], v[180:183], v[120:123], v[68:71]
    ds_read_b64_tr_b16 v[160:161], v10 offset:46240
    v_mfma_f32_16x16x32_bf16 v[72:75], v[176:179], v[124:127], v[72:75]
    ds_read_b64_tr_b16 v[162:163], v10 offset:48544
    v_mfma_f32_16x16x32_bf16 v[76:79], v[180:183], v[124:127], v[76:79]
    ds_read_b64_tr_b16 v[164:165], v10 offset:46272
    s_waitcnt lgkmcnt(14)
    v_mfma_f32_16x16x32_bf16 v[80:83], v[176:179], v[128:131], v[80:83]
    ds_read_b64_tr_b16 v[166:167], v10 offset:48576
    v_mfma_f32_16x16x32_bf16 v[84:87], v[180:183], v[128:131], v[84:87]
    ds_read_b64_tr_b16 v[168:169], v10 offset:46304
    v_mfma_f32_16x16x32_bf16 v[88:91], v[176:179], v[132:135], v[88:91]
    ds_read_b64_tr_b16 v[170:171], v10 offset:48608
    v_mfma_f32_16x16x32_bf16 v[92:95], v[180:183], v[132:135], v[92:95]
    ds_read_b64_tr_b16 v[172:173], v10 offset:46336
    v_mfma_f32_16x16x32_bf16 v[96:99], v[176:179], v[136:139], v[96:99]
    ds_read_b64_tr_b16 v[174:175], v10 offset:48640
    v_mfma_f32_16x16x32_bf16 v[100:103], v[180:183], v[136:139], v[100:103]
    s_waitcnt lgkmcnt(12)
    v_mfma_f32_16x16x32_bf16 v[32:35], v[184:187], v[140:143], v[32:35]
    v_mfma_f32_16x16x32_bf16 v[36:39], v[188:191], v[140:143], v[36:39]
    v_mfma_f32_16x16x32_bf16 v[40:43], v[184:187], v[144:147], v[40:43]
    v_mfma_f32_16x16x32_bf16 v[44:47], v[188:191], v[144:147], v[44:47]
    s_waitcnt lgkmcnt(0)
    s_barrier
    ds_read_b128 v[176:179], v16 offset:49152
    v_mfma_f32_16x16x32_bf16 v[48:51], v[184:187], v[148:151], v[48:51]
    ds_read_b128 v[180:183], v16 offset:51200
    ds_read_b64_tr_b16 v[104:105], v10 offset:55296
    v_mfma_f32_16x16x32_bf16 v[52:55], v[188:191], v[148:151], v[52:55]
    ds_read_b64_tr_b16 v[106:107], v10 offset:57600
    ds_read_b64_tr_b16 v[108:109], v10 offset:55328
    v_mfma_f32_16x16x32_bf16 v[56:59], v[184:187], v[152:155], v[56:59]
    ds_read_b64_tr_b16 v[110:111], v10 offset:57632
    v_mfma_f32_16x16x32_bf16 v[60:63], v[188:191], v[152:155], v[60:63]
    ds_read_b64_tr_b16 v[112:113], v10 offset:55360
    ds_read_b64_tr_b16 v[114:115], v10 offset:57664
    v_mfma_f32_16x16x32_bf16 v[64:67], v[184:187], v[156:159], v[64:67]
    ds_read_b64_tr_b16 v[116:117], v10 offset:55392
    v_mfma_f32_16x16x32_bf16 v[68:71], v[188:191], v[156:159], v[68:71]
    ds_read_b64_tr_b16 v[118:119], v10 offset:57696
    v_mfma_f32_16x16x32_bf16 v[72:75], v[184:187], v[160:163], v[72:75]
    ds_read_b64_tr_b16 v[120:121], v10 offset:55424
    ds_read_b64_tr_b16 v[122:123], v10 offset:57728
    v_mfma_f32_16x16x32_bf16 v[76:79], v[188:191], v[160:163], v[76:79]
    ds_read_b64_tr_b16 v[124:125], v10 offset:55456
    v_mfma_f32_16x16x32_bf16 v[80:83], v[184:187], v[164:167], v[80:83]
    ds_read_b64_tr_b16 v[126:127], v10 offset:57760
    v_mfma_f32_16x16x32_bf16 v[84:87], v[188:191], v[164:167], v[84:87]
    ds_read_b64_tr_b16 v[128:129], v10 offset:55488
    ds_read_b64_tr_b16 v[130:131], v10 offset:57792
    v_mfma_f32_16x16x32_bf16 v[88:91], v[184:187], v[168:171], v[88:91]
    ds_read_b64_tr_b16 v[132:133], v10 offset:55520
    v_mfma_f32_16x16x32_bf16 v[92:95], v[188:191], v[168:171], v[92:95]
    ds_read_b64_tr_b16 v[134:135], v10 offset:57824
    v_mfma_f32_16x16x32_bf16 v[96:99], v[184:187], v[172:175], v[96:99]
    ds_read_b64_tr_b16 v[136:137], v10 offset:55552
    ds_read_b64_tr_b16 v[138:139], v10 offset:57856
    v_mfma_f32_16x16x32_bf16 v[100:103], v[188:191], v[172:175], v[100:103]
    s_waitcnt lgkmcnt(12)
    v_mfma_f32_16x16x32_bf16 v[32:35], v[176:179], v[104:107], v[32:35]
    ds_read_b128 v[184:187], v17 offset:49152
    v_mfma_f32_16x16x32_bf16 v[36:39], v[180:183], v[104:107], v[36:39]
    ds_read_b128 v[188:191], v17 offset:51200
    ds_read_b64_tr_b16 v[140:141], v10 offset:64512
    v_mfma_f32_16x16x32_bf16 v[40:43], v[176:179], v[108:111], v[40:43]
    ds_read_b64_tr_b16 v[142:143], v11 offset:29952
    v_mfma_f32_16x16x32_bf16 v[44:47], v[180:183], v[108:111], v[44:47]
    ds_read_b64_tr_b16 v[144:145], v10 offset:64544
    v_mfma_f32_16x16x32_bf16 v[48:51], v[176:179], v[112:115], v[48:51]
    ds_read_b64_tr_b16 v[146:147], v11 offset:29984
    ds_read_b64_tr_b16 v[148:149], v10 offset:64576
    v_mfma_f32_16x16x32_bf16 v[52:55], v[180:183], v[112:115], v[52:55]
    ds_read_b64_tr_b16 v[150:151], v11 offset:30016
    s_waitcnt lgkmcnt(14)
    v_mfma_f32_16x16x32_bf16 v[56:59], v[176:179], v[116:119], v[56:59]
    ds_read_b64_tr_b16 v[152:153], v10 offset:64608
    v_mfma_f32_16x16x32_bf16 v[60:63], v[180:183], v[116:119], v[60:63]
    ds_read_b64_tr_b16 v[154:155], v11 offset:30048
    ds_read_b64_tr_b16 v[156:157], v10 offset:64640
    v_mfma_f32_16x16x32_bf16 v[64:67], v[176:179], v[120:123], v[64:67]
    ds_read_b64_tr_b16 v[158:159], v11 offset:30080
    v_mfma_f32_16x16x32_bf16 v[68:71], v[180:183], v[120:123], v[68:71]
    ds_read_b64_tr_b16 v[160:161], v10 offset:64672
    v_mfma_f32_16x16x32_bf16 v[72:75], v[176:179], v[124:127], v[72:75]
    ds_read_b64_tr_b16 v[162:163], v11 offset:30112
    v_mfma_f32_16x16x32_bf16 v[76:79], v[180:183], v[124:127], v[76:79]
    ds_read_b64_tr_b16 v[164:165], v10 offset:64704
    s_waitcnt lgkmcnt(14)
    v_mfma_f32_16x16x32_bf16 v[80:83], v[176:179], v[128:131], v[80:83]
    ds_read_b64_tr_b16 v[166:167], v11 offset:30144
    v_mfma_f32_16x16x32_bf16 v[84:87], v[180:183], v[128:131], v[84:87]
    ds_read_b64_tr_b16 v[168:169], v10 offset:64736
    v_mfma_f32_16x16x32_bf16 v[88:91], v[176:179], v[132:135], v[88:91]
    ds_read_b64_tr_b16 v[170:171], v11 offset:30176
    v_mfma_f32_16x16x32_bf16 v[92:95], v[180:183], v[132:135], v[92:95]
    ds_read_b64_tr_b16 v[172:173], v10 offset:64768
    v_mfma_f32_16x16x32_bf16 v[96:99], v[176:179], v[136:139], v[96:99]
    ds_read_b64_tr_b16 v[174:175], v11 offset:30208
    v_mfma_f32_16x16x32_bf16 v[100:103], v[180:183], v[136:139], v[100:103]
    s_waitcnt lgkmcnt(12)
    v_mfma_f32_16x16x32_bf16 v[32:35], v[184:187], v[140:143], v[32:35]
    v_mfma_f32_16x16x32_bf16 v[36:39], v[188:191], v[140:143], v[36:39]
    v_mfma_f32_16x16x32_bf16 v[40:43], v[184:187], v[144:147], v[40:43]
    v_mfma_f32_16x16x32_bf16 v[44:47], v[188:191], v[144:147], v[44:47]
    s_waitcnt lgkmcnt(0)
    s_barrier
    ds_read_b128 v[176:179], v16 offset:0
    v_mfma_f32_16x16x32_bf16 v[48:51], v[184:187], v[148:151], v[48:51]
    ds_read_b128 v[180:183], v16 offset:2048
    ds_read_b64_tr_b16 v[104:105], v10 offset:0
    v_mfma_f32_16x16x32_bf16 v[52:55], v[188:191], v[148:151], v[52:55]
    ds_read_b64_tr_b16 v[106:107], v10 offset:2304
    ds_read_b64_tr_b16 v[108:109], v10 offset:32
    v_mfma_f32_16x16x32_bf16 v[56:59], v[184:187], v[152:155], v[56:59]
    ds_read_b64_tr_b16 v[110:111], v10 offset:2336
    v_mfma_f32_16x16x32_bf16 v[60:63], v[188:191], v[152:155], v[60:63]
    ds_read_b64_tr_b16 v[112:113], v10 offset:64
    ds_read_b64_tr_b16 v[114:115], v10 offset:2368
    v_mfma_f32_16x16x32_bf16 v[64:67], v[184:187], v[156:159], v[64:67]
    ds_read_b64_tr_b16 v[116:117], v10 offset:96
    v_mfma_f32_16x16x32_bf16 v[68:71], v[188:191], v[156:159], v[68:71]
    ds_read_b64_tr_b16 v[118:119], v10 offset:2400
    v_mfma_f32_16x16x32_bf16 v[72:75], v[184:187], v[160:163], v[72:75]
    ds_read_b64_tr_b16 v[120:121], v10 offset:128
    ds_read_b64_tr_b16 v[122:123], v10 offset:2432
    v_mfma_f32_16x16x32_bf16 v[76:79], v[188:191], v[160:163], v[76:79]
    ds_read_b64_tr_b16 v[124:125], v10 offset:160
    v_mfma_f32_16x16x32_bf16 v[80:83], v[184:187], v[164:167], v[80:83]
    ds_read_b64_tr_b16 v[126:127], v10 offset:2464
    v_mfma_f32_16x16x32_bf16 v[84:87], v[188:191], v[164:167], v[84:87]
    ds_read_b64_tr_b16 v[128:129], v10 offset:192
    ds_read_b64_tr_b16 v[130:131], v10 offset:2496
    v_mfma_f32_16x16x32_bf16 v[88:91], v[184:187], v[168:171], v[88:91]
    ds_read_b64_tr_b16 v[132:133], v10 offset:224
    v_mfma_f32_16x16x32_bf16 v[92:95], v[188:191], v[168:171], v[92:95]
    ds_read_b64_tr_b16 v[134:135], v10 offset:2528
    v_mfma_f32_16x16x32_bf16 v[96:99], v[184:187], v[172:175], v[96:99]
    ds_read_b64_tr_b16 v[136:137], v10 offset:256
    ds_read_b64_tr_b16 v[138:139], v10 offset:2560
    v_mfma_f32_16x16x32_bf16 v[100:103], v[188:191], v[172:175], v[100:103]
    s_waitcnt lgkmcnt(12)
    v_mfma_f32_16x16x32_bf16 v[32:35], v[176:179], v[104:107], v[32:35]
    ds_read_b128 v[184:187], v17 offset:0
    ds_read_b128 v[188:191], v17 offset:2048
    v_mfma_f32_16x16x32_bf16 v[36:39], v[180:183], v[104:107], v[36:39]
    ds_read_b64_tr_b16 v[140:141], v10 offset:9216
    ds_read_b64_tr_b16 v[142:143], v10 offset:11520
    ds_read_b64_tr_b16 v[144:145], v10 offset:9248
    v_mfma_f32_16x16x32_bf16 v[40:43], v[176:179], v[108:111], v[40:43]
    ds_read_b64_tr_b16 v[146:147], v10 offset:11552
    ds_read_b64_tr_b16 v[148:149], v10 offset:9280
    v_mfma_f32_16x16x32_bf16 v[44:47], v[180:183], v[108:111], v[44:47]
    ds_read_b64_tr_b16 v[150:151], v10 offset:11584
    ds_read_b64_tr_b16 v[152:153], v10 offset:9312
    v_mfma_f32_16x16x32_bf16 v[48:51], v[176:179], v[112:115], v[48:51]
    ds_read_b64_tr_b16 v[154:155], v10 offset:11616
    ds_read_b64_tr_b16 v[156:157], v10 offset:9344
    v_mfma_f32_16x16x32_bf16 v[52:55], v[180:183], v[112:115], v[52:55]
    ds_read_b64_tr_b16 v[158:159], v10 offset:11648
    s_waitcnt lgkmcnt(14)
    v_mfma_f32_16x16x32_bf16 v[56:59], v[176:179], v[116:119], v[56:59]
    ds_read_b64_tr_b16 v[160:161], v10 offset:9376
    ds_read_b64_tr_b16 v[162:163], v10 offset:11680
    v_mfma_f32_16x16x32_bf16 v[60:63], v[180:183], v[116:119], v[60:63]
    ds_read_b64_tr_b16 v[164:165], v10 offset:9408
    ds_read_b64_tr_b16 v[166:167], v10 offset:11712
    v_mfma_f32_16x16x32_bf16 v[64:67], v[176:179], v[120:123], v[64:67]
    ds_read_b64_tr_b16 v[168:169], v10 offset:9440
    ds_read_b64_tr_b16 v[170:171], v10 offset:11744
    v_mfma_f32_16x16x32_bf16 v[68:71], v[180:183], v[120:123], v[68:71]
    ds_read_b64_tr_b16 v[172:173], v10 offset:9472
    ds_read_b64_tr_b16 v[174:175], v10 offset:11776
    v_mfma_f32_16x16x32_bf16 v[72:75], v[176:179], v[124:127], v[72:75]
    ds_read_b128 v[228:231], v18 offset:0
    ds_read_b128 v[236:239], v18 offset:512
    v_mfma_f32_16x16x32_bf16 v[76:79], v[180:183], v[124:127], v[76:79]
    ds_read_b128 v[232:235], v18 offset:64
    s_waitcnt lgkmcnt(14)
    v_mfma_f32_16x16x32_bf16 v[80:83], v[176:179], v[128:131], v[80:83]
    ds_read_b128 v[240:243], v18 offset:576
    ds_read_b32 v192, v21 offset:0
    v_mfma_f32_16x16x32_bf16 v[84:87], v[180:183], v[128:131], v[84:87]
    ds_read_b32 v193, v21 offset:64
    ds_read_b32 v194, v21 offset:128
    v_mfma_f32_16x16x32_bf16 v[88:91], v[176:179], v[132:135], v[88:91]
    ds_read_b32 v195, v21 offset:192
    ds_read_b32 v196, v21 offset:256
    v_mfma_f32_16x16x32_bf16 v[92:95], v[180:183], v[132:135], v[92:95]
    ds_read_b32 v197, v21 offset:320
    ds_read_b32 v198, v21 offset:384
    v_mfma_f32_16x16x32_bf16 v[96:99], v[176:179], v[136:139], v[96:99]
    ds_read_b32 v199, v21 offset:448
    ds_read_b32 v200, v21 offset:512
    v_mfma_f32_16x16x32_bf16 v[100:103], v[180:183], v[136:139], v[100:103]
    v_mfma_f32_16x16x32_bf16 v[32:35], v[184:187], v[140:143], v[32:35]
    v_mfma_f32_16x16x32_bf16 v[36:39], v[188:191], v[140:143], v[36:39]
    v_mfma_f32_16x16x32_bf16 v[40:43], v[184:187], v[144:147], v[40:43]
    v_mfma_f32_16x16x32_bf16 v[44:47], v[188:191], v[144:147], v[44:47]
    v_mfma_f32_16x16x32_bf16 v[48:51], v[184:187], v[148:151], v[48:51]
    v_mfma_f32_16x16x32_bf16 v[52:55], v[188:191], v[148:151], v[52:55]
    s_waitcnt lgkmcnt(14)
    v_mfma_f32_16x16x32_bf16 v[56:59], v[184:187], v[152:155], v[56:59]
    v_mfma_f32_16x16x32_bf16 v[60:63], v[188:191], v[152:155], v[60:63]
    s_waitcnt lgkmcnt(0)
    ds_write_b128 v213, v[24:27] offset:18720
    v_mfma_f32_16x16x32_bf16 v[64:67], v[184:187], v[156:159], v[64:67]
    v_mfma_f32_16x16x32_bf16 v[68:71], v[188:191], v[156:159], v[68:71]
    v_mfma_f32_16x16x32_bf16 v[72:75], v[184:187], v[160:163], v[72:75]
    v_mfma_f32_16x16x32_bf16 v[76:79], v[188:191], v[160:163], v[76:79]
    v_mfma_f32_16x16x32_bf16 v[80:83], v[184:187], v[164:167], v[80:83]
    v_mfma_f32_16x16x32_bf16 v[84:87], v[188:191], v[164:167], v[84:87]
    v_mfma_f32_16x16x32_bf16 v[88:91], v[184:187], v[168:171], v[88:91]
    v_mfma_f32_16x16x32_bf16 v[92:95], v[188:191], v[168:171], v[92:95]
    v_mfma_f32_16x16x32_bf16 v[96:99], v[184:187], v[172:175], v[96:99]
    v_mfma_f32_16x16x32_bf16 v[100:103], v[188:191], v[172:175], v[100:103]
    s_nop 7
    v_pk_fma_f32 v[32:33], v[228:229], v[192:193], v[32:33] op_sel:[0,0,0] op_sel_hi:[1,0,1] neg_lo:[0,1,0] neg_hi:[0,1,0]
    v_pk_fma_f32 v[34:35], v[230:231], v[192:193], v[34:35] op_sel:[0,0,0] op_sel_hi:[1,0,1] neg_lo:[0,1,0] neg_hi:[0,1,0]
    v_pk_mul_f32 v[32:33], v[32:33], v[236:237]
    v_pk_mul_f32 v[34:35], v[34:35], v[238:239]
    v_cvt_pk_bf16_f32 v104, v32, v33
    v_cvt_pk_bf16_f32 v105, v34, v35
    v_pk_fma_f32 v[36:37], v[232:233], v[192:193], v[36:37] op_sel:[0,0,0] op_sel_hi:[1,0,1] neg_lo:[0,1,0] neg_hi:[0,1,0]
    v_pk_fma_f32 v[38:39], v[234:235], v[192:193], v[38:39] op_sel:[0,0,0] op_sel_hi:[1,0,1] neg_lo:[0,1,0] neg_hi:[0,1,0]
    v_pk_mul_f32 v[36:37], v[36:37], v[240:241]
    v_pk_mul_f32 v[38:39], v[38:39], v[242:243]
    v_cvt_pk_bf16_f32 v106, v36, v37
    v_cvt_pk_bf16_f32 v107, v38, v39
    ds_write_b128 v204, v[104:107] offset:18432
    v_pk_fma_f32 v[40:41], v[228:229], v[192:193], v[40:41] op_sel:[0,1,0] op_sel_hi:[1,1,1] neg_lo:[0,1,0] neg_hi:[0,1,0]
    v_pk_fma_f32 v[42:43], v[230:231], v[192:193], v[42:43] op_sel:[0,1,0] op_sel_hi:[1,1,1] neg_lo:[0,1,0] neg_hi:[0,1,0]
    v_pk_mul_f32 v[40:41], v[40:41], v[236:237]
    v_pk_mul_f32 v[42:43], v[42:43], v[238:239]
    v_cvt_pk_bf16_f32 v108, v40, v41
    v_cvt_pk_bf16_f32 v109, v42, v43
    v_pk_fma_f32 v[44:45], v[232:233], v[192:193], v[44:45] op_sel:[0,1,0] op_sel_hi:[1,1,1] neg_lo:[0,1,0] neg_hi:[0,1,0]
    v_pk_fma_f32 v[46:47], v[234:235], v[192:193], v[46:47] op_sel:[0,1,0] op_sel_hi:[1,1,1] neg_lo:[0,1,0] neg_hi:[0,1,0]
    v_pk_mul_f32 v[44:45], v[44:45], v[240:241]
    v_pk_mul_f32 v[46:47], v[46:47], v[242:243]
    v_cvt_pk_bf16_f32 v110, v44, v45
    v_cvt_pk_bf16_f32 v111, v46, v47
    ds_write_b128 v205, v[108:111] offset:18432
    v_pk_fma_f32 v[48:49], v[228:229], v[194:195], v[48:49] op_sel:[0,0,0] op_sel_hi:[1,0,1] neg_lo:[0,1,0] neg_hi:[0,1,0]
    v_pk_fma_f32 v[50:51], v[230:231], v[194:195], v[50:51] op_sel:[0,0,0] op_sel_hi:[1,0,1] neg_lo:[0,1,0] neg_hi:[0,1,0]
    v_pk_mul_f32 v[48:49], v[48:49], v[236:237]
    v_pk_mul_f32 v[50:51], v[50:51], v[238:239]
    v_cvt_pk_bf16_f32 v112, v48, v49
    v_cvt_pk_bf16_f32 v113, v50, v51
    v_pk_fma_f32 v[52:53], v[232:233], v[194:195], v[52:53] op_sel:[0,0,0] op_sel_hi:[1,0,1] neg_lo:[0,1,0] neg_hi:[0,1,0]
    v_pk_fma_f32 v[54:55], v[234:235], v[194:195], v[54:55] op_sel:[0,0,0] op_sel_hi:[1,0,1] neg_lo:[0,1,0] neg_hi:[0,1,0]
    v_pk_mul_f32 v[52:53], v[52:53], v[240:241]
    v_pk_mul_f32 v[54:55], v[54:55], v[242:243]
    v_cvt_pk_bf16_f32 v114, v52, v53
    v_cvt_pk_bf16_f32 v115, v54, v55
    ds_write_b128 v206, v[112:115] offset:18432
    v_pk_fma_f32 v[56:57], v[228:229], v[194:195], v[56:57] op_sel:[0,1,0] op_sel_hi:[1,1,1] neg_lo:[0,1,0] neg_hi:[0,1,0]
    v_pk_fma_f32 v[58:59], v[230:231], v[194:195], v[58:59] op_sel:[0,1,0] op_sel_hi:[1,1,1] neg_lo:[0,1,0] neg_hi:[0,1,0]
    v_pk_mul_f32 v[56:57], v[56:57], v[236:237]
    v_pk_mul_f32 v[58:59], v[58:59], v[238:239]
    v_cvt_pk_bf16_f32 v116, v56, v57
    v_cvt_pk_bf16_f32 v117, v58, v59
    v_pk_fma_f32 v[60:61], v[232:233], v[194:195], v[60:61] op_sel:[0,1,0] op_sel_hi:[1,1,1] neg_lo:[0,1,0] neg_hi:[0,1,0]
    v_pk_fma_f32 v[62:63], v[234:235], v[194:195], v[62:63] op_sel:[0,1,0] op_sel_hi:[1,1,1] neg_lo:[0,1,0] neg_hi:[0,1,0]
    v_pk_mul_f32 v[60:61], v[60:61], v[240:241]
    v_pk_mul_f32 v[62:63], v[62:63], v[242:243]
    v_cvt_pk_bf16_f32 v118, v60, v61
    v_cvt_pk_bf16_f32 v119, v62, v63
    ds_write_b128 v207, v[116:119] offset:18432
    v_pk_fma_f32 v[64:65], v[228:229], v[196:197], v[64:65] op_sel:[0,0,0] op_sel_hi:[1,0,1] neg_lo:[0,1,0] neg_hi:[0,1,0]
    v_pk_fma_f32 v[66:67], v[230:231], v[196:197], v[66:67] op_sel:[0,0,0] op_sel_hi:[1,0,1] neg_lo:[0,1,0] neg_hi:[0,1,0]
    v_pk_mul_f32 v[64:65], v[64:65], v[236:237]
    v_pk_mul_f32 v[66:67], v[66:67], v[238:239]
    v_cvt_pk_bf16_f32 v120, v64, v65
    v_cvt_pk_bf16_f32 v121, v66, v67
    v_pk_fma_f32 v[68:69], v[232:233], v[196:197], v[68:69] op_sel:[0,0,0] op_sel_hi:[1,0,1] neg_lo:[0,1,0] neg_hi:[0,1,0]
    v_pk_fma_f32 v[70:71], v[234:235], v[196:197], v[70:71] op_sel:[0,0,0] op_sel_hi:[1,0,1] neg_lo:[0,1,0] neg_hi:[0,1,0]
    v_pk_mul_f32 v[68:69], v[68:69], v[240:241]
    v_pk_mul_f32 v[70:71], v[70:71], v[242:243]
    v_cvt_pk_bf16_f32 v122, v68, v69
    v_cvt_pk_bf16_f32 v123, v70, v71
    ds_write_b128 v208, v[120:123] offset:18432
    v_pk_fma_f32 v[72:73], v[228:229], v[196:197], v[72:73] op_sel:[0,1,0] op_sel_hi:[1,1,1] neg_lo:[0,1,0] neg_hi:[0,1,0]
    v_pk_fma_f32 v[74:75], v[230:231], v[196:197], v[74:75] op_sel:[0,1,0] op_sel_hi:[1,1,1] neg_lo:[0,1,0] neg_hi:[0,1,0]
    v_pk_mul_f32 v[72:73], v[72:73], v[236:237]
    v_pk_mul_f32 v[74:75], v[74:75], v[238:239]
    v_cvt_pk_bf16_f32 v124, v72, v73
    v_cvt_pk_bf16_f32 v125, v74, v75
    v_pk_fma_f32 v[76:77], v[232:233], v[196:197], v[76:77] op_sel:[0,1,0] op_sel_hi:[1,1,1] neg_lo:[0,1,0] neg_hi:[0,1,0]
    v_pk_fma_f32 v[78:79], v[234:235], v[196:197], v[78:79] op_sel:[0,1,0] op_sel_hi:[1,1,1] neg_lo:[0,1,0] neg_hi:[0,1,0]
    v_pk_mul_f32 v[76:77], v[76:77], v[240:241]
    v_pk_mul_f32 v[78:79], v[78:79], v[242:243]
    v_cvt_pk_bf16_f32 v126, v76, v77
    v_cvt_pk_bf16_f32 v127, v78, v79
    ds_write_b128 v209, v[124:127] offset:18432
    v_pk_fma_f32 v[80:81], v[228:229], v[198:199], v[80:81] op_sel:[0,0,0] op_sel_hi:[1,0,1] neg_lo:[0,1,0] neg_hi:[0,1,0]
    v_pk_fma_f32 v[82:83], v[230:231], v[198:199], v[82:83] op_sel:[0,0,0] op_sel_hi:[1,0,1] neg_lo:[0,1,0] neg_hi:[0,1,0]
    v_pk_mul_f32 v[80:81], v[80:81], v[236:237]
    v_pk_mul_f32 v[82:83], v[82:83], v[238:239]
    v_cvt_pk_bf16_f32 v128, v80, v81
    v_cvt_pk_bf16_f32 v129, v82, v83
    v_pk_fma_f32 v[84:85], v[232:233], v[198:199], v[84:85] op_sel:[0,0,0] op_sel_hi:[1,0,1] neg_lo:[0,1,0] neg_hi:[0,1,0]
    v_pk_fma_f32 v[86:87], v[234:235], v[198:199], v[86:87] op_sel:[0,0,0] op_sel_hi:[1,0,1] neg_lo:[0,1,0] neg_hi:[0,1,0]
    v_pk_mul_f32 v[84:85], v[84:85], v[240:241]
    v_pk_mul_f32 v[86:87], v[86:87], v[242:243]
    v_cvt_pk_bf16_f32 v130, v84, v85
    v_cvt_pk_bf16_f32 v131, v86, v87
    ds_write_b128 v210, v[128:131] offset:18432
    v_pk_fma_f32 v[88:89], v[228:229], v[198:199], v[88:89] op_sel:[0,1,0] op_sel_hi:[1,1,1] neg_lo:[0,1,0] neg_hi:[0,1,0]
    v_pk_fma_f32 v[90:91], v[230:231], v[198:199], v[90:91] op_sel:[0,1,0] op_sel_hi:[1,1,1] neg_lo:[0,1,0] neg_hi:[0,1,0]
    v_pk_mul_f32 v[88:89], v[88:89], v[236:237]
    v_pk_mul_f32 v[90:91], v[90:91], v[238:239]
    v_cvt_pk_bf16_f32 v132, v88, v89
    v_cvt_pk_bf16_f32 v133, v90, v91
    v_pk_fma_f32 v[92:93], v[232:233], v[198:199], v[92:93] op_sel:[0,1,0] op_sel_hi:[1,1,1] neg_lo:[0,1,0] neg_hi:[0,1,0]
    v_pk_fma_f32 v[94:95], v[234:235], v[198:199], v[94:95] op_sel:[0,1,0] op_sel_hi:[1,1,1] neg_lo:[0,1,0] neg_hi:[0,1,0]
    v_pk_mul_f32 v[92:93], v[92:93], v[240:241]
    v_pk_mul_f32 v[94:95], v[94:95], v[242:243]
    v_cvt_pk_bf16_f32 v134, v92, v93
    v_cvt_pk_bf16_f32 v135, v94, v95
    ds_write_b128 v211, v[132:135] offset:18432
    v_pk_fma_f32 v[96:97], v[228:229], v[200:201], v[96:97] op_sel:[0,0,0] op_sel_hi:[1,0,1] neg_lo:[0,1,0] neg_hi:[0,1,0]
    v_pk_fma_f32 v[98:99], v[230:231], v[200:201], v[98:99] op_sel:[0,0,0] op_sel_hi:[1,0,1] neg_lo:[0,1,0] neg_hi:[0,1,0]
    v_pk_mul_f32 v[96:97], v[96:97], v[236:237]
    v_pk_mul_f32 v[98:99], v[98:99], v[238:239]
    v_cvt_pk_bf16_f32 v136, v96, v97
    v_cvt_pk_bf16_f32 v137, v98, v99
    v_pk_fma_f32 v[100:101], v[232:233], v[200:201], v[100:101] op_sel:[0,0,0] op_sel_hi:[1,0,1] neg_lo:[0,1,0] neg_hi:[0,1,0]
    v_pk_fma_f32 v[102:103], v[234:235], v[200:201], v[102:103] op_sel:[0,0,0] op_sel_hi:[1,0,1] neg_lo:[0,1,0] neg_hi:[0,1,0]
    v_pk_mul_f32 v[100:101], v[100:101], v[240:241]
    v_pk_mul_f32 v[102:103], v[102:103], v[242:243]
    v_cvt_pk_bf16_f32 v138, v100, v101
    v_cvt_pk_bf16_f32 v139, v102, v103
    ds_write_b128 v212, v[136:139] offset:18432
    s_waitcnt lgkmcnt(0)
A_JOIN:
    s_cmp_ge_u32 s33, 8
    s_cbranch_scc0 A_NOTV
    s_barrier
    v_and_b32 v1, 63, v0
    v_lshlrev_b32 v4, 4, v1
    s_mul_i32 s36, s3, 4864
    v_add_u32 v5, s36, v4
    ds_read_b128 v[32:35], v5 offset:18432
    ds_read_b128 v[36:39], v5 offset:19456
    ds_read_b128 v[40:43], v5 offset:20480
    ds_read_b128 v[44:47], v5 offset:21504
    ds_read_b128 v[48:51], v5 offset:22528
    s_and_b32 s40, s33, 3
    s_lshl_b32 s40, s40, 3
    s_add_u32 s40, s40, s3
    s_mul_i32 s47, s40, 151552
    s_mul_i32 s51, s32, 4864
    s_add_u32 s47, s47, s51
    s_add_u32 s47, s47, 2629632
    s_add_u32 s48, s47, 4096
    s_waitcnt lgkmcnt(4)
    buffer_store_dwordx4 v[32:35], v4, s[20:23], s47 offen offset:0 sc1
    s_waitcnt lgkmcnt(3)
    buffer_store_dwordx4 v[36:39], v4, s[20:23], s47 offen offset:1024 sc1
    s_waitcnt lgkmcnt(2)
    buffer_store_dwordx4 v[40:43], v4, s[20:23], s47 offen offset:2048 sc1
    s_waitcnt lgkmcnt(1)
    buffer_store_dwordx4 v[44:47], v4, s[20:23], s47 offen offset:3072 sc1
    s_waitcnt lgkmcnt(0)
    s_mov_b32 exec_hi, 0xffff
    buffer_store_dwordx4 v[48:51], v4, s[20:23], s48 offen sc1
    s_mov_b32 exec_hi, -1
A_NOTV:
    s_lshl_b32 s30, s33, 2
    s_lshr_b32 s31, s32, 2
    s_add_u32 s30, s30, s31
    s_lshl_b32 s30, s30, 8
    s_add_u32 s30, s30, 32768
    s_waitcnt vmcnt(0)
A_JOIN2:
    s_barrier
    s_cmp_eq_u32 s3, 4
    s_cbranch_scc0 SKIP_7
    v_mov_b32 v2, 1
    s_mov_b64 exec, 1
    buffer_atomic_add v2, off, s[20:23], s30
    s_mov_b64 exec, -1
SKIP_7:
    s_branch PH_B
PH_H:
    s_sub_u32 s30, s2, 192
    v_and_b32 v1, 31, v0
    v_lshrrev_b32 v2, 5, v0
    v_and_b32 v3, 63, v0
    s_waitcnt lgkmcnt(0)
    s_mov_b32 s8, s76
    s_mov_b32 s9, s77
    s_mov_b32 s10, 0x240000
    s_mov_b32 s11, 0x00020000
    s_mov_b32 s12, s78
    s_mov_b32 s13, s79
    s_mov_b32 s14, 0x1e6000
    s_mov_b32 s15, 0x00020000
    s_lshl_b32 s31, s30, 5
    v_lshl_add_u32 v8, v2, 1, s31
    v_mul_u32_u24 v9, 1152, v8
    v_add_u32 v10, 1152, v9
    v_lshl_add_u32 v5, v1, 4, v9
    v_lshl_add_u32 v6, v1, 2, v9
    buffer_load_dwordx4 v[40:43], v5, s[8:11], 0 offen
    buffer_load_dwordx4 v[44:47], v5, s[8:11], 0 offen offset:512
    buffer_load_dword v48, v6, s[8:11], 0 offen offset:1024
    v_lshl_add_u32 v5, v1, 4, v10
    v_lshl_add_u32 v6, v1, 2, v10
    buffer_load_dwordx4 v[52:55], v5, s[8:11], 0 offen
    buffer_load_dwordx4 v[56:59], v5, s[8:11], 0 offen offset:512
    buffer_load_dword v60, v6, s[8:11], 0 offen offset:1024
    v_lshrrev_b32 v4, 3, v0
    v_mul_u32_u24 v4, 3456, v4
    v_and_b32 v5, 7, v0
    v_lshl_add_u32 v4, v5, 4, v4
    s_lshr_b32 s33, s30, 1
    s_lshl_b32 s33, s33, 7
    s_and_b32 s34, s30, 1
    s_mul_i32 s34, s34, 995328
    s_add_u32 s33, s33, s34
    s_cmp_ge_u32 s30, 54
    s_cmov_b32 s33, 0x10000000
    buffer_load_dwordx4 v[76:79], v4, s[12:15], s33 offen
    s_add_u32 s33, s33, 221184
    buffer_load_dwordx4 v[80:83], v4, s[12:15], s33 offen
    s_add_u32 s33, s33, 221184
    buffer_load_dwordx4 v[84:87], v4, s[12:15], s33 offen
    s_add_u32 s33, s33, 221184
    buffer_load_dwordx4 v[88:91], v4, s[12:15], s33 offen
    s_add_u32 s33, s33, 221184
    s_cmp_ge_u32 s3, 4
    s_cmov_b32 s33, 0x10000000
    buffer_load_dwordx4 v[92:95], v4, s[12:15], s33 offen
    s_mov_b32 s16, s92
    s_mov_b32 s17, s93
    s_mov_b32 s18, 0x100
    s_mov_b32 s19, 0x00020000
    s_mov_b32 s20, s94
    s_mov_b32 s21, s95
    s_mov_b32 s22, 0x10000000
    s_mov_b32 s23, 0x00020000
    s_lshl_b32 s32, s30, 1
    s_add_u32 s32, s32, s3
    s_lshl_b32 s33, s3, 6
    s_add_u32 s33, s33, s30
    s_add_u32 s33, s33, 160
    s_cmp_ge_u32 s3, 2
    s_cmov_b32 s32, s33
    s_cmp_eq_u32 s32, 607
    s_cbranch_scc0 H_NOINIT
    v_lshlrev_b32 v4, 8, v3
    v_mov_b32 v5, 0
    s_mov_b32 s33, 0
    buffer_store_dword v5, v4, s[20:23], s33 offen sc1
    s_mov_b32 s33, 16384
    buffer_store_dword v5, v4, s[20:23], s33 offen sc1
    s_mov_b32 s33, 32768
    buffer_store_dword v5, v4, s[20:23], s33 offen sc1
    s_mov_b32 s33, 49152
    buffer_store_dword v5, v4, s[20:23], s33 offen sc1
    s_mov_b32 s33, 65536
    buffer_store_dword v5, v4, s[20:23], s33 offen sc1
    s_mov_b32 s33, 81920
    buffer_store_dword v5, v4, s[20:23], s33 offen sc1
    s_mov_b32 s33, 98304
    buffer_store_dword v5, v4, s[20:23], s33 offen sc1
    s_mov_b32 s33, 114688
    buffer_store_dword v5, v4, s[20:23], s33 offen sc1
    s_mov_b32 s33, 131072
    buffer_store_dword v5, v4, s[20:23], s33 offen sc1
    v_mov_b32 v5, 1
    s_waitcnt vmcnt(0)
    s_mov_b64 exec, 1
    buffer_store_dword v5, off, s[16:19], 0 sc1
    s_mov_b64 exec, -1
H_NOINIT:
    s_waitcnt vmcnt(5)
    s_mov_b32 s36, 0x3f803f80
    v_dot2_f32_bf16 v24, v40, s36, 0
    v_dot2_f32_bf16 v32, v40, v40, 0
    v_dot2_f32_bf16 v24, v41, s36, v24
    v_dot2_f32_bf16 v32, v41, v41, v32
    v_dot2_f32_bf16 v24, v42, s36, v24
    v_dot2_f32_bf16 v32, v42, v42, v32
    v_dot2_f32_bf16 v24, v43, s36, v24
    v_dot2_f32_bf16 v32, v43, v43, v32
    v_dot2_f32_bf16 v24, v44, s36, v24
    v_dot2_f32_bf16 v32, v44, v44, v32
    v_dot2_f32_bf16 v24, v45, s36, v24
    v_dot2_f32_bf16 v32, v45, v45, v32
    v_dot2_f32_bf16 v24, v46, s36, v24
    v_dot2_f32_bf16 v32, v46, v46, v32
    v_dot2_f32_bf16 v24, v47, s36, v24
    v_dot2_f32_bf16 v32, v47, v47, v32
    v_dot2_f32_bf16 v24, v48, s36, v24
    v_dot2_f32_bf16 v32, v48, v48, v32
    v_dot2_f32_bf16 v25, v52, s36, 0
    v_dot2_f32_bf16 v33, v52, v52, 0
    v_dot2_f32_bf16 v25, v53, s36, v25
    v_dot2_f32_bf16 v33, v53, v53, v33
    v_dot2_f32_bf16 v25, v54, s36, v25
    v_dot2_f32_bf16 v33, v54, v54, v33
    v_dot2_f32_bf16 v25, v55, s36, v25
    v_dot2_f32_bf16 v33, v55, v55, v33
    v_dot2_f32_bf16 v25, v56, s36, v25
    v_dot2_f32_bf16 v33, v56, v56, v33
    v_dot2_f32_bf16 v25, v57, s36, v25
    v_dot2_f32_bf16 v33, v57, v57, v33
    v_dot2_f32_bf16 v25, v58, s36, v25
    v_dot2_f32_bf16 v33, v58, v58, v33
    v_dot2_f32_bf16 v25, v59, s36, v25
    v_dot2_f32_bf16 v33, v59, v59, v33
    v_dot2_f32_bf16 v25, v60, s36, v25
    v_dot2_f32_bf16 v33, v60, v60, v33
    s_nop 2
    ds_swizzle_b32 v27, v24 offset:0x41f
    ds_swizzle_b32 v28, v25 offset:0x41f
    ds_swizzle_b32 v36, v32 offset:0x41f
    ds_swizzle_b32 v37, v33 offset:0x41f
    s_waitcnt lgkmcnt(0)
    v_add_f32 v24, v24, v27
    v_add_f32 v25, v25, v28
    v_add_f32 v32, v32, v36
    v_add_f32 v33, v33, v37
    ds_swizzle_b32 v27, v24 offset:0x81f
    ds_swizzle_b32 v28, v25 offset:0x81f
    ds_swizzle_b32 v36, v32 offset:0x81f
    ds_swizzle_b32 v37, v33 offset:0x81f
    s_waitcnt lgkmcnt(0)
    v_add_f32 v24, v24, v27
    v_add_f32 v25, v25, v28
    v_add_f32 v32, v32, v36
    v_add_f32 v33, v33, v37
    ds_swizzle_b32 v27, v24 offset:0x101f
    ds_swizzle_b32 v28, v25 offset:0x101f
    ds_swizzle_b32 v36, v32 offset:0x101f
    ds_swizzle_b32 v37, v33 offset:0x101f
    s_waitcnt lgkmcnt(0)
    v_add_f32 v24, v24, v27
    v_add_f32 v25, v25, v28
    v_add_f32 v32, v32, v36
    v_add_f32 v33, v33, v37
    ds_swizzle_b32 v27, v24 offset:0x201f
    ds_swizzle_b32 v28, v25 offset:0x201f
    ds_swizzle_b32 v36, v32 offset:0x201f
    ds_swizzle_b32 v37, v33 offset:0x201f
    s_waitcnt lgkmcnt(0)
    v_add_f32 v24, v24, v27
    v_add_f32 v25, v25, v28
    v_add_f32 v32, v32, v36
    v_add_f32 v33, v33, v37
    ds_swizzle_b32 v27, v24 offset:0x401f
    ds_swizzle_b32 v28, v25 offset:0x401f
    ds_swizzle_b32 v36, v32 offset:0x401f
    ds_swizzle_b32 v37, v33 offset:0x401f
    s_waitcnt lgkmcnt(0)
    v_add_f32 v24, v24, v27
    v_add_f32 v25, v25, v28
    v_add_f32 v32, v32, v36
    v_add_f32 v33, v33, v37
    v_mul_f32 v24, 0x3ae38e39, v24
    v_mul_f32 v25, 0x3ae38e39, v25
    v_mul_f32 v32, 0x3ae38e39, v32
    v_fma_f32 v32, -v24, v24, v32
    v_max_f32 v32, 0, v32
    v_cvt_pk_bf16_f32 v32, v32, v32
    v_lshlrev_b32 v32, 16, v32
    v_add_f32 v32, 0x3727c5ac, v32
    v_cvt_pk_bf16_f32 v32, v32, v32
    v_lshlrev_b32 v32, 16, v32
    v_sqrt_f32 v32, v32
    s_nop 0
    v_cvt_pk_bf16_f32 v32, v32, v32
    v_lshlrev_b32 v32, 16, v32
    v_rcp_f32 v32, v32
    v_mul_f32 v33, 0x3ae38e39, v33
    v_fma_f32 v33, -v25, v25, v33
    v_max_f32 v33, 0, v33
    v_cvt_pk_bf16_f32 v33, v33, v33
    v_lshlrev_b32 v33, 16, v33
    v_add_f32 v33, 0x3727c5ac, v33
    v_cvt_pk_bf16_f32 v33, v33, v33
    v_lshlrev_b32 v33, 16, v33
    v_sqrt_f32 v33, v33
    s_nop 0
    v_cvt_pk_bf16_f32 v33, v33, v33
    v_lshlrev_b32 v33, 16, v33
    v_rcp_f32 v33, v33
    v_cvt_pk_bf16_f32 v34, v24, v24
    v_lshlrev_b32 v34, 16, v34
    v_cvt_pk_bf16_f32 v35, v25, v25
    v_lshlrev_b32 v35, 16, v35
    v_lshlrev_b32 v6, 3, v2
    ds_write_b64 v6, v[34:35] offset:20480
    ds_write_b64 v6, v[32:33] offset:20608
    ds_write_b64 v6, v[24:25] offset:20736
    s_waitcnt vmcnt(0)
    s_mov_b32 s36, 0x00003f80
    s_mov_b32 s37, 0x3f800000
    v_dot2_f32_bf16 v192, v76, s36, 0
    v_dot2_f32_bf16 v193, v76, s37, 0
    v_dot2_f32_bf16 v194, v77, s36, 0
    v_dot2_f32_bf16 v195, v77, s37, 0
    v_dot2_f32_bf16 v196, v78, s36, 0
    v_dot2_f32_bf16 v197, v78, s37, 0
    v_dot2_f32_bf16 v198, v79, s36, 0
    v_dot2_f32_bf16 v199, v79, s37, 0
    v_dot2_f32_bf16 v192, v80, s36, v192
    v_dot2_f32_bf16 v193, v80, s37, v193
    v_dot2_f32_bf16 v194, v81, s36, v194
    v_dot2_f32_bf16 v195, v81, s37, v195
    v_dot2_f32_bf16 v196, v82, s36, v196
    v_dot2_f32_bf16 v197, v82, s37, v197
    v_dot2_f32_bf16 v198, v83, s36, v198
    v_dot2_f32_bf16 v199, v83, s37, v199
    v_dot2_f32_bf16 v192, v84, s36, v192
    v_dot2_f32_bf16 v193, v84, s37, v193
    v_dot2_f32_bf16 v194, v85, s36, v194
    v_dot2_f32_bf16 v195, v85, s37, v195
    v_dot2_f32_bf16 v196, v86, s36, v196
    v_dot2_f32_bf16 v197, v86, s37, v197
    v_dot2_f32_bf16 v198, v87, s36, v198
    v_dot2_f32_bf16 v199, v87, s37, v199
    v_dot2_f32_bf16 v192, v88, s36, v192
    v_dot2_f32_bf16 v193, v88, s37, v193
    v_dot2_f32_bf16 v194, v89, s36, v194
    v_dot2_f32_bf16 v195, v89, s37, v195
    v_dot2_f32_bf16 v196, v90, s36, v196
    v_dot2_f32_bf16 v197, v90, s37, v197
    v_dot2_f32_bf16 v198, v91, s36, v198
    v_dot2_f32_bf16 v199, v91, s37, v199
    v_dot2_f32_bf16 v192, v92, s36, v192
    v_dot2_f32_bf16 v193, v92, s37, v193
    v_dot2_f32_bf16 v194, v93, s36, v194
    v_dot2_f32_bf16 v195, v93, s37, v195
    v_dot2_f32_bf16 v196, v94, s36, v196
    v_dot2_f32_bf16 v197, v94, s37, v197
    v_dot2_f32_bf16 v198, v95, s36, v198
    v_dot2_f32_bf16 v199, v95, s37, v199
    s_nop 2
    v_lshlrev_b32 v4, 5, v0
    ds_write_b128 v4, v[192:195]
    ds_write_b128 v4, v[196:199] offset:16
    s_waitcnt lgkmcnt(0)
    s_barrier
    v_lshlrev_b32 v4, 2, v3
    s_lshl_b32 s33, s3, 11
    v_add_u32 v5, s33, v4
    ds_read_b32 v192, v5 offset:0
    ds_read_b32 v193, v5 offset:256
    ds_read_b32 v194, v5 offset:512
    ds_read_b32 v195, v5 offset:768
    ds_read_b32 v196, v5 offset:1024
    ds_read_b32 v197, v5 offset:1280
    ds_read_b32 v198, v5 offset:1536
    ds_read_b32 v199, v5 offset:1792
    s_waitcnt lgkmcnt(0)
    v_add_f32 v192, v192, v193
    v_add_f32 v192, v192, v194
    v_add_f32 v192, v192, v195
    v_add_f32 v192, v192, v196
    v_add_f32 v192, v192, v197
    v_add_f32 v192, v192, v198
    v_add_f32 v192, v192, v199
    v_lshlrev_b32 v5, 2, v0
    ds_write_b32 v5, v192 offset:16384
    s_waitcnt lgkmcnt(0)
    s_barrier
    s_cmp_eq_u32 s3, 7
    s_cbranch_scc0 SKIP_8
    ds_read_b32 v192, v4 offset:16384
    ds_read_b32 v193, v4 offset:16640
    ds_read_b32 v194, v4 offset:16896
    ds_read_b32 v195, v4 offset:17152
    ds_read_b32 v196, v4 offset:17408
    ds_read_b32 v197, v4 offset:17664
    ds_read_b32 v198, v4 offset:17920
    ds_read_b32 v199, v4 offset:18176
    ds_read_b32 v24, v4 offset:20480
    v_lshlrev_b32 v6, 2, v1
    ds_read_b32 v25, v6 offset:20736
    v_bfe_u32 v7, v0, 5, 1
    v_lshl_add_u32 v7, v7, 13, v6
    s_lshl_b32 s33, s30, 7
    s_add_u32 s33, s33, 147456
    s_add_u32 s34, s33, 16384
    s_waitcnt lgkmcnt(0)
    buffer_store_dword v24, v7, s[20:23], s33 offen sc1
    buffer_store_dword v25, v6, s[20:23], s34 offen sc1
    v_add_f32 v192, v192, v193
    v_add_f32 v192, v192, v194
    v_add_f32 v192, v192, v195
    v_add_f32 v192, v192, v196
    v_add_f32 v192, v192, v197
    v_add_f32 v192, v192, v198
    v_add_f32 v192, v192, v199
    s_lshr_b32 s33, s30, 1
    s_lshl_b32 s33, s33, 8
    s_and_b32 s34, s30, 1
    s_lshl_b32 s34, s34, 13
    s_add_u32 s33, s33, s34
    s_add_u32 s33, s33, 180224
    buffer_store_dword v192, v4, s[20:23], s33 offen sc1
    s_waitcnt vmcnt(0)
    s_mov_b32 s33, 128
    v_mov_b32 v24, 1
    s_mov_b64 exec, 1
    buffer_atomic_add v24, off, s[16:19], s33
    s_mov_b64 exec, -1
SKIP_8:
    s_barrier
    s_mov_b32 s12, s80
    s_mov_b32 s13, s81
    s_mov_b32 s14, 0xa2000
    s_mov_b32 s15, 0x00020000
    v_min_u32 v11, 8, v2
    s_mul_i32 s33, s30, 9
    v_add_u32 v11, s33, v11
    v_lshrrev_b32 v12, 4, v11
    v_lshl_add_u32 v12, v12, 1, v11
    v_and_b32 v13, 63, v11
    v_lshrrev_b32 v7, 1, v13
    v_xor_b32 v7, v7, v13
    v_and_b32 v7, 4, v7
    v_mul_u32_u24 v7, 3, v7
    v_xor_b32 v13, v13, v7
    v_lshrrev_b32 v14, 1, v13
    v_lshlrev_b32 v14, 4, v14
    v_add3_u32 v13, v13, v14, 16
    v_cmp_le_u32 vcc, 512, v11
    s_nop 1
    v_cndmask_b32 v12, v12, v13, vcc
    v_mul_u32_u24 v12, 1152, v12
    v_lshl_add_u32 v5, v1, 4, v12
    v_lshl_add_u32 v6, v1, 2, v12
    buffer_load_dwordx4 v[64:67], v5, s[12:15], 0 offen
    buffer_load_dwordx4 v[68:71], v5, s[12:15], 0 offen offset:512
    buffer_load_dword v72, v6, s[12:15], 0 offen offset:1024
    s_cmp_lt_u32 s32, 324
    s_cbranch_scc0 H_NORP
    s_and_b32 s34, s32, 3
    s_lshr_b32 s35, s32, 2
    s_cmp_lt_u32 s35, 72
    s_cbranch_scc0 H_WO
    s_mov_b32 s12, s88
    s_mov_b32 s13, s89
    s_mov_b32 s14, 0x510000
    s_mov_b32 s15, 0x00020000
    s_mul_hi_u32 s36, s35, 0x2aaaaaab
    s_mul_i32 s37, s36, 6
    s_sub_u32 s37, s35, s37
    s_lshl_b32 s37, s37, 2
    s_mul_hi_u32 s38, s36, 0x55555556
    s_mul_i32 s39, s38, 63
    s_mul_i32 s36, s36, 3
    s_add_u32 s39, s39, s36
    s_add_u32 s36, s37, 0
    s_mul_hi_u32 s38, s36, 0x55555556
    s_mul_i32 s38, s38, 6
    s_add_u32 s36, s36, s38
    s_add_u32 s36, s36, s39
    s_mul_i32 s40, s36, 18432
    s_add_u32 s36, s37, 1
    s_mul_hi_u32 s38, s36, 0x55555556
    s_mul_i32 s38, s38, 6
    s_add_u32 s36, s36, s38
    s_add_u32 s36, s36, s39
    s_mul_i32 s41, s36, 18432
    s_add_u32 s36, s37, 2
    s_mul_hi_u32 s38, s36, 0x55555556
    s_mul_i32 s38, s38, 6
    s_add_u32 s36, s36, s38
    s_add_u32 s36, s36, s39
    s_mul_i32 s42, s36, 18432
    s_add_u32 s36, s37, 3
    s_mul_hi_u32 s38, s36, 0x55555556
    s_mul_i32 s38, s38, 6
    s_add_u32 s36, s36, s38
    s_add_u32 s36, s36, s39
    s_mul_i32 s43, s36, 18432
    s_mul_i32 s46, s34, 72
    s_add_u32 s46, s46, s35
    s_mul_i32 s46, s46, 18432
    s_add_u32 s46, s46, 53600256
    s_mov_b32 s50, 1024
    s_mov_b32 s51, 9216
    s_mov_b32 s44, 3
    s_mov_b32 s45, 0
    s_branch H_RP
H_WO:
    s_sub_u32 s35, s35, 72
    s_mul_i32 s40, s35, 82944
    s_mov_b32 s36, 20736
    s_mov_b32 s44, 0
    s_mov_b32 s45, 0
    s_cmp_eq_u32 s35, 8
    s_cmov_b32 s40, 18432
    s_cmov_b32 s36, 165888
    s_cmov_b32 s44, 3
    s_cmov_b32 s45, 16
    s_add_u32 s41, s40, s36
    s_add_u32 s42, s41, s36
    s_add_u32 s43, s42, s36
    s_mul_i32 s46, s34, 165888
    s_lshl_b32 s47, s35, 11
    s_add_u32 s46, s46, s47
    s_add_u32 s46, s46, 58908672
    s_mov_b32 s50, 18432
    s_mov_b32 s51, 1024
H_RP:
    s_mul_i32 s34, s34, 288
    v_add_u32 v4, 0, v3
    v_mul_u32_u24 v5, 0xe38f, v4
    v_lshrrev_b32 v5, 20, v5
    v_mul_u32_u24 v6, 18, v5
    v_sub_u32 v6, v4, v6
    v_lshrrev_b32 v7, 1, v5
    v_xor_b32 v7, v7, v5
    v_and_b32 v7, 4, v7
    v_mul_u32_u24 v7, s44, v7
    v_xor_b32 v5, v5, v7
    v_lshrrev_b32 v7, 1, v5
    v_mad_u32_u24 v5, v7, s45, v5
    v_mul_u32_u24 v5, 1152, v5
    v_lshl_add_u32 v5, v6, 4, v5
    v_add_u32 v16, s34, v5
    v_add_u32 v4, 64, v3
    v_mul_u32_u24 v5, 0xe38f, v4
    v_lshrrev_b32 v5, 20, v5
    v_mul_u32_u24 v6, 18, v5
    v_sub_u32 v6, v4, v6
    v_lshrrev_b32 v7, 1, v5
    v_xor_b32 v7, v7, v5
    v_and_b32 v7, 4, v7
    v_mul_u32_u24 v7, s44, v7
    v_xor_b32 v5, v5, v7
    v_lshrrev_b32 v7, 1, v5
    v_mad_u32_u24 v5, v7, s45, v5
    v_mul_u32_u24 v5, 1152, v5
    v_lshl_add_u32 v5, v6, 4, v5
    v_add_u32 v17, s34, v5
    v_add_u32 v4, 128, v3
    v_mul_u32_u24 v5, 0xe38f, v4
    v_lshrrev_b32 v5, 20, v5
    v_mul_u32_u24 v6, 18, v5
    v_sub_u32 v6, v4, v6
    v_lshrrev_b32 v7, 1, v5
    v_xor_b32 v7, v7, v5
    v_and_b32 v7, 4, v7
    v_mul_u32_u24 v7, s44, v7
    v_xor_b32 v5, v5, v7
    v_lshrrev_b32 v7, 1, v5
    v_mad_u32_u24 v5, v7, s45, v5
    v_mul_u32_u24 v5, 1152, v5
    v_lshl_add_u32 v5, v6, 4, v5
    v_add_u32 v18, s34, v5
    v_add_u32 v4, 192, v3
    v_mul_u32_u24 v5, 0xe38f, v4
    v_lshrrev_b32 v5, 20, v5
    v_mul_u32_u24 v6, 18, v5
    v_sub_u32 v6, v4, v6
    v_lshrrev_b32 v7, 1, v5
    v_xor_b32 v7, v7, v5
    v_and_b32 v7, 4, v7
    v_mul_u32_u24 v7, s44, v7
    v_xor_b32 v5, v5, v7
    v_lshrrev_b32 v7, 1, v5
    v_mad_u32_u24 v5, v7, s45, v5
    v_mul_u32_u24 v5, 1152, v5
    v_lshl_add_u32 v5, v6, 4, v5
    v_add_u32 v19, s34, v5
    v_add_u32 v4, 256, v3
    v_mul_u32_u24 v5, 0xe38f, v4
    v_lshrrev_b32 v5, 20, v5
    v_mul_u32_u24 v6, 18, v5
    v_sub_u32 v6, v4, v6
    v_lshrrev_b32 v7, 1, v5
    v_xor_b32 v7, v7, v5
    v_and_b32 v7, 4, v7
    v_mul_u32_u24 v7, s44, v7
    v_xor_b32 v5, v5, v7
    v_lshrrev_b32 v7, 1, v5
    v_mad_u32_u24 v5, v7, s45, v5
    v_mul_u32_u24 v5, 1152, v5
    v_lshl_add_u32 v5, v6, 4, v5
    v_add_u32 v20, s34, v5
    buffer_load_dwordx4 v[112:115], v16, s[12:15], s40 offen
    buffer_load_dwordx4 v[116:119], v17, s[12:15], s40 offen
    buffer_load_dwordx4 v[120:123], v18, s[12:15], s40 offen
    buffer_load_dwordx4 v[124:127], v19, s[12:15], s40 offen
    s_mov_b32 exec_hi, 0
    buffer_load_dwordx4 v[128:131], v20, s[12:15], s40 offen
    s_mov_b32 exec_hi, -1
    buffer_load_dwordx4 v[132:135], v16, s[12:15], s41 offen
    buffer_load_dwordx4 v[136:139], v17, s[12:15], s41 offen
    buffer_load_dwordx4 v[140:143], v18, s[12:15], s41 offen
    buffer_load_dwordx4 v[144:147], v19, s[12:15], s41 offen
    s_mov_b32 exec_hi, 0
    buffer_load_dwordx4 v[148:151], v20, s[12:15], s41 offen
    s_mov_b32 exec_hi, -1
    buffer_load_dwordx4 v[152:155], v16, s[12:15], s42 offen
    buffer_load_dwordx4 v[156:159], v17, s[12:15], s42 offen
    buffer_load_dwordx4 v[160:163], v18, s[12:15], s42 offen
    buffer_load_dwordx4 v[164:167], v19, s[12:15], s42 offen
    s_mov_b32 exec_hi, 0
    buffer_load_dwordx4 v[168:171], v20, s[12:15], s42 offen
    s_mov_b32 exec_hi, -1
    buffer_load_dwordx4 v[172:175], v16, s[12:15], s43 offen
    buffer_load_dwordx4 v[176:179], v17, s[12:15], s43 offen
    buffer_load_dwordx4 v[180:183], v18, s[12:15], s43 offen
    buffer_load_dwordx4 v[184:187], v19, s[12:15], s43 offen
    s_mov_b32 exec_hi, 0
    buffer_load_dwordx4 v[188:191], v20, s[12:15], s43 offen
    s_mov_b32 exec_hi, -1
    s_waitcnt vmcnt(20)
    s_branch H_GO
H_NORP:
    s_waitcnt vmcnt(0)
H_GO:
    v_lshlrev_b32 v232, 16, v64
    v_and_b32 v233, 0xffff0000, v64
    v_lshlrev_b32 v234, 16, v65
    v_and_b32 v235, 0xffff0000, v65
    v_lshlrev_b32 v236, 16, v66
    v_and_b32 v237, 0xffff0000, v66
    v_lshlrev_b32 v238, 16, v67
    v_and_b32 v239, 0xffff0000, v67
    v_lshlrev_b32 v240, 16, v68
    v_and_b32 v241, 0xffff0000, v68
    v_lshlrev_b32 v242, 16, v69
    v_and_b32 v243, 0xffff0000, v69
    v_lshlrev_b32 v244, 16, v70
    v_and_b32 v245, 0xffff0000, v70
    v_lshlrev_b32 v246, 16, v71
    v_and_b32 v247, 0xffff0000, v71
    v_lshlrev_b32 v248, 16, v72
    v_and_b32 v249, 0xffff0000, v72
    v_add_f32 v26, v232, v233
    v_add_f32 v26, v26, v234
    v_add_f32 v26, v26, v235
    v_add_f32 v26, v26, v236
    v_add_f32 v26, v26, v237
    v_add_f32 v26, v26, v238
    v_add_f32 v26, v26, v239
    v_add_f32 v26, v26, v240
    v_add_f32 v26, v26, v241
    v_add_f32 v26, v26, v242
    v_add_f32 v26, v26, v243
    v_add_f32 v26, v26, v244
    v_add_f32 v26, v26, v245
    v_add_f32 v26, v26, v246
    v_add_f32 v26, v26, v247
    v_add_f32 v26, v26, v248
    v_add_f32 v26, v26, v249
    ds_swizzle_b32 v29, v26 offset:0x41f
    s_waitcnt lgkmcnt(0)
    v_add_f32 v26, v26, v29
    ds_swizzle_b32 v29, v26 offset:0x81f
    s_waitcnt lgkmcnt(0)
    v_add_f32 v26, v26, v29
    ds_swizzle_b32 v29, v26 offset:0x101f
    s_waitcnt lgkmcnt(0)
    v_add_f32 v26, v26, v29
    ds_swizzle_b32 v29, v26 offset:0x201f
    s_waitcnt lgkmcnt(0)
    v_add_f32 v26, v26, v29
    ds_swizzle_b32 v29, v26 offset:0x401f
    s_waitcnt lgkmcnt(0)
    v_add_f32 v26, v26, v29
    v_mul_f32 v26, 0x3ae38e39, v26
    v_cvt_pk_bf16_f32 v27, v26, v26
    v_lshlrev_b32 v27, 16, v27
    v_sub_f32 v28, v26, v27
    v_cvt_pk_bf16_f32 v24, v27, v28
    v_lshrrev_b32 v7, 1, v11
    v_xor_b32 v7, v7, v11
    v_and_b32 v7, 4, v7
    v_mul_u32_u24 v7, 3, v7
    v_xor_b32 v12, v11, v7
    v_lshlrev_b32 v12, 1, v12
    v_cmp_eq_u32 vcc, 0, v1
    s_and_saveexec_b64 s[48:49], vcc
    s_mov_b32 s33, 59572224
    buffer_store_short v24, v12, s[20:23], s33 offen sc1
    buffer_store_short_d16_hi v24, v12, s[20:23], s33 offen offset:1152 sc1
    s_mov_b64 exec, -1
    s_cmp_lt_u32 s32, 324
    s_cbranch_scc0 H_NORP2
    v_lshlrev_b32 v4, 4, v3
    s_waitcnt vmcnt(2)
    s_mul_i32 s36, s3, 18432
    v_add_u32 v5, s36, v4
    ds_write_b128 v5, v[112:115] offset:0
    ds_write_b128 v5, v[116:119] offset:1024
    ds_write_b128 v5, v[120:123] offset:2048
    ds_write_b128 v5, v[124:127] offset:3072
    s_mov_b32 exec_hi, 0
    ds_write_b128 v5, v[128:131] offset:4096
    s_mov_b32 exec_hi, -1
    ds_write_b128 v5, v[132:135] offset:4608
    ds_write_b128 v5, v[136:139] offset:5632
    ds_write_b128 v5, v[140:143] offset:6656
    ds_write_b128 v5, v[144:147] offset:7680
    s_mov_b32 exec_hi, 0
    ds_write_b128 v5, v[148:151] offset:8704
    s_mov_b32 exec_hi, -1
    ds_write_b128 v5, v[152:155] offset:9216
    ds_write_b128 v5, v[156:159] offset:10240
    ds_write_b128 v5, v[160:163] offset:11264
    ds_write_b128 v5, v[164:167] offset:12288
    s_mov_b32 exec_hi, 0
    ds_write_b128 v5, v[168:171] offset:13312
    s_mov_b32 exec_hi, -1
    ds_write_b128 v5, v[172:175] offset:13824
    ds_write_b128 v5, v[176:179] offset:14848
    ds_write_b128 v5, v[180:183] offset:15872
    ds_write_b128 v5, v[184:187] offset:16896
    s_mov_b32 exec_hi, 0
    ds_write_b128 v5, v[188:191] offset:17920
    s_mov_b32 exec_hi, -1
    v_mov_b32 v9, v4
    v_and_b32 v1, 63, v0
    v_and_b32 v3, 15, v1
    v_lshrrev_b32 v4, 4, v1
    v_and_b32 v5, 3, v1
    v_lshrrev_b32 v6, 2, v3
    v_and_b32 v7, 1, v4
    v_lshl_add_u32 v6, v7, 2, v6
    v_lshrrev_b32 v7, 1, v4
    v_lshl_add_u32 v6, v7, 4, v6
    v_mul_u32_u24 v6, 288, v6
    v_lshl_add_u32 v10, v5, 3, v6
    v_add_u32 v10, s36, v10
    s_waitcnt lgkmcnt(0)
    ds_read_b64_tr_b16 v[112:113], v10 offset:0
    ds_read_b64_tr_b16 v[114:115], v10 offset:2304
    ds_read_b64_tr_b16 v[116:117], v10 offset:9216
    ds_read_b64_tr_b16 v[118:119], v10 offset:11520
    s_waitcnt lgkmcnt(0)
    s_add_u32 s47, s46, s51
    buffer_store_dwordx4 v[112:115], v9, s[20:23], s46 offen sc1
    buffer_store_dwordx4 v[116:119], v9, s[20:23], s47 offen sc1
    s_add_u32 s46, s46, s50
    ds_read_b64_tr_b16 v[120:121], v10 offset:32
    ds_read_b64_tr_b16 v[122:123], v10 offset:2336
    ds_read_b64_tr_b16 v[124:125], v10 offset:9248
    ds_read_b64_tr_b16 v[126:127], v10 offset:11552
    s_waitcnt lgkmcnt(0)
    s_add_u32 s47, s46, s51
    buffer_store_dwordx4 v[120:123], v9, s[20:23], s46 offen sc1
    buffer_store_dwordx4 v[124:127], v9, s[20:23], s47 offen sc1
    s_add_u32 s46, s46, s50
    ds_read_b64_tr_b16 v[128:129], v10 offset:64
    ds_read_b64_tr_b16 v[130:131], v10 offset:2368
    ds_read_b64_tr_b16 v[132:133], v10 offset:9280
    ds_read_b64_tr_b16 v[134:135], v10 offset:11584
    s_waitcnt lgkmcnt(0)
    s_add_u32 s47, s46, s51
    buffer_store_dwordx4 v[128:131], v9, s[20:23], s46 offen sc1
    buffer_store_dwordx4 v[132:135], v9, s[20:23], s47 offen sc1
    s_add_u32 s46, s46, s50
    ds_read_b64_tr_b16 v[136:137], v10 offset:96
    ds_read_b64_tr_b16 v[138:139], v10 offset:2400
    ds_read_b64_tr_b16 v[140:141], v10 offset:9312
    ds_read_b64_tr_b16 v[142:143], v10 offset:11616
    s_waitcnt lgkmcnt(0)
    s_add_u32 s47, s46, s51
    buffer_store_dwordx4 v[136:139], v9, s[20:23], s46 offen sc1
    buffer_store_dwordx4 v[140:143], v9, s[20:23], s47 offen sc1
    s_add_u32 s46, s46, s50
    ds_read_b64_tr_b16 v[144:145], v10 offset:128
    ds_read_b64_tr_b16 v[146:147], v10 offset:2432
    ds_read_b64_tr_b16 v[148:149], v10 offset:9344
    ds_read_b64_tr_b16 v[150:151], v10 offset:11648
    s_waitcnt lgkmcnt(0)
    s_add_u32 s47, s46, s51
    buffer_store_dwordx4 v[144:147], v9, s[20:23], s46 offen sc1
    buffer_store_dwordx4 v[148:151], v9, s[20:23], s47 offen sc1
    s_add_u32 s46, s46, s50
    ds_read_b64_tr_b16 v[152:153], v10 offset:160
    ds_read_b64_tr_b16 v[154:155], v10 offset:2464
    ds_read_b64_tr_b16 v[156:157], v10 offset:9376
    ds_read_b64_tr_b16 v[158:159], v10 offset:11680
    s_waitcnt lgkmcnt(0)
    s_add_u32 s47, s46, s51
    buffer_store_dwordx4 v[152:155], v9, s[20:23], s46 offen sc1
    buffer_store_dwordx4 v[156:159], v9, s[20:23], s47 offen sc1
    s_add_u32 s46, s46, s50
    ds_read_b64_tr_b16 v[160:161], v10 offset:192
    ds_read_b64_tr_b16 v[162:163], v10 offset:2496
    ds_read_b64_tr_b16 v[164:165], v10 offset:9408
    ds_read_b64_tr_b16 v[166:167], v10 offset:11712
    s_waitcnt lgkmcnt(0)
    s_add_u32 s47, s46, s51
    buffer_store_dwordx4 v[160:163], v9, s[20:23], s46 offen sc1
    buffer_store_dwordx4 v[164:167], v9, s[20:23], s47 offen sc1
    s_add_u32 s46, s46, s50
    ds_read_b64_tr_b16 v[168:169], v10 offset:224
    ds_read_b64_tr_b16 v[170:171], v10 offset:2528
    ds_read_b64_tr_b16 v[172:173], v10 offset:9440
    ds_read_b64_tr_b16 v[174:175], v10 offset:11744
    s_waitcnt lgkmcnt(0)
    s_add_u32 s47, s46, s51
    buffer_store_dwordx4 v[168:171], v9, s[20:23], s46 offen sc1
    buffer_store_dwordx4 v[172:175], v9, s[20:23], s47 offen sc1
    s_add_u32 s46, s46, s50
    ds_read_b64_tr_b16 v[176:177], v10 offset:256
    ds_read_b64_tr_b16 v[178:179], v10 offset:2560
    ds_read_b64_tr_b16 v[180:181], v10 offset:9472
    ds_read_b64_tr_b16 v[182:183], v10 offset:11776
    s_waitcnt lgkmcnt(0)
    s_add_u32 s47, s46, s51
    buffer_store_dwordx4 v[176:179], v9, s[20:23], s46 offen sc1
    buffer_store_dwordx4 v[180:183], v9, s[20:23], s47 offen sc1
    s_add_u32 s46, s46, s50
H_NORP2:
    s_waitcnt vmcnt(0)
    s_barrier
    s_cmp_eq_u32 s3, 4
    s_cbranch_scc0 SKIP_9
    v_mov_b32 v20, 0
    v_mov_b32 v21, 1
    s_mov_b32 s59, 0
POLL_10:
    buffer_load_dword v22, v20, s[16:19], 0 offen sc1
    s_waitcnt vmcnt(0)
POLLC_12:
    v_cmp_lt_u32 vcc, v22, v21
    s_add_u32 s59, s59, 1
    s_cbranch_vccz POLLD_11
    s_sleep 1
    s_cmp_lt_u32 s59, 2000000
    s_cbranch_scc1 POLL_10
POLLD_11:
    s_mov_b32 s34, 256
    v_mov_b32 v2, 1
    s_mov_b64 exec, 1
    buffer_atomic_add v2, off, s[20:23], s34
    s_mov_b64 exec, -1
SKIP_9:
PH_B:
    v_and_b32 v1, 63, v0
    v_mov_b32 v19, 0
    s_and_b32 s61, s3, 3
    s_lshl_b32 s61, s61, 11
    s_add_u32 s61, s61, 153600
    v_lshl_add_u32 v17, v1, 4, s61
    v_bfe_u32 v14, v1, 2, 3
    v_lshrrev_b32 v15, 5, v1
    v_lshl_add_u32 v14, v15, 4, v14
    v_lshlrev_b32 v14, 5, v14
    v_and_b32 v15, 3, v1
    v_lshl_add_u32 v14, v15, 3, v14
    v_add_u32 v18, s61, v14
    s_lshl_b32 s60, s2, 2
    s_and_b32 s61, s3, 3
    s_add_u32 s60, s60, s61
    s_cmp_lt_u32 s60, 864
    s_cbranch_scc0 B_PWD
    s_mul_hi_u32 s61, s60, 0x55555556
    s_mul_i32 s62, s61, 3
    s_sub_u32 s62, s60, s62
    s_mul_hi_u32 s63, s61, 0x1c71c71d
    s_mul_i32 s64, s63, 9
    s_sub_u32 s64, s61, s64
    s_mul_i32 s65, s64, 589824
    s_mul_i32 s66, s63, 288
    s_add_u32 s65, s65, s66
    s_mul_i32 s66, s62, 96
    s_add_u32 s65, s65, s66
    s_add_u32 s66, s65, 294912
    s_mul_i32 s67, s63, 27
    s_mul_i32 s68, s62, 9
    s_add_u32 s67, s67, s68
    s_add_u32 s67, s67, s64
    s_mul_i32 s67, s67, 12288
    s_add_u32 s67, s67, 42967040
    s_lshl_b32 s68, s63, 8
    s_add_u32 s68, s68, 49152
    v_lshrrev_b32 v14, 1, v1
    v_lshrrev_b32 v13, 1, v14
    v_xor_b32 v13, v13, v14
    v_and_b32 v13, 4, v13
    v_mul_u32_u24 v13, 3, v13
    v_xor_b32 v14, v14, v13
    v_mul_u32_u24 v14, 9216, v14
    v_and_b32 v15, 1, v1
    v_lshl_add_u32 v16, v15, 4, v14
    s_mov_b32 s8, s84
    s_mov_b32 s9, s85
    s_mov_b32 s10, 0x510000
    s_mov_b32 s11, 0x00020000
    s_mov_b32 s12, s86
    s_mov_b32 s13, s87
    s_mov_b32 s14, 0x510000
    s_mov_b32 s15, 0x00020000
    s_branch B_PDONE
B_PWD:
    s_sub_u32 s61, s60, 736
    s_and_b32 s62, s61, 3
    s_lshr_b32 s61, s61, 2
    s_mul_hi_u32 s36, s61, 0x2aaaaaab
    s_mul_i32 s37, s36, 6
    s_sub_u32 s37, s61, s37
    s_lshl_b32 s37, s37, 2
    s_mul_hi_u32 s38, s36, 0x55555556
    s_mul_i32 s39, s38, 63
    s_mul_i32 s36, s36, 3
    s_add_u32 s39, s39, s36
    s_add_u32 s36, s37, 0
    s_mul_hi_u32 s38, s36, 0x55555556
    s_mul_i32 s38, s38, 6
    s_add_u32 s36, s36, s38
    s_add_u32 s36, s36, s39
    s_mul_i32 s63, s36, 18432
    s_add_u32 s36, s37, 1
    s_mul_hi_u32 s38, s36, 0x55555556
    s_mul_i32 s38, s38, 6
    s_add_u32 s36, s36, s38
    s_add_u32 s36, s36, s39
    s_mul_i32 s64, s36, 18432
    s_add_u32 s36, s37, 2
    s_mul_hi_u32 s38, s36, 0x55555556
    s_mul_i32 s38, s38, 6
    s_add_u32 s36, s36, s38
    s_add_u32 s36, s36, s39
    s_mul_i32 s65, s36, 18432
    s_add_u32 s36, s37, 3
    s_mul_hi_u32 s38, s36, 0x55555556
    s_mul_i32 s38, s38, 6
    s_add_u32 s36, s36, s38
    s_add_u32 s36, s36, s39
    s_mul_i32 s66, s36, 18432
    s_mul_i32 s67, s62, 72
    s_add_u32 s67, s67, s61
    s_mul_i32 s67, s67, 18432
    s_add_u32 s67, s67, 53600256
    s_mul_i32 s62, s62, 288
    s_mov_b32 s68, 0
    v_bfe_u32 v14, v1, 1, 4
    v_lshrrev_b32 v13, 1, v14
    v_xor_b32 v13, v13, v14
    v_and_b32 v13, 4, v13
    v_mul_u32_u24 v13, 3, v13
    v_xor_b32 v14, v14, v13
    v_mul_u32_u24 v14, 1152, v14
    v_and_b32 v15, 1, v1
    v_lshl_add_u32 v14, v15, 4, v14
    v_add_u32 v16, s63, v14
    v_add_u32 v19, s65, v14
    s_mov_b32 exec_lo, 0
    v_add_u32 v16, s64, v14
    v_add_u32 v19, s66, v14
    s_mov_b32 exec_lo, -1
    s_mov_b32 s8, s88
    s_mov_b32 s9, s89
    s_mov_b32 s10, 0x510000
    s_mov_b32 s11, 0x00020000
    s_mov_b32 s12, s88
    s_mov_b32 s13, s89
    s_mov_b32 s14, 0x510000
    s_mov_b32 s15, 0x00020000
B_PDONE:
    s_and_b32 s30, s2, 7
    s_lshl_b32 s30, s30, 2
    s_bfe_u32 s31, s2, 0x20003
    s_add_u32 s30, s30, s31
    s_lshr_b32 s55, s2, 5
    s_lshr_b32 s48, s3, 2
    s_and_b32 s49, s3, 3
    s_lshl_b32 s31, s55, 3
    s_lshl_b32 s32, s49, 1
    s_add_u32 s31, s31, s32
    s_xor_b32 s35, s31, 1
    v_lshlrev_b32 v3, 4, v1
    v_and_b32 v7, 31, v1
    v_lshlrev_b32 v8, 2, v7
    s_lshl_b32 s32, s30, 16
    s_add_u32 s32, s32, 196608
    s_lshl_b32 s36, s35, 10
    s_add_u32 s36, s36, s32
    s_lshl_b32 s33, s31, 10
    s_add_u32 s32, s32, s33
    s_lshl_b32 s33, s30, 13
    s_add_u32 s33, s33, 2293760
    s_lshl_b32 s37, s35, 7
    s_add_u32 s37, s37, s33
    s_lshl_b32 s34, s31, 7
    s_add_u32 s33, s33, s34
    s_mul_i32 s34, s30, 151552
    s_add_u32 s34, s34, 2555904
    s_lshl_b32 s40, s3, 10
    s_add_u32 s41, s40, 73728
    s_add_u32 s42, s40, 77824
    s_add_u32 s43, s40, 63488
    s_cmp_lt_u32 s3, 4
    s_cmov_b32 s42, s43
    s_add_u32 s43, s40, 8192
    s_cmp_lt_u32 s3, 2
    s_cmov_b32 s42, s43
    s_lshl_b32 s43, s48, 15
    v_add_u32 v9, s43, v3
    s_lshl_b32 s43, s48, 12
    s_add_u32 s43, s43, 65536
    v_add_u32 v10, s43, v8
    v_lshrrev_b32 v12, 5, v1
    v_mul_u32_u24 v13, 304, v12
    v_cmp_lt_u32 vcc, 18, v7
    v_lshl_add_u32 v11, v7, 4, v13
    s_mul_i32 s43, s48, 38912
    s_add_u32 s43, s43, 73728
    v_add_u32 v11, s43, v11
    v_mov_b32 v13, 0x100000
    v_cndmask_b32 v11, v11, v13, vcc
    v_mov_b32 v41, 0
    v_mov_b32 v169, 0
    v_mov_b32 v45, 0
    v_mov_b32 v173, 0
    v_mov_b32 v128, 0
    v_mov_b32 v129, 0
    v_mov_b32 v130, 0
    v_mov_b32 v131, 0
    v_mov_b32 v132, 0
    v_mov_b32 v133, 0
    v_mov_b32 v134, 0
    v_mov_b32 v135, 0
    v_mov_b32 v136, 0
    v_mov_b32 v137, 0
    v_mov_b32 v138, 0
    v_mov_b32 v139, 0
    v_mov_b32 v140, 0
    v_mov_b32 v141, 0
    v_mov_b32 v142, 0
    v_mov_b32 v143, 0
    v_mov_b32 v144, 0
    v_mov_b32 v145, 0
    v_mov_b32 v146, 0
    v_mov_b32 v147, 0
    v_mov_b32 v148, 0
    v_mov_b32 v149, 0
    v_mov_b32 v150, 0
    v_mov_b32 v151, 0
    v_mov_b32 v152, 0
    v_mov_b32 v153, 0
    v_mov_b32 v154, 0
    v_mov_b32 v155, 0
    v_mov_b32 v156, 0
    v_mov_b32 v157, 0
    v_mov_b32 v158, 0
    v_mov_b32 v159, 0
    v_mov_b32 v120, 0
    v_mov_b32 v121, 0
    v_mov_b32 v122, 0
    v_mov_b32 v123, 0
    v_mov_b32 v124, 0
    v_mov_b32 v125, 0
    v_mov_b32 v126, 0
    v_mov_b32 v127, 0
    v_mov_b32 v180, 0
    v_mov_b32 v188, 0
    v_mov_b32 v181, 0
    v_mov_b32 v189, 0
    v_mov_b32 v182, 0
    v_mov_b32 v190, 0
    v_mov_b32 v183, 0
    v_mov_b32 v191, 0
    v_mov_b32 v192, 0
    v_mov_b32 v193, 0
    s_mov_b32 s50, 1
    s_mov_b32 s51, 1
    v_cmp_eq_u32 s[52:53], 0, v12
    s_and_b32 s74, s2, 1
    s_lshl_b32 s74, s74, 3
    s_add_u32 s74, s74, s55
    s_bfe_u32 s43, s2, 0x20003
    s_bfe_u32 s44, s2, 0x20001
    s_lshl_b32 s75, s74, 2
    s_add_u32 s74, s75, s49
    s_mul_i32 s74, s74, 36864
    s_add_u32 s75, s75, s43
    s_lshl_b32 s75, s75, 2
    s_add_u32 s75, s75, s49
    s_lshl_b32 s75, s75, 8
    s_add_u32 s75, s75, 65536
    s_mul_i32 s43, s43, 4608
    s_add_u32 s74, s74, s43
    s_mul_i32 s43, s44, 2359296
    s_add_u32 s74, s74, s43
    s_add_u32 s74, s74, 33529856
    s_cmp_eq_u32 s44, s49
    s_cmov_b32 s75, -1
    v_mov_b32 v13, 163328
    v_mov_b32 v14, 0
    v_mov_b32 v15, 0
    ds_write_b64 v13, v[14:15]
    ds_write_b64 v13, v[14:15] offset:8
    ds_write_b64 v13, v[14:15] offset:16
    s_waitcnt lgkmcnt(0)
    s_lshr_b32 s43, s30, 3
    s_lshl_b32 s43, s43, 2
    s_lshl_b32 s43, s43, 8
    s_add_u32 s43, s43, 32768
    s_add_u32 s44, s43, 4096
    s_add_u32 s45, s43, 8192
    v_and_b32 v26, 3, v1
    v_lshlrev_b32 v26, 8, v26
    v_bfe_u32 v27, v1, 2, 1
    v_lshl_add_u32 v26, v27, 12, v26
    v_add_u32 v26, s44, v26
    v_mov_b32 v27, 4
    s_cmp_eq_u32 s3, 4
    s_cbranch_scc0 SKIP_13
    s_lshr_b32 s46, s55, 1
    s_lshl_b32 s46, s46, 8
    s_add_u32 s43, s43, s46
    v_mov_b32 v20, s43
    v_mov_b32 v21, 4
    v_writelane_b32 v20, s44, 1
    v_writelane_b32 v21, 4, 1
    v_writelane_b32 v20, s45, 2
    v_writelane_b32 v21, 4, 2
    s_mov_b32 s59, 0
POLL_14:
    buffer_load_dword v22, v20, s[20:23], 0 offen sc1
    s_waitcnt vmcnt(0)
POLLC_16:
    v_cmp_lt_u32 vcc, v22, v21
    s_add_u32 s59, s59, 1
    s_cbranch_vccz POLLD_15
    s_sleep 1
    s_cmp_lt_u32 s59, 2000000
    s_cbranch_scc1 POLL_14
POLLD_15:
SKIP_13:
    s_barrier
    buffer_load_dwordx4 v[32:35], v3, s[20:23], s32 offen sc1
    buffer_load_dwordx4 v[160:163], v3, s[20:23], s34 offen sc1
    buffer_load_dwordx4 v[36:39], v3, s[20:23], s36 offen sc1
    s_add_u32 s47, s34, 65536
    buffer_load_dword v40, v8, s[20:23], s33 offen sc1
    buffer_load_dword v44, v8, s[20:23], s37 offen sc1
    buffer_load_dword v168, v8, s[20:23], s47 offen sc1
    s_mov_b32 m0, s40
    s_add_u32 s47, s34, s40
    buffer_load_dwordx4 v3, s[20:23], s47 offen sc1 lds
    s_mov_b32 m0, s41
    s_add_u32 s47, s34, s41
    buffer_load_dwordx4 v3, s[20:23], s47 offen sc1 lds
    s_mov_b32 m0, s42
    s_add_u32 s47, s34, s42
    buffer_load_dwordx4 v3, s[20:23], s47 offen sc1 lds
    s_cmp_eq_u32 s48, 0
    s_cbranch_scc1 B_LOW
    s_lshl_b32 s40, s49, 14
    s_setprio 3
    buffer_load_dword v28, v26, s[20:23], 0 offen sc1
    s_waitcnt vmcnt(0)
    s_barrier
    s_mov_b32 s59, 0
    s_branch POLLC_19
POLL_17:
    buffer_load_dword v28, v26, s[20:23], 0 offen sc1
    s_waitcnt vmcnt(0)
POLLC_19:
    v_cmp_lt_u32 vcc, v28, v27
    s_add_u32 s59, s59, 1
    s_cbranch_vccz POLLD_18
    s_sleep 1
    s_cmp_lt_u32 s59, 2000000
    s_cbranch_scc1 POLL_17
POLLD_18:
    s_add_u32 s41, s40, 10240
    s_mov_b32 m0, s41
    s_add_u32 s47, s34, s41
    buffer_load_dwordx4 v3, s[20:23], s47 offen offset:0 sc1 lds
    buffer_load_dwordx4 v3, s[20:23], s47 offen offset:1024 sc1 lds
    buffer_load_dwordx4 v3, s[20:23], s47 offen offset:2048 sc1 lds
    buffer_load_dwordx4 v3, s[20:23], s47 offen offset:3072 sc1 lds
    s_add_u32 s41, s40, 86016
    s_mov_b32 m0, s41
    s_add_u32 s47, s34, s41
    buffer_load_dwordx4 v3, s[20:23], s47 offen offset:0 sc1 lds
    buffer_load_dwordx4 v3, s[20:23], s47 offen offset:1024 sc1 lds
    buffer_load_dwordx4 v3, s[20:23], s47 offen offset:2048 sc1 lds
    buffer_load_dwordx4 v3, s[20:23], s47 offen offset:3072 sc1 lds
    s_add_u32 s41, s40, 14336
    s_mov_b32 m0, s41
    s_add_u32 s47, s34, s41
    buffer_load_dwordx4 v3, s[20:23], s47 offen offset:0 sc1 lds
    buffer_load_dwordx4 v3, s[20:23], s47 offen offset:1024 sc1 lds
    buffer_load_dwordx4 v3, s[20:23], s47 offen offset:2048 sc1 lds
    buffer_load_dwordx4 v3, s[20:23], s47 offen offset:3072 sc1 lds
    s_add_u32 s41, s40, 90112
    s_mov_b32 m0, s41
    s_add_u32 s47, s34, s41
    buffer_load_dwordx4 v3, s[20:23], s47 offen offset:0 sc1 lds
    buffer_load_dwordx4 v3, s[20:23], s47 offen offset:1024 sc1 lds
    buffer_load_dwordx4 v3, s[20:23], s47 offen offset:2048 sc1 lds
    buffer_load_dwordx4 v3, s[20:23], s47 offen offset:3072 sc1 lds
    s_add_u32 s41, s40, 18432
    s_mov_b32 m0, s41
    s_add_u32 s47, s34, s41
    buffer_load_dwordx4 v3, s[20:23], s47 offen offset:0 sc1 lds
    buffer_load_dwordx4 v3, s[20:23], s47 offen offset:1024 sc1 lds
    buffer_load_dwordx4 v3, s[20:23], s47 offen offset:2048 sc1 lds
    buffer_load_dwordx4 v3, s[20:23], s47 offen offset:3072 sc1 lds
    s_add_u32 s41, s40, 94208
    s_mov_b32 m0, s41
    s_add_u32 s47, s34, s41
    buffer_load_dwordx4 v3, s[20:23], s47 offen offset:0 sc1 lds
    buffer_load_dwordx4 v3, s[20:23], s47 offen offset:1024 sc1 lds
    buffer_load_dwordx4 v3, s[20:23], s47 offen offset:2048 sc1 lds
    buffer_load_dwordx4 v3, s[20:23], s47 offen offset:3072 sc1 lds
    s_add_u32 s41, s40, 22528
    s_mov_b32 m0, s41
    s_add_u32 s47, s34, s41
    buffer_load_dwordx4 v3, s[20:23], s47 offen offset:0 sc1 lds
    buffer_load_dwordx4 v3, s[20:23], s47 offen offset:1024 sc1 lds
    buffer_load_dwordx4 v3, s[20:23], s47 offen offset:2048 sc1 lds
    buffer_load_dwordx4 v3, s[20:23], s47 offen offset:3072 sc1 lds
    s_add_u32 s41, s40, 98304
    s_mov_b32 m0, s41
    s_add_u32 s47, s34, s41
    buffer_load_dwordx4 v3, s[20:23], s47 offen offset:0 sc1 lds
    buffer_load_dwordx4 v3, s[20:23], s47 offen offset:1024 sc1 lds
    buffer_load_dwordx4 v3, s[20:23], s47 offen offset:2048 sc1 lds
    buffer_load_dwordx4 v3, s[20:23], s47 offen offset:3072 sc1 lds
    s_mov_b32 s51, -1
    s_mov_b32 s43, 256
    buffer_load_dword v22, off, s[20:23], s43 sc1
    s_waitcnt vmcnt(0)
    v_mov_b32 v24, 163344
    v_mov_b32 v25, 1
    s_mov_b64 exec, 1
    ds_add_u32 v24, v25
    s_mov_b64 exec, -1
    v_mov_b32 v24, 163344
    s_mov_b32 s59, 0
LW_20:
    ds_read_b32 v25, v24
    s_waitcnt lgkmcnt(0)
    v_cmp_gt_u32 vcc, 4, v25
    s_add_u32 s59, s59, 1
    s_cbranch_vccz LWD_21
    s_sleep 1
    s_cmp_lt_u32 s59, 16000000
    s_cbranch_scc1 LW_20
LWD_21:
    s_branch B_GO
B_LOW:
    s_setprio 2
    v_mov_b32 v20, 256
    v_mov_b32 v14, 0xff800000
    v_mov_b32 v15, 0xff800000
    s_mov_b32 s54, 0
    s_mov_b32 s69, 1
    s_waitcnt vmcnt(3)
    v_cndmask_b32 v40, 0, v40, s[52:53]
    v_cndmask_b32 v44, 0, v44, s[52:53]
    s_branch B_A2
B_GO:
    v_mov_b32 v20, 256
    v_mov_b32 v21, 64
    v_cndmask_b32 v40, 0, v40, s[52:53]
    v_cndmask_b32 v44, 0, v44, s[52:53]
B_A:
    s_mov_b32 s69, 0
    v_mov_b32 v4, v9
    v_mov_b32 v5, v10
    v_mov_b32 v14, 0xff800000
    v_mov_b32 v15, 0xff800000
    s_sub_u32 s54, s50, 1
    s_lshl_b32 s43, s54, 10
    v_add_u32 v4, s43, v4
    s_lshl_b32 s43, s54, 7
    v_add_u32 v5, s43, v5
    s_mov_b32 s54, 0
B_A1:
    ds_read_b128 v[160:163], v4
    ds_read_b32 v168, v5
    v_subrev_u32 v4, 1024, v4
    v_subrev_u32 v5, 128, v5
    s_waitcnt lgkmcnt(0)
B_A2:
    v_mfma_f32_32x32x16_bf16 v[80:95], v[160:163], v[32:35], 0
    v_mfma_f32_32x32x16_bf16 v[96:111], v[160:163], v[36:39], 0
    v_mfma_f32_32x32x8_bf16 v[80:95], v[168:169], v[40:41], v[80:95]
    v_mfma_f32_32x32x8_bf16 v[96:111], v[168:169], v[44:45], v[96:111]
    s_add_u32 s54, s54, 1
    s_nop 10
    v_max3_f32 v14, v14, v80, v81
    v_max3_f32 v14, v14, v82, v83
    v_max3_f32 v14, v14, v84, v85
    v_max3_f32 v14, v14, v86, v87
    v_max3_f32 v14, v14, v88, v89
    v_max3_f32 v14, v14, v90, v91
    v_max3_f32 v14, v14, v92, v93
    v_max3_f32 v14, v14, v94, v95
    v_max3_f32 v15, v15, v96, v97
    v_max3_f32 v15, v15, v98, v99
    v_max3_f32 v15, v15, v100, v101
    v_max3_f32 v15, v15, v102, v103
    v_max3_f32 v15, v15, v104, v105
    v_max3_f32 v15, v15, v106, v107
    v_max3_f32 v15, v15, v108, v109
    v_max3_f32 v15, v15, v110, v111
    s_cmp_lt_u32 s54, s50
    s_cbranch_scc1 B_A1
    v_mov_b32 v24, v14
    v_mov_b32 v25, v15
    s_nop 1
    v_permlane32_swap_b32 v14, v24
    v_permlane32_swap_b32 v15, v25
    s_nop 0
    v_max_f32 v14, v14, v24
    v_max_f32 v15, v15, v25
    v_sub_f32 v80, v80, v14
    v_sub_f32 v81, v81, v14
    v_sub_f32 v82, v82, v14
    v_sub_f32 v83, v83, v14
    v_sub_f32 v84, v84, v14
    v_sub_f32 v85, v85, v14
    v_sub_f32 v86, v86, v14
    v_sub_f32 v87, v87, v14
    v_sub_f32 v88, v88, v14
    v_sub_f32 v89, v89, v14
    v_sub_f32 v90, v90, v14
    v_sub_f32 v91, v91, v14
    v_sub_f32 v92, v92, v14
    v_sub_f32 v93, v93, v14
    v_sub_f32 v94, v94, v14
    v_sub_f32 v95, v95, v14
    v_sub_f32 v64, 0, v15
    v_sub_f32 v65, 0, v15
    v_sub_f32 v66, 0, v15
    v_sub_f32 v67, 0, v15
    v_sub_f32 v68, 0, v15
    v_sub_f32 v69, 0, v15
    v_sub_f32 v70, 0, v15
    v_sub_f32 v71, 0, v15
    v_sub_f32 v72, 0, v15
    v_sub_f32 v73, 0, v15
    v_sub_f32 v74, 0, v15
    v_sub_f32 v75, 0, v15
    v_sub_f32 v76, 0, v15
    v_sub_f32 v77, 0, v15
    v_sub_f32 v78, 0, v15
    v_sub_f32 v79, 0, v15
    s_cmp_eq_u32 s69, 0
    s_cbranch_scc1 B_NB1
    s_waitcnt vmcnt(0)
    s_barrier
B_NB1:
    ds_read_b128 v[164:167], v9 offset:1024
    ds_read_b32 v172, v10 offset:128
    ds_read_b128 v[176:179], v11
    ds_read_b128 v[184:187], v11 offset:608
    v_sub_f32 v48, 0, v14
    v_sub_f32 v49, 0, v14
    v_sub_f32 v50, 0, v14
    v_sub_f32 v51, 0, v14
    v_sub_f32 v52, 0, v14
    v_sub_f32 v53, 0, v14
    v_sub_f32 v54, 0, v14
    v_sub_f32 v55, 0, v14
    v_sub_f32 v56, 0, v14
    v_sub_f32 v57, 0, v14
    v_sub_f32 v58, 0, v14
    v_sub_f32 v59, 0, v14
    v_sub_f32 v60, 0, v14
    v_sub_f32 v61, 0, v14
    v_sub_f32 v62, 0, v14
    v_sub_f32 v63, 0, v14
    v_mov_b32 v4, v9
    v_mov_b32 v5, v10
    v_mov_b32 v6, v11
    s_mov_b32 s54, 0
    s_cmp_eq_u32 s48, 0
    s_cbranch_scc1 B_NOP
    s_setprio 1
B_NOP:
    .p2align 6
B_LOOP:
    s_cmp_eq_u32 s54, s51
    s_cbranch_scc1 B_HOOK
B_HOOKBACK:
    v_mfma_f32_32x32x16_bf16 v[96:111], v[160:163], v[36:39], v[64:79]
    v_exp_f32 v80, v80
    v_cvt_pk_bf16_f32 v127, v192, v193
    v_exp_f32 v81, v81
    v_exp_f32 v82, v82
    v_cvt_pk_bf16_f32 v112, v80, v81
    v_exp_f32 v83, v83
    v_mfma_f32_32x32x8_bf16 v[96:111], v[168:169], v[44:45], v[96:111]
    v_exp_f32 v84, v84
    v_cvt_pk_bf16_f32 v113, v82, v83
    v_exp_f32 v85, v85
    v_exp_f32 v86, v86
    v_cvt_pk_bf16_f32 v114, v84, v85
    v_exp_f32 v87, v87
    v_mfma_f32_32x32x16_bf16 v[144:159], v[180:183], v[120:123], v[144:159]
    v_exp_f32 v88, v88
    v_cvt_pk_bf16_f32 v115, v86, v87
    v_exp_f32 v89, v89
    v_exp_f32 v90, v90
    v_cvt_pk_bf16_f32 v116, v88, v89
    v_exp_f32 v91, v91
    v_mfma_f32_32x32x16_bf16 v[144:159], v[188:191], v[124:127], v[144:159]
    s_waitcnt lgkmcnt(0)
    v_exp_f32 v92, v92
    v_cvt_pk_bf16_f32 v117, v90, v91
    v_exp_f32 v93, v93
    v_exp_f32 v192, v94
    v_cvt_pk_bf16_f32 v118, v92, v93
    v_exp_f32 v193, v95
    v_mfma_f32_32x32x16_bf16 v[80:95], v[164:167], v[32:35], v[48:63]
    ds_read_b128 v[160:163], v4 offset:2048
    v_exp_f32 v96, v96
    v_cvt_pk_bf16_f32 v119, v192, v193
    v_exp_f32 v97, v97
    v_exp_f32 v98, v98
    v_cvt_pk_bf16_f32 v120, v96, v97
    v_exp_f32 v99, v99
    v_mfma_f32_32x32x8_bf16 v[80:95], v[172:173], v[40:41], v[80:95]
    ds_read_b32 v168, v5 offset:256
    v_exp_f32 v100, v100
    v_cvt_pk_bf16_f32 v121, v98, v99
    v_exp_f32 v101, v101
    v_exp_f32 v102, v102
    v_cvt_pk_bf16_f32 v122, v100, v101
    v_exp_f32 v103, v103
    v_mfma_f32_32x32x16_bf16 v[128:143], v[176:179], v[112:115], v[128:143]
    ds_read_b128 v[180:183], v6 offset:1216
    v_exp_f32 v104, v104
    v_cvt_pk_bf16_f32 v123, v102, v103
    v_exp_f32 v105, v105
    v_exp_f32 v106, v106
    v_cvt_pk_bf16_f32 v124, v104, v105
    v_exp_f32 v107, v107
    v_mfma_f32_32x32x16_bf16 v[128:143], v[184:187], v[116:119], v[128:143]
    ds_read_b128 v[188:191], v6 offset:1824
    v_exp_f32 v108, v108
    v_cvt_pk_bf16_f32 v125, v106, v107
    v_exp_f32 v109, v109
    v_exp_f32 v192, v110
    v_cvt_pk_bf16_f32 v126, v108, v109
    v_exp_f32 v193, v111
    v_mfma_f32_32x32x16_bf16 v[96:111], v[164:167], v[36:39], v[64:79]
    v_exp_f32 v80, v80
    v_cvt_pk_bf16_f32 v127, v192, v193
    v_exp_f32 v81, v81
    v_exp_f32 v82, v82
    v_cvt_pk_bf16_f32 v112, v80, v81
    v_exp_f32 v83, v83
    v_mfma_f32_32x32x8_bf16 v[96:111], v[172:173], v[44:45], v[96:111]
    v_exp_f32 v84, v84
    v_cvt_pk_bf16_f32 v113, v82, v83
    v_exp_f32 v85, v85
    v_exp_f32 v86, v86
    v_cvt_pk_bf16_f32 v114, v84, v85
    v_exp_f32 v87, v87
    v_mfma_f32_32x32x16_bf16 v[144:159], v[176:179], v[120:123], v[144:159]
    v_exp_f32 v88, v88
    v_cvt_pk_bf16_f32 v115, v86, v87
    v_exp_f32 v89, v89
    v_exp_f32 v90, v90
    v_cvt_pk_bf16_f32 v116, v88, v89
    v_exp_f32 v91, v91
    v_mfma_f32_32x32x16_bf16 v[144:159], v[184:187], v[124:127], v[144:159]
    s_waitcnt lgkmcnt(0)
    v_exp_f32 v92, v92
    v_cvt_pk_bf16_f32 v117, v90, v91
    v_exp_f32 v93, v93
    v_exp_f32 v192, v94
    v_cvt_pk_bf16_f32 v118, v92, v93
    v_exp_f32 v193, v95
    v_mfma_f32_32x32x16_bf16 v[80:95], v[160:163], v[32:35], v[48:63]
    ds_read_b128 v[164:167], v4 offset:3072
    v_exp_f32 v96, v96
    v_cvt_pk_bf16_f32 v119, v192, v193
    v_exp_f32 v97, v97
    v_exp_f32 v98, v98
    v_cvt_pk_bf16_f32 v120, v96, v97
    v_exp_f32 v99, v99
    v_mfma_f32_32x32x8_bf16 v[80:95], v[168:169], v[40:41], v[80:95]
    ds_read_b32 v172, v5 offset:384
    v_exp_f32 v100, v100
    v_cvt_pk_bf16_f32 v121, v98, v99
    v_exp_f32 v101, v101
    v_exp_f32 v102, v102
    v_cvt_pk_bf16_f32 v122, v100, v101
    v_exp_f32 v103, v103
    v_mfma_f32_32x32x16_bf16 v[128:143], v[180:183], v[112:115], v[128:143]
    ds_read_b128 v[176:179], v6 offset:2432
    v_exp_f32 v104, v104
    v_cvt_pk_bf16_f32 v123, v102, v103
    v_exp_f32 v105, v105
    v_exp_f32 v106, v106
    v_cvt_pk_bf16_f32 v124, v104, v105
    v_exp_f32 v107, v107
    v_mfma_f32_32x32x16_bf16 v[128:143], v[188:191], v[116:119], v[128:143]
    ds_read_b128 v[184:187], v6 offset:3040
    v_exp_f32 v108, v108
    v_cvt_pk_bf16_f32 v125, v106, v107
    v_exp_f32 v109, v109
    v_exp_f32 v192, v110
    v_cvt_pk_bf16_f32 v126, v108, v109
    v_exp_f32 v193, v111
    v_mfma_f32_32x32x16_bf16 v[96:111], v[160:163], v[36:39], v[64:79]
    v_exp_f32 v80, v80
    v_cvt_pk_bf16_f32 v127, v192, v193
    v_exp_f32 v81, v81
    v_exp_f32 v82, v82
    v_cvt_pk_bf16_f32 v112, v80, v81
    v_exp_f32 v83, v83
    v_mfma_f32_32x32x8_bf16 v[96:111], v[168:169], v[44:45], v[96:111]
    v_exp_f32 v84, v84
    v_cvt_pk_bf16_f32 v113, v82, v83
    v_exp_f32 v85, v85
    v_exp_f32 v86, v86
    v_cvt_pk_bf16_f32 v114, v84, v85
    v_exp_f32 v87, v87
    v_mfma_f32_32x32x16_bf16 v[144:159], v[180:183], v[120:123], v[144:159]
    v_exp_f32 v88, v88
    v_cvt_pk_bf16_f32 v115, v86, v87
    v_exp_f32 v89, v89
    v_exp_f32 v90, v90
    v_cvt_pk_bf16_f32 v116, v88, v89
    v_exp_f32 v91, v91
    v_mfma_f32_32x32x16_bf16 v[144:159], v[188:191], v[124:127], v[144:159]
    s_waitcnt lgkmcnt(0)
    v_exp_f32 v92, v92
    v_cvt_pk_bf16_f32 v117, v90, v91
    v_exp_f32 v93, v93
    v_exp_f32 v192, v94
    v_cvt_pk_bf16_f32 v118, v92, v93
    v_exp_f32 v193, v95
    v_mfma_f32_32x32x16_bf16 v[80:95], v[164:167], v[32:35], v[48:63]
    ds_read_b128 v[160:163], v4 offset:4096
    v_exp_f32 v96, v96
    v_cvt_pk_bf16_f32 v119, v192, v193
    v_exp_f32 v97, v97
    v_exp_f32 v98, v98
    v_cvt_pk_bf16_f32 v120, v96, v97
    v_exp_f32 v99, v99
    v_mfma_f32_32x32x8_bf16 v[80:95], v[172:173], v[40:41], v[80:95]
    ds_read_b32 v168, v5 offset:512
    v_exp_f32 v100, v100
    v_cvt_pk_bf16_f32 v121, v98, v99
    v_exp_f32 v101, v101
    v_exp_f32 v102, v102
    v_cvt_pk_bf16_f32 v122, v100, v101
    v_exp_f32 v103, v103
    v_mfma_f32_32x32x16_bf16 v[128:143], v[176:179], v[112:115], v[128:143]
    ds_read_b128 v[180:183], v6 offset:3648
    v_exp_f32 v104, v104
    v_cvt_pk_bf16_f32 v123, v102, v103
    v_exp_f32 v105, v105
    v_exp_f32 v106, v106
    v_cvt_pk_bf16_f32 v124, v104, v105
    v_exp_f32 v107, v107
    v_mfma_f32_32x32x16_bf16 v[128:143], v[184:187], v[116:119], v[128:143]
    ds_read_b128 v[188:191], v6 offset:4256
    v_exp_f32 v108, v108
    v_cvt_pk_bf16_f32 v125, v106, v107
    v_exp_f32 v109, v109
    v_exp_f32 v192, v110
    v_cvt_pk_bf16_f32 v126, v108, v109
    v_exp_f32 v193, v111
    v_mfma_f32_32x32x16_bf16 v[96:111], v[164:167], v[36:39], v[64:79]
    v_exp_f32 v80, v80
    v_cvt_pk_bf16_f32 v127, v192, v193
    v_exp_f32 v81, v81
    v_exp_f32 v82, v82
    v_cvt_pk_bf16_f32 v112, v80, v81
    v_exp_f32 v83, v83
    v_mfma_f32_32x32x8_bf16 v[96:111], v[172:173], v[44:45], v[96:111]
    v_exp_f32 v84, v84
    v_cvt_pk_bf16_f32 v113, v82, v83
    v_exp_f32 v85, v85
    v_exp_f32 v86, v86
    v_cvt_pk_bf16_f32 v114, v84, v85
    v_exp_f32 v87, v87
    v_mfma_f32_32x32x16_bf16 v[144:159], v[176:179], v[120:123], v[144:159]
    v_exp_f32 v88, v88
    v_cvt_pk_bf16_f32 v115, v86, v87
    v_exp_f32 v89, v89
    v_exp_f32 v90, v90
    v_cvt_pk_bf16_f32 v116, v88, v89
    v_exp_f32 v91, v91
    v_mfma_f32_32x32x16_bf16 v[144:159], v[184:187], v[124:127], v[144:159]
    s_waitcnt lgkmcnt(0)
    v_exp_f32 v92, v92
    v_cvt_pk_bf16_f32 v117, v90, v91
    v_exp_f32 v93, v93
    v_exp_f32 v192, v94
    v_cvt_pk_bf16_f32 v118, v92, v93
    v_exp_f32 v193, v95
    v_mfma_f32_32x32x16_bf16 v[80:95], v[160:163], v[32:35], v[48:63]
    ds_read_b128 v[164:167], v4 offset:5120
    v_exp_f32 v96, v96
    v_cvt_pk_bf16_f32 v119, v192, v193
    v_exp_f32 v97, v97
    v_exp_f32 v98, v98
    v_cvt_pk_bf16_f32 v120, v96, v97
    v_exp_f32 v99, v99
    v_mfma_f32_32x32x8_bf16 v[80:95], v[168:169], v[40:41], v[80:95]
    ds_read_b32 v172, v5 offset:640
    v_exp_f32 v100, v100
    v_cvt_pk_bf16_f32 v121, v98, v99
    v_exp_f32 v101, v101
    v_exp_f32 v102, v102
    v_cvt_pk_bf16_f32 v122, v100, v101
    v_exp_f32 v103, v103
    v_mfma_f32_32x32x16_bf16 v[128:143], v[180:183], v[112:115], v[128:143]
    ds_read_b128 v[176:179], v6 offset:4864
    v_exp_f32 v104, v104
    v_cvt_pk_bf16_f32 v123, v102, v103
    v_exp_f32 v105, v105
    v_exp_f32 v106, v106
    v_cvt_pk_bf16_f32 v124, v104, v105
    v_exp_f32 v107, v107
    v_mfma_f32_32x32x16_bf16 v[128:143], v[188:191], v[116:119], v[128:143]
    ds_read_b128 v[184:187], v6 offset:5472
    v_exp_f32 v108, v108
    v_cvt_pk_bf16_f32 v125, v106, v107
    v_exp_f32 v109, v109
    v_exp_f32 v192, v110
    v_cvt_pk_bf16_f32 v126, v108, v109
    v_exp_f32 v193, v111
    v_mfma_f32_32x32x16_bf16 v[96:111], v[160:163], v[36:39], v[64:79]
    v_exp_f32 v80, v80
    v_cvt_pk_bf16_f32 v127, v192, v193
    v_exp_f32 v81, v81
    v_exp_f32 v82, v82
    v_cvt_pk_bf16_f32 v112, v80, v81
    v_exp_f32 v83, v83
    v_mfma_f32_32x32x8_bf16 v[96:111], v[168:169], v[44:45], v[96:111]
    v_exp_f32 v84, v84
    v_cvt_pk_bf16_f32 v113, v82, v83
    v_exp_f32 v85, v85
    v_exp_f32 v86, v86
    v_cvt_pk_bf16_f32 v114, v84, v85
    v_exp_f32 v87, v87
    v_mfma_f32_32x32x16_bf16 v[144:159], v[180:183], v[120:123], v[144:159]
    v_exp_f32 v88, v88
    v_cvt_pk_bf16_f32 v115, v86, v87
    v_exp_f32 v89, v89
    v_exp_f32 v90, v90
    v_cvt_pk_bf16_f32 v116, v88, v89
    v_exp_f32 v91, v91
    v_mfma_f32_32x32x16_bf16 v[144:159], v[188:191], v[124:127], v[144:159]
    s_waitcnt lgkmcnt(0)
    v_exp_f32 v92, v92
    v_cvt_pk_bf16_f32 v117, v90, v91
    v_exp_f32 v93, v93
    v_exp_f32 v192, v94
    v_cvt_pk_bf16_f32 v118, v92, v93
    v_exp_f32 v193, v95
    v_mfma_f32_32x32x16_bf16 v[80:95], v[164:167], v[32:35], v[48:63]
    ds_read_b128 v[160:163], v4 offset:6144
    v_exp_f32 v96, v96
    v_cvt_pk_bf16_f32 v119, v192, v193
    v_exp_f32 v97, v97
    v_exp_f32 v98, v98
    v_cvt_pk_bf16_f32 v120, v96, v97
    v_exp_f32 v99, v99
    v_mfma_f32_32x32x8_bf16 v[80:95], v[172:173], v[40:41], v[80:95]
    ds_read_b32 v168, v5 offset:768
    v_exp_f32 v100, v100
    v_cvt_pk_bf16_f32 v121, v98, v99
    v_exp_f32 v101, v101
    v_exp_f32 v102, v102
    v_cvt_pk_bf16_f32 v122, v100, v101
    v_exp_f32 v103, v103
    v_mfma_f32_32x32x16_bf16 v[128:143], v[176:179], v[112:115], v[128:143]
    ds_read_b128 v[180:183], v6 offset:6080
    v_exp_f32 v104, v104
    v_cvt_pk_bf16_f32 v123, v102, v103
    v_exp_f32 v105, v105
    v_exp_f32 v106, v106
    v_cvt_pk_bf16_f32 v124, v104, v105
    v_exp_f32 v107, v107
    v_mfma_f32_32x32x16_bf16 v[128:143], v[184:187], v[116:119], v[128:143]
    ds_read_b128 v[188:191], v6 offset:6688
    v_exp_f32 v108, v108
    v_cvt_pk_bf16_f32 v125, v106, v107
    v_exp_f32 v109, v109
    v_exp_f32 v192, v110
    v_cvt_pk_bf16_f32 v126, v108, v109
    v_exp_f32 v193, v111
    v_mfma_f32_32x32x16_bf16 v[96:111], v[164:167], v[36:39], v[64:79]
    v_exp_f32 v80, v80
    v_cvt_pk_bf16_f32 v127, v192, v193
    v_exp_f32 v81, v81
    v_exp_f32 v82, v82
    v_cvt_pk_bf16_f32 v112, v80, v81
    v_exp_f32 v83, v83
    v_mfma_f32_32x32x8_bf16 v[96:111], v[172:173], v[44:45], v[96:111]
    v_exp_f32 v84, v84
    v_cvt_pk_bf16_f32 v113, v82, v83
    v_exp_f32 v85, v85
    v_exp_f32 v86, v86
    v_cvt_pk_bf16_f32 v114, v84, v85
    v_exp_f32 v87, v87
    v_mfma_f32_32x32x16_bf16 v[144:159], v[176:179], v[120:123], v[144:159]
    v_exp_f32 v88, v88
    v_cvt_pk_bf16_f32 v115, v86, v87
    v_exp_f32 v89, v89
    v_exp_f32 v90, v90
    v_cvt_pk_bf16_f32 v116, v88, v89
    v_exp_f32 v91, v91
    v_mfma_f32_32x32x16_bf16 v[144:159], v[184:187], v[124:127], v[144:159]
    s_waitcnt lgkmcnt(0)
    v_exp_f32 v92, v92
    v_cvt_pk_bf16_f32 v117, v90, v91
    v_exp_f32 v93, v93
    v_exp_f32 v192, v94
    v_cvt_pk_bf16_f32 v118, v92, v93
    v_exp_f32 v193, v95
    v_mfma_f32_32x32x16_bf16 v[80:95], v[160:163], v[32:35], v[48:63]
    ds_read_b128 v[164:167], v4 offset:7168
    v_exp_f32 v96, v96
    v_cvt_pk_bf16_f32 v119, v192, v193
    v_exp_f32 v97, v97
    v_exp_f32 v98, v98
    v_cvt_pk_bf16_f32 v120, v96, v97
    v_exp_f32 v99, v99
    v_mfma_f32_32x32x8_bf16 v[80:95], v[168:169], v[40:41], v[80:95]
    ds_read_b32 v172, v5 offset:896
    v_exp_f32 v100, v100
    v_cvt_pk_bf16_f32 v121, v98, v99
    v_exp_f32 v101, v101
    v_exp_f32 v102, v102
    v_cvt_pk_bf16_f32 v122, v100, v101
    v_exp_f32 v103, v103
    v_mfma_f32_32x32x16_bf16 v[128:143], v[180:183], v[112:115], v[128:143]
    ds_read_b128 v[176:179], v6 offset:7296
    v_exp_f32 v104, v104
    v_cvt_pk_bf16_f32 v123, v102, v103
    v_exp_f32 v105, v105
    v_exp_f32 v106, v106
    v_cvt_pk_bf16_f32 v124, v104, v105
    v_exp_f32 v107, v107
    v_mfma_f32_32x32x16_bf16 v[128:143], v[188:191], v[116:119], v[128:143]
    ds_read_b128 v[184:187], v6 offset:7904
    v_exp_f32 v108, v108
    v_cvt_pk_bf16_f32 v125, v106, v107
    v_exp_f32 v109, v109
    v_exp_f32 v192, v110
    v_cvt_pk_bf16_f32 v126, v108, v109
    v_exp_f32 v193, v111
    v_mfma_f32_32x32x16_bf16 v[96:111], v[160:163], v[36:39], v[64:79]
    v_exp_f32 v80, v80
    v_cvt_pk_bf16_f32 v127, v192, v193
    v_exp_f32 v81, v81
    v_exp_f32 v82, v82
    v_cvt_pk_bf16_f32 v112, v80, v81
    v_exp_f32 v83, v83
    v_mfma_f32_32x32x8_bf16 v[96:111], v[168:169], v[44:45], v[96:111]
    v_exp_f32 v84, v84
    v_cvt_pk_bf16_f32 v113, v82, v83
    v_exp_f32 v85, v85
    v_exp_f32 v86, v86
    v_cvt_pk_bf16_f32 v114, v84, v85
    v_exp_f32 v87, v87
    v_mfma_f32_32x32x16_bf16 v[144:159], v[180:183], v[120:123], v[144:159]
    v_exp_f32 v88, v88
    v_cvt_pk_bf16_f32 v115, v86, v87
    v_exp_f32 v89, v89
    v_exp_f32 v90, v90
    v_cvt_pk_bf16_f32 v116, v88, v89
    v_exp_f32 v91, v91
    v_mfma_f32_32x32x16_bf16 v[144:159], v[188:191], v[124:127], v[144:159]
    s_waitcnt lgkmcnt(0)
    v_exp_f32 v92, v92
    v_cvt_pk_bf16_f32 v117, v90, v91
    v_exp_f32 v93, v93
    v_exp_f32 v192, v94
    v_cvt_pk_bf16_f32 v118, v92, v93
    v_exp_f32 v193, v95
    v_mfma_f32_32x32x16_bf16 v[80:95], v[164:167], v[32:35], v[48:63]
    ds_read_b128 v[160:163], v4 offset:8192
    v_exp_f32 v96, v96
    v_cvt_pk_bf16_f32 v119, v192, v193
    v_exp_f32 v97, v97
    v_exp_f32 v98, v98
    v_cvt_pk_bf16_f32 v120, v96, v97
    v_exp_f32 v99, v99
    v_mfma_f32_32x32x8_bf16 v[80:95], v[172:173], v[40:41], v[80:95]
    ds_read_b32 v168, v5 offset:1024
    v_exp_f32 v100, v100
    v_cvt_pk_bf16_f32 v121, v98, v99
    v_exp_f32 v101, v101
    v_exp_f32 v102, v102
    v_cvt_pk_bf16_f32 v122, v100, v101
    v_exp_f32 v103, v103
    v_mfma_f32_32x32x16_bf16 v[128:143], v[176:179], v[112:115], v[128:143]
    ds_read_b128 v[180:183], v6 offset:8512
    v_exp_f32 v104, v104
    v_cvt_pk_bf16_f32 v123, v102, v103
    v_exp_f32 v105, v105
    v_exp_f32 v106, v106
    v_cvt_pk_bf16_f32 v124, v104, v105
    v_exp_f32 v107, v107
    v_mfma_f32_32x32x16_bf16 v[128:143], v[184:187], v[116:119], v[128:143]
    ds_read_b128 v[188:191], v6 offset:9120
    v_exp_f32 v108, v108
    v_cvt_pk_bf16_f32 v125, v106, v107
    v_exp_f32 v109, v109
    v_exp_f32 v192, v110
    v_cvt_pk_bf16_f32 v126, v108, v109
    v_exp_f32 v193, v111
    v_mfma_f32_32x32x16_bf16 v[96:111], v[164:167], v[36:39], v[64:79]
    s_add_u32 s54, s54, 1
    v_exp_f32 v80, v80
    v_cvt_pk_bf16_f32 v127, v192, v193
    v_exp_f32 v81, v81
    v_exp_f32 v82, v82
    v_cvt_pk_bf16_f32 v112, v80, v81
    v_exp_f32 v83, v83
    v_mfma_f32_32x32x8_bf16 v[96:111], v[172:173], v[44:45], v[96:111]
    s_cmp_lt_u32 s54, 4
    v_exp_f32 v84, v84
    v_cvt_pk_bf16_f32 v113, v82, v83
    v_exp_f32 v85, v85
    v_exp_f32 v86, v86
    v_cvt_pk_bf16_f32 v114, v84, v85
    v_exp_f32 v87, v87
    v_mfma_f32_32x32x16_bf16 v[144:159], v[176:179], v[120:123], v[144:159]
    v_exp_f32 v88, v88
    v_cvt_pk_bf16_f32 v115, v86, v87
    v_exp_f32 v89, v89
    v_exp_f32 v90, v90
    v_cvt_pk_bf16_f32 v116, v88, v89
    v_exp_f32 v91, v91
    v_mfma_f32_32x32x16_bf16 v[144:159], v[184:187], v[124:127], v[144:159]
    s_waitcnt lgkmcnt(0)
    v_exp_f32 v92, v92
    v_cvt_pk_bf16_f32 v117, v90, v91
    v_exp_f32 v93, v93
    v_exp_f32 v192, v94
    v_cvt_pk_bf16_f32 v118, v92, v93
    v_exp_f32 v193, v95
    v_mfma_f32_32x32x16_bf16 v[80:95], v[160:163], v[32:35], v[48:63]
    ds_read_b128 v[164:167], v4 offset:9216
    v_exp_f32 v96, v96
    v_cvt_pk_bf16_f32 v119, v192, v193
    v_exp_f32 v97, v97
    v_exp_f32 v98, v98
    v_cvt_pk_bf16_f32 v120, v96, v97
    v_exp_f32 v99, v99
    v_mfma_f32_32x32x8_bf16 v[80:95], v[168:169], v[40:41], v[80:95]
    ds_read_b32 v172, v5 offset:1152
    v_exp_f32 v100, v100
    v_cvt_pk_bf16_f32 v121, v98, v99
    v_exp_f32 v101, v101
    v_exp_f32 v102, v102
    v_cvt_pk_bf16_f32 v122, v100, v101
    v_exp_f32 v103, v103
    v_mfma_f32_32x32x16_bf16 v[128:143], v[180:183], v[112:115], v[128:143]
    ds_read_b128 v[176:179], v6 offset:9728
    v_exp_f32 v104, v104
    v_cvt_pk_bf16_f32 v123, v102, v103
    v_exp_f32 v105, v105
    v_exp_f32 v106, v106
    v_cvt_pk_bf16_f32 v124, v104, v105
    v_exp_f32 v107, v107
    v_mfma_f32_32x32x16_bf16 v[128:143], v[188:191], v[116:119], v[128:143]
    ds_read_b128 v[184:187], v6 offset:10336
    v_exp_f32 v108, v108
    v_cvt_pk_bf16_f32 v125, v106, v107
    v_exp_f32 v109, v109
    v_exp_f32 v192, v110
    v_add_u32 v4, 8192, v4
    v_add_u32 v5, 1024, v5
    v_add_u32 v6, 9728, v6
    v_cvt_pk_bf16_f32 v126, v108, v109
    v_exp_f32 v193, v111
    s_cbranch_scc1 B_LOOP
    v_mfma_f32_32x32x16_bf16 v[144:159], v[180:183], v[120:123], v[144:159]
    v_cvt_pk_bf16_f32 v127, v192, v193
    s_waitcnt lgkmcnt(0)
    s_nop 0
    v_mfma_f32_32x32x16_bf16 v[144:159], v[188:191], v[124:127], v[144:159]
    s_mul_i32 s32, s31, 36864
    s_add_u32 s32, s32, 7413760
    s_lshr_b32 s33, s30, 2
    s_lshl_b32 s35, s33, 12
    s_add_u32 s35, s35, s32
    s_bfe_u32 s36, s30, 0x10001
    s_lshl_b32 s36, s36, 10
    s_add_u32 s35, s35, s36
    s_and_b32 s36, s30, 1
    s_lshl_b32 s36, s36, 9
    s_add_u32 s35, s35, s36
    s_lshl_b32 s36, s30, 7
    s_add_u32 s36, s36, s32
    s_add_u32 s36, s36, 32768
    s_mov_b32 s38, 0x5f800000
    s_mov_b32 s39, 0x7b800000
    v_add_f32 v14, v138, v154
    v_add_f32 v15, |v128|, |v144|
    v_add_f32 v15, |v129|, v15
    v_add_f32 v15, |v145|, v15
    v_add_f32 v15, |v130|, v15
    v_add_f32 v15, |v146|, v15
    v_add_f32 v15, |v131|, v15
    v_add_f32 v15, |v147|, v15
    v_add_f32 v15, |v132|, v15
    v_add_f32 v15, |v148|, v15
    v_add_f32 v15, |v133|, v15
    v_add_f32 v15, |v149|, v15
    v_add_f32 v15, |v134|, v15
    v_add_f32 v15, |v150|, v15
    v_add_f32 v15, |v135|, v15
    v_add_f32 v15, |v151|, v15
    v_add_f32 v15, |v136|, v15
    v_add_f32 v15, |v152|, v15
    v_add_f32 v15, |v137|, v15
    v_add_f32 v15, |v153|, v15
    v_cmp_ngt_f32 vcc, s38, v14
    v_cmp_ngt_f32 s[56:57], s39, v15
    s_nop 0
    s_or_b64 vcc, vcc, s[56:57]
    s_cbranch_vccz B_OK
    s_cmp_eq_u32 s50, 1
    s_cbranch_scc0 B_OK
    s_mov_b32 s50, 32
    s_mov_b32 s51, -1
    v_mov_b32 v128, 0
    v_mov_b32 v129, 0
    v_mov_b32 v130, 0
    v_mov_b32 v131, 0
    v_mov_b32 v132, 0
    v_mov_b32 v133, 0
    v_mov_b32 v134, 0
    v_mov_b32 v135, 0
    v_mov_b32 v136, 0
    v_mov_b32 v137, 0
    v_mov_b32 v138, 0
    v_mov_b32 v139, 0
    v_mov_b32 v140, 0
    v_mov_b32 v141, 0
    v_mov_b32 v142, 0
    v_mov_b32 v143, 0
    v_mov_b32 v144, 0
    v_mov_b32 v145, 0
    v_mov_b32 v146, 0
    v_mov_b32 v147, 0
    v_mov_b32 v148, 0
    v_mov_b32 v149, 0
    v_mov_b32 v150, 0
    v_mov_b32 v151, 0
    v_mov_b32 v152, 0
    v_mov_b32 v153, 0
    v_mov_b32 v154, 0
    v_mov_b32 v155, 0
    v_mov_b32 v156, 0
    v_mov_b32 v157, 0
    v_mov_b32 v158, 0
    v_mov_b32 v159, 0
    v_mov_b32 v120, 0
    v_mov_b32 v121, 0
    v_mov_b32 v122, 0
    v_mov_b32 v123, 0
    v_mov_b32 v124, 0
    v_mov_b32 v125, 0
    v_mov_b32 v126, 0
    v_mov_b32 v127, 0
    v_mov_b32 v180, 0
    v_mov_b32 v188, 0
    v_mov_b32 v181, 0
    v_mov_b32 v189, 0
    v_mov_b32 v182, 0
    v_mov_b32 v190, 0
    v_mov_b32 v183, 0
    v_mov_b32 v191, 0
    v_mov_b32 v192, 0
    v_mov_b32 v193, 0
    s_branch B_A
B_HOOK:
    s_cmp_eq_u32 s48, 0
    s_cbranch_scc0 B_HOOKU
    s_add_u32 s51, s51, 1
    s_cmp_eq_u32 s54, 1
    s_cbranch_scc0 B_HOOKL2
    v_mov_b32 v24, 163344
    s_mov_b32 s59, 0
LW_22:
    ds_read_b32 v25, v24
    s_waitcnt lgkmcnt(0)
    v_cmp_gt_u32 vcc, 4, v25
    s_add_u32 s59, s59, 1
    s_cbranch_vccz LWD_23
    s_sleep 1
    s_cmp_lt_u32 s59, 16000000
    s_cbranch_scc1 LW_22
LWD_23:
    s_cmp_lt_u32 s60, 864
    s_cbranch_scc0 B_HWD
    buffer_load_dwordx4 v[200:203], v16, s[8:11], s65 offen offset:0
    buffer_load_dwordx4 v[204:207], v16, s[8:11], s65 offen offset:32
    buffer_load_dwordx4 v[208:211], v16, s[8:11], s65 offen offset:64
    buffer_load_dwordx4 v[212:215], v16, s[8:11], s66 offen offset:0
    buffer_load_dwordx4 v[216:219], v16, s[8:11], s66 offen offset:32
    buffer_load_dwordx4 v[220:223], v16, s[8:11], s66 offen offset:64
    buffer_load_dwordx4 v[224:227], v16, s[12:15], s65 offen offset:0
    buffer_load_dwordx4 v[228:231], v16, s[12:15], s65 offen offset:32
    buffer_load_dwordx4 v[232:235], v16, s[12:15], s65 offen offset:64
    buffer_load_dwordx4 v[236:239], v16, s[12:15], s66 offen offset:0
    buffer_load_dwordx4 v[240:243], v16, s[12:15], s66 offen offset:32
    buffer_load_dwordx4 v[244:247], v16, s[12:15], s66 offen offset:64
    s_branch B_HOOKBACK
B_HOOKL2:
    s_mov_b32 s51, -1
    v_mov_b32 v2, 1
    v_mov_b32 v24, -1
    v_mov_b32 v25, -1
    v_mov_b32 v26, -1
    v_mov_b32 v27, -1
    s_setprio 0
    s_cmp_lt_u32 s60, 864
    s_cbranch_scc0 B_HWD2
    s_waitcnt vmcnt(0)
    ds_write_b128 v17, v[200:203] offset:0
    ds_read_b64_tr_b16 v[200:201], v18 offset:0
    ds_read_b64_tr_b16 v[202:203], v18 offset:256
    ds_write_b128 v17, v[204:207] offset:1024
    ds_read_b64_tr_b16 v[204:205], v18 offset:1024
    ds_read_b64_tr_b16 v[206:207], v18 offset:1280
    ds_write_b128 v17, v[208:211] offset:0
    ds_read_b64_tr_b16 v[208:209], v18 offset:0
    ds_read_b64_tr_b16 v[210:211], v18 offset:256
    s_waitcnt lgkmcnt(6)
    buffer_store_dwordx4 v[200:203], v3, s[20:23], s67 offen offset:0 sc1
    ds_write_b128 v17, v[212:215] offset:1024
    ds_read_b64_tr_b16 v[212:213], v18 offset:1024
    ds_read_b64_tr_b16 v[214:215], v18 offset:1280
    s_waitcnt lgkmcnt(6)
    buffer_store_dwordx4 v[204:207], v3, s[20:23], s67 offen offset:1024 sc1
    ds_write_b128 v17, v[216:219] offset:0
    ds_read_b64_tr_b16 v[216:217], v18 offset:0
    ds_read_b64_tr_b16 v[218:219], v18 offset:256
    s_waitcnt lgkmcnt(6)
    buffer_store_dwordx4 v[208:211], v3, s[20:23], s67 offen offset:2048 sc1
    ds_write_b128 v17, v[220:223] offset:1024
    ds_read_b64_tr_b16 v[220:221], v18 offset:1024
    ds_read_b64_tr_b16 v[222:223], v18 offset:1280
    s_waitcnt lgkmcnt(6)
    buffer_store_dwordx4 v[212:215], v3, s[20:23], s67 offen offset:3072 sc1
    s_add_u32 s67, s67, 4096
    ds_write_b128 v17, v[224:227] offset:0
    ds_read_b64_tr_b16 v[224:225], v18 offset:0
    ds_read_b64_tr_b16 v[226:227], v18 offset:256
    s_waitcnt lgkmcnt(6)
    buffer_store_dwordx4 v[216:219], v3, s[20:23], s67 offen offset:0 sc1
    ds_write_b128 v17, v[228:231] offset:1024
    ds_read_b64_tr_b16 v[228:229], v18 offset:1024
    ds_read_b64_tr_b16 v[230:231], v18 offset:1280
    s_waitcnt lgkmcnt(6)
    buffer_store_dwordx4 v[220:223], v3, s[20:23], s67 offen offset:1024 sc1
    ds_write_b128 v17, v[232:235] offset:0
    ds_read_b64_tr_b16 v[232:233], v18 offset:0
    ds_read_b64_tr_b16 v[234:235], v18 offset:256
    s_waitcnt lgkmcnt(6)
    buffer_store_dwordx4 v[224:227], v3, s[20:23], s67 offen offset:2048 sc1
    ds_write_b128 v17, v[236:239] offset:1024
    ds_read_b64_tr_b16 v[236:237], v18 offset:1024
    ds_read_b64_tr_b16 v[238:239], v18 offset:1280
    s_waitcnt lgkmcnt(6)
    buffer_store_dwordx4 v[228:231], v3, s[20:23], s67 offen offset:3072 sc1
    s_add_u32 s67, s67, 4096
    ds_write_b128 v17, v[240:243] offset:0
    ds_read_b64_tr_b16 v[240:241], v18 offset:0
    ds_read_b64_tr_b16 v[242:243], v18 offset:256
    s_waitcnt lgkmcnt(6)
    buffer_store_dwordx4 v[232:235], v3, s[20:23], s67 offen offset:0 sc1
    ds_write_b128 v17, v[244:247] offset:1024
    ds_read_b64_tr_b16 v[244:245], v18 offset:1024
    ds_read_b64_tr_b16 v[246:247], v18 offset:1280
    s_waitcnt lgkmcnt(6)
    buffer_store_dwordx4 v[236:239], v3, s[20:23], s67 offen offset:1024 sc1
    s_waitcnt lgkmcnt(3)
    buffer_store_dwordx4 v[240:243], v3, s[20:23], s67 offen offset:2048 sc1
    s_waitcnt lgkmcnt(0)
    buffer_store_dwordx4 v[244:247], v3, s[20:23], s67 offen offset:3072 sc1
    s_add_u32 s67, s67, 4096
B_HOOKL3:
    s_cmp_eq_u32 s75, -1
    s_cbranch_scc1 B_NOPOIS
    buffer_store_dwordx4 v[24:27], v3, s[20:23], s74 offen offset:0 sc1
    buffer_store_dwordx4 v[24:27], v3, s[20:23], s74 offen offset:1024 sc1
    buffer_store_dwordx4 v[24:27], v3, s[20:23], s74 offen offset:2048 sc1
    buffer_store_dwordx4 v[24:27], v3, s[20:23], s74 offen offset:3072 sc1
    s_add_u32 s74, s74, 4096
    s_mov_b32 exec_hi, 0
    buffer_store_dwordx4 v[24:27], v3, s[20:23], s74 offen sc1
    s_mov_b32 exec_hi, -1
    s_add_u32 s74, s74, 14336
    buffer_store_dwordx4 v[24:27], v3, s[20:23], s74 offen offset:0 sc1
    buffer_store_dwordx4 v[24:27], v3, s[20:23], s74 offen offset:1024 sc1
    buffer_store_dwordx4 v[24:27], v3, s[20:23], s74 offen offset:2048 sc1
    buffer_store_dwordx4 v[24:27], v3, s[20:23], s74 offen offset:3072 sc1
    s_add_u32 s74, s74, 4096
    s_mov_b32 exec_hi, 0
    buffer_store_dwordx4 v[24:27], v3, s[20:23], s74 offen sc1
    s_mov_b32 exec_hi, -1
    s_add_u32 s74, s74, 14336
    s_waitcnt vmcnt(0)
    s_mov_b64 exec, 1
    buffer_atomic_add v2, off, s[20:23], s75
B_NOPOIS:
    s_waitcnt vmcnt(1)
    s_cbranch_scc0 B_POIS2
    s_waitcnt vmcnt(0)
B_POIS2:
    s_mov_b64 exec, 1
    buffer_atomic_add v2, off, s[20:23], s68
    s_mov_b64 exec, -1
    s_branch B_HOOKBACK
B_HWD:
    buffer_load_dwordx4 v[196:199], v16, s[8:11], s62 offen offset:0
    buffer_load_dwordx4 v[200:203], v16, s[8:11], s62 offen offset:32
    buffer_load_dwordx4 v[204:207], v16, s[8:11], s62 offen offset:64
    buffer_load_dwordx4 v[208:211], v16, s[8:11], s62 offen offset:96
    buffer_load_dwordx4 v[212:215], v16, s[8:11], s62 offen offset:128
    buffer_load_dwordx4 v[216:219], v16, s[8:11], s62 offen offset:160
    buffer_load_dwordx4 v[220:223], v16, s[8:11], s62 offen offset:192
    buffer_load_dwordx4 v[224:227], v16, s[8:11], s62 offen offset:224
    buffer_load_dwordx4 v[228:231], v16, s[8:11], s62 offen offset:256
    buffer_load_dwordx4 v[232:235], v19, s[8:11], s62 offen offset:0
    buffer_load_dwordx4 v[236:239], v19, s[8:11], s62 offen offset:32
    buffer_load_dwordx4 v[240:243], v19, s[8:11], s62 offen offset:64
    buffer_load_dwordx4 v[244:247], v19, s[8:11], s62 offen offset:96
    buffer_load_dwordx4 v[248:251], v19, s[8:11], s62 offen offset:128
    buffer_load_dwordx4 v[252:255], v19, s[8:11], s62 offen offset:160
    s_branch B_HOOKBACK
B_HWD2:
    s_waitcnt vmcnt(0)
    ds_write_b128 v17, v[196:199] offset:0
    ds_read_b64_tr_b16 v[196:197], v18 offset:0
    ds_read_b64_tr_b16 v[198:199], v18 offset:256
    ds_write_b128 v17, v[200:203] offset:1024
    ds_read_b64_tr_b16 v[200:201], v18 offset:1024
    ds_read_b64_tr_b16 v[202:203], v18 offset:1280
    ds_write_b128 v17, v[204:207] offset:0
    ds_read_b64_tr_b16 v[204:205], v18 offset:0
    ds_read_b64_tr_b16 v[206:207], v18 offset:256
    s_waitcnt lgkmcnt(6)
    buffer_store_dwordx4 v[196:199], v3, s[20:23], s67 offen offset:0 sc1
    ds_write_b128 v17, v[208:211] offset:1024
    ds_read_b64_tr_b16 v[208:209], v18 offset:1024
    ds_read_b64_tr_b16 v[210:211], v18 offset:1280
    s_waitcnt lgkmcnt(6)
    buffer_store_dwordx4 v[200:203], v3, s[20:23], s67 offen offset:1024 sc1
    ds_write_b128 v17, v[212:215] offset:0
    ds_read_b64_tr_b16 v[212:213], v18 offset:0
    ds_read_b64_tr_b16 v[214:215], v18 offset:256
    s_waitcnt lgkmcnt(6)
    buffer_store_dwordx4 v[204:207], v3, s[20:23], s67 offen offset:2048 sc1
    ds_write_b128 v17, v[216:219] offset:1024
    ds_read_b64_tr_b16 v[216:217], v18 offset:1024
    ds_read_b64_tr_b16 v[218:219], v18 offset:1280
    s_waitcnt lgkmcnt(6)
    buffer_store_dwordx4 v[208:211], v3, s[20:23], s67 offen offset:3072 sc1
    s_add_u32 s67, s67, 4096
    buffer_load_dwordx4 v[196:199], v19, s[8:11], s62 offen offset:192
    buffer_load_dwordx4 v[200:203], v19, s[8:11], s62 offen offset:224
    buffer_load_dwordx4 v[204:207], v19, s[8:11], s62 offen offset:256
    ds_write_b128 v17, v[220:223] offset:0
    ds_read_b64_tr_b16 v[220:221], v18 offset:0
    ds_read_b64_tr_b16 v[222:223], v18 offset:256
    s_waitcnt lgkmcnt(6)
    buffer_store_dwordx4 v[212:215], v3, s[20:23], s67 offen offset:0 sc1
    ds_write_b128 v17, v[224:227] offset:1024
    ds_read_b64_tr_b16 v[224:225], v18 offset:1024
    ds_read_b64_tr_b16 v[226:227], v18 offset:1280
    s_waitcnt lgkmcnt(6)
    buffer_store_dwordx4 v[216:219], v3, s[20:23], s67 offen offset:1024 sc1
    ds_write_b128 v17, v[228:231] offset:0
    ds_read_b64_tr_b16 v[228:229], v18 offset:0
    ds_read_b64_tr_b16 v[230:231], v18 offset:256
    s_waitcnt lgkmcnt(6)
    buffer_store_dwordx4 v[220:223], v3, s[20:23], s67 offen offset:2048 sc1
    ds_write_b128 v17, v[232:235] offset:1024
    ds_read_b64_tr_b16 v[232:233], v18 offset:1024
    ds_read_b64_tr_b16 v[234:235], v18 offset:1280
    s_waitcnt lgkmcnt(6)
    buffer_store_dwordx4 v[224:227], v3, s[20:23], s67 offen offset:3072 sc1
    s_add_u32 s67, s67, 4096
    ds_write_b128 v17, v[236:239] offset:0
    ds_read_b64_tr_b16 v[236:237], v18 offset:0
    ds_read_b64_tr_b16 v[238:239], v18 offset:256
    s_waitcnt lgkmcnt(6)
    buffer_store_dwordx4 v[228:231], v3, s[20:23], s67 offen offset:0 sc1
    ds_write_b128 v17, v[240:243] offset:1024
    ds_read_b64_tr_b16 v[240:241], v18 offset:1024
    ds_read_b64_tr_b16 v[242:243], v18 offset:1280
    s_waitcnt lgkmcnt(6)
    buffer_store_dwordx4 v[232:235], v3, s[20:23], s67 offen offset:1024 sc1
    ds_write_b128 v17, v[244:247] offset:0
    ds_read_b64_tr_b16 v[244:245], v18 offset:0
    ds_read_b64_tr_b16 v[246:247], v18 offset:256
    s_waitcnt lgkmcnt(6)
    buffer_store_dwordx4 v[236:239], v3, s[20:23], s67 offen offset:2048 sc1
    ds_write_b128 v17, v[248:251] offset:1024
    ds_read_b64_tr_b16 v[248:249], v18 offset:1024
    ds_read_b64_tr_b16 v[250:251], v18 offset:1280
    s_waitcnt lgkmcnt(6)
    buffer_store_dwordx4 v[240:243], v3, s[20:23], s67 offen offset:3072 sc1
    s_add_u32 s67, s67, 4096
    ds_write_b128 v17, v[252:255] offset:0
    ds_read_b64_tr_b16 v[252:253], v18 offset:0
    ds_read_b64_tr_b16 v[254:255], v18 offset:256
    s_waitcnt lgkmcnt(6)
    buffer_store_dwordx4 v[244:247], v3, s[20:23], s67 offen offset:0 sc1
    s_waitcnt lgkmcnt(3)
    buffer_store_dwordx4 v[248:251], v3, s[20:23], s67 offen offset:1024 sc1
    s_waitcnt lgkmcnt(0)
    buffer_store_dwordx4 v[252:255], v3, s[20:23], s67 offen offset:2048 sc1
    s_waitcnt vmcnt(11)
    ds_write_b128 v17, v[196:199] offset:1024
    ds_read_b64_tr_b16 v[196:197], v18 offset:1024
    ds_read_b64_tr_b16 v[198:199], v18 offset:1280
    ds_write_b128 v17, v[200:203] offset:0
    ds_read_b64_tr_b16 v[200:201], v18 offset:0
    ds_read_b64_tr_b16 v[202:203], v18 offset:256
    ds_write_b128 v17, v[204:207] offset:1024
    ds_read_b64_tr_b16 v[204:205], v18 offset:1024
    ds_read_b64_tr_b16 v[206:207], v18 offset:1280
    s_waitcnt lgkmcnt(0)
    buffer_store_dwordx4 v[196:199], v3, s[20:23], s67 offen offset:3072 sc1
    s_add_u32 s67, s67, 4096
    buffer_store_dwordx4 v[200:203], v3, s[20:23], s67 offen offset:0 sc1
    buffer_store_dwordx4 v[204:207], v3, s[20:23], s67 offen offset:1024 sc1
    s_branch B_HOOKL3
B_HOOKU:
    s_branch B_HOOKBACK
B_OK:
    s_mul_i32 s40, s49, 6144
    s_add_u32 s40, s40, 32768
    v_add_u32 v14, s40, v3
    s_cmp_eq_u32 s48, 0
    s_cbranch_scc1 B_LOWT
    v_mov_b32 v139, v48
    v_mov_b32 v155, v64
    s_and_b32 s70, s2, 1
    s_lshl_b32 s70, s70, 2
    s_bfe_u32 s71, s2, 0x20003
    s_add_u32 s70, s70, s71
    s_bfe_u32 s71, s2, 0x20001
    s_lshl_b32 s71, s71, 3
    s_lshr_b32 s72, s2, 5
    s_add_u32 s71, s71, s72
    s_lshl_b32 s43, s71, 8
    s_add_u32 s43, s43, 49152
    buffer_load_dword v26, off, s[20:23], s43 sc1
    s_cmp_eq_u32 s3, 5
    s_cbranch_scc0 SKIP_24
    s_getpc_b64 s[4:5]
PC_25:
    s_add_u32 s4, s4, PH_C-PC_25
    s_addc_u32 s5, s5, 0
    v_and_b32 v24, 63, v0
    v_min_u32 v24, 11, v24
    s_bfe_u32 s58, s2, 0x40003
    s_mul_i32 s58, s58, 1536
    v_lshl_add_u32 v24, v24, 7, s58
    v_min_u32 v24, PH_E-PH_C-4, v24
    v_mov_b32 v25, s5
    v_add_co_u32 v24, vcc, s4, v24
    s_nop 1
    v_addc_co_u32 v25, vcc, 0, v25, vcc
    global_load_dword v23, v[24:25], off
SKIP_24:
    s_cmp_eq_u32 s3, 4
    s_cbranch_scc0 SKIP_26
    s_mov_b32 s59, 0
    s_branch POLLC_29
POLL_27:
    buffer_load_dword v22, v20, s[20:23], 0 offen sc1
    s_waitcnt vmcnt(0)
POLLC_29:
    v_cmp_lt_u32 vcc, v22, v21
    s_add_u32 s59, s59, 1
    s_cbranch_vccz POLLD_28
    s_sleep 1
    s_cmp_lt_u32 s59, 2000000
    s_cbranch_scc1 POLL_27
POLLD_28:
SKIP_26:
    v_mov_b32 v24, 163328
    v_mov_b32 v25, 1
    s_mov_b64 exec, 1
    ds_add_u32 v24, v25
    s_mov_b64 exec, -1
    v_mov_b32 v24, 163328
    s_mov_b32 s59, 0
LW_30:
    ds_read_b32 v25, v24
    s_waitcnt lgkmcnt(0)
    v_cmp_gt_u32 vcc, 4, v25
    s_add_u32 s59, s59, 1
    s_cbranch_vccz LWD_31
    s_sleep 1
    s_cmp_lt_u32 s59, 16000000
    s_cbranch_scc1 LW_30
LWD_31:
    ds_write_b128 v14, v[128:131] offset:0
    ds_write_b128 v14, v[132:135] offset:1024
    ds_write_b128 v14, v[136:139] offset:2048
    ds_write_b128 v14, v[144:147] offset:3072
    ds_write_b128 v14, v[148:151] offset:4096
    ds_write_b128 v14, v[152:155] offset:5120
    s_waitcnt lgkmcnt(0)
    v_mov_b32 v24, 163336
    v_mov_b32 v25, 1
    s_mov_b64 exec, 1
    ds_add_u32 v24, v25
    s_mov_b64 exec, -1
    s_branch C_UP
B_LOWT:
    v_bfe_u32 v11, v1, 4, 1
    v_lshlrev_b32 v11, 11, v11
    v_and_b32 v13, 15, v1
    v_lshl_add_u32 v11, v13, 4, v11
    v_lshl_add_u32 v13, v12, 8, v11
    v_mov_b32 v24, 163336
    s_mov_b32 s59, 0
LW_32:
    ds_read_b32 v25, v24
    s_waitcnt lgkmcnt(0)
    v_cmp_gt_u32 vcc, 4, v25
    s_add_u32 s59, s59, 1
    s_cbranch_vccz LWD_33
    s_sleep 1
    s_cmp_lt_u32 s59, 16000000
    s_cbranch_scc1 LW_32
LWD_33:
    ds_read_b128 v[80:83], v14 offset:0
    ds_read_b128 v[84:87], v14 offset:1024
    ds_read_b128 v[88:91], v14 offset:2048
    ds_read_b128 v[96:99], v14 offset:3072
    ds_read_b128 v[100:103], v14 offset:4096
    ds_read_b128 v[104:107], v14 offset:5120
    s_waitcnt lgkmcnt(3)
    v_min_f32 v24, v48, v91
    v_sub_f32 v25, v24, v48
    v_sub_f32 v26, v24, v91
    v_exp_f32 v25, v25
    v_exp_f32 v26, v26
    s_nop 0
    v_mul_f32 v27, v138, v25
    v_fmac_f32 v27, v90, v26
    v_mov_b32 v28, v27
    s_nop 1
    v_permlane32_swap_b32 v27, v28
    s_nop 0
    v_rcp_f32 v27, v27
    s_nop 0
    v_mul_f32 v25, v25, v27
    v_mul_f32 v26, v26, v27
    v_mul_f32 v128, v128, v25
    v_fmac_f32 v128, v80, v26
    v_mul_f32 v129, v129, v25
    v_fmac_f32 v129, v81, v26
    v_mul_f32 v130, v130, v25
    v_fmac_f32 v130, v82, v26
    v_mul_f32 v131, v131, v25
    v_fmac_f32 v131, v83, v26
    v_mul_f32 v132, v132, v25
    v_fmac_f32 v132, v84, v26
    v_mul_f32 v133, v133, v25
    v_fmac_f32 v133, v85, v26
    v_mul_f32 v134, v134, v25
    v_fmac_f32 v134, v86, v26
    v_mul_f32 v135, v135, v25
    v_fmac_f32 v135, v87, v26
    v_mul_f32 v136, v136, v25
    v_fmac_f32 v136, v88, v26
    v_mul_f32 v137, v137, v25
    v_fmac_f32 v137, v89, v26
    v_cvt_pk_bf16_f32 v112, v128, v129
    v_cvt_pk_bf16_f32 v113, v130, v131
    v_cvt_pk_bf16_f32 v114, v132, v133
    v_cvt_pk_bf16_f32 v115, v134, v135
    v_cvt_pk_bf16_f32 v116, v136, v137
    buffer_store_dwordx4 v[112:115], v13, s[20:23], s35 offen sc1
    s_mov_b32 exec_hi, 0
    buffer_store_dword v116, v8, s[20:23], s36 offen sc1
    s_mov_b32 exec_hi, -1
    s_add_u32 s35, s35, 36864
    s_add_u32 s36, s36, 36864
    s_waitcnt lgkmcnt(0)
    v_min_f32 v24, v64, v107
    v_sub_f32 v25, v24, v64
    v_sub_f32 v26, v24, v107
    v_exp_f32 v25, v25
    v_exp_f32 v26, v26
    s_nop 0
    v_mul_f32 v27, v154, v25
    v_fmac_f32 v27, v106, v26
    v_mov_b32 v28, v27
    s_nop 1
    v_permlane32_swap_b32 v27, v28
    s_nop 0
    v_rcp_f32 v27, v27
    s_nop 0
    v_mul_f32 v25, v25, v27
    v_mul_f32 v26, v26, v27
    v_mul_f32 v144, v144, v25
    v_fmac_f32 v144, v96, v26
    v_mul_f32 v145, v145, v25
    v_fmac_f32 v145, v97, v26
    v_mul_f32 v146, v146, v25
    v_fmac_f32 v146, v98, v26
    v_mul_f32 v147, v147, v25
    v_fmac_f32 v147, v99, v26
    v_mul_f32 v148, v148, v25
    v_fmac_f32 v148, v100, v26
    v_mul_f32 v149, v149, v25
    v_fmac_f32 v149, v101, v26
    v_mul_f32 v150, v150, v25
    v_fmac_f32 v150, v102, v26
    v_mul_f32 v151, v151, v25
    v_fmac_f32 v151, v103, v26
    v_mul_f32 v152, v152, v25
    v_fmac_f32 v152, v104, v26
    v_mul_f32 v153, v153, v25
    v_fmac_f32 v153, v105, v26
    v_cvt_pk_bf16_f32 v120, v144, v145
    v_cvt_pk_bf16_f32 v121, v146, v147
    v_cvt_pk_bf16_f32 v122, v148, v149
    v_cvt_pk_bf16_f32 v123, v150, v151
    v_cvt_pk_bf16_f32 v124, v152, v153
    buffer_store_dwordx4 v[120:123], v13, s[20:23], s35 offen sc1
    s_mov_b32 exec_hi, 0
    buffer_store_dword v124, v8, s[20:23], s36 offen sc1
    s_mov_b32 exec_hi, -1
    s_lshl_b32 s55, s55, 8
    s_add_u32 s55, s55, 4096
PH_C:
    v_mov_b32 v24, 163340
    v_mov_b32 v25, 1
    s_waitcnt vmcnt(0)
    s_mov_b64 exec, 1
    ds_add_rtn_u32 v26, v24, v25
    s_waitcnt lgkmcnt(0)
    v_cmp_eq_u32 vcc, 3, v26
    s_cbranch_vccz C_NOSIG
    buffer_atomic_add v25, off, s[20:23], s55
C_NOSIG:
    s_mov_b64 exec, -1
    s_and_b32 s30, s2, 7
    s_lshl_b32 s32, s30, 3
    s_bfe_u32 s31, s2, 0x30003
    s_add_u32 s32, s32, s31
    s_lshr_b32 s33, s2, 6
    s_and_b32 s34, s3, 3
    v_and_b32 v1, 63, v0
    v_and_b32 v3, 15, v1
    v_lshrrev_b32 v4, 4, v1
    v_and_b32 v5, 3, v1
    v_lshlrev_b32 v9, 4, v1
    s_and_b32 s70, s2, 1
    s_lshl_b32 s70, s70, 2
    s_bfe_u32 s71, s2, 0x20003
    s_add_u32 s70, s70, s71
    s_bfe_u32 s71, s2, 0x20001
    s_lshl_b32 s71, s71, 3
    s_lshr_b32 s72, s2, 5
    s_add_u32 s71, s71, s72
    s_mov_b32 s8, s76
    s_mov_b32 s9, s77
    s_mov_b32 s10, 0x240000
    s_mov_b32 s11, 0x00020000
    v_mul_u32_u24 v20, 1152, v3
    v_lshl_add_u32 v20, v4, 3, v20
    s_mul_i32 s36, s32, 36864
    s_mul_i32 s37, s33, 288
    s_add_u32 s36, s36, s37
    s_mul_i32 s42, s32, 36864
    s_mul_i32 s43, s33, 4608
    s_add_u32 s42, s42, s43
    s_mul_i32 s44, s32, 20
    s_mul_i32 s45, s33, 5
    s_add_u32 s44, s44, s45
    s_lshl_b32 s44, s44, 7
    s_add_u32 s44, s44, 14491648
    s_mul_i32 s40, s33, 165888
    s_add_u32 s40, s40, 58908672
    v_add_u32 v16, 122880, v9
    v_lshlrev_b32 v17, 9, v4
    v_lshl_add_u32 v17, v3, 2, v17
    v_add_u32 v17, 155648, v17
    v_lshlrev_b32 v21, 2, v3
    s_and_b32 s35, s3, 1
    s_cmp_ge_u32 s3, 2
    s_cbranch_scc1 C_LWB
    s_mul_i32 s37, s35, 18432
    s_add_u32 s37, s37, s36
    buffer_load_dwordx2 v[36:37], v20, s[8:11], s37 offen offset:256
    s_barrier
    ds_read_b128 v[176:179], v16 offset:0
    ds_read_b128 v[180:183], v16 offset:1024
    ds_read_b128 v[184:187], v16 offset:2048
    ds_read_b128 v[188:191], v16 offset:3072
    ds_read_b128 v[192:195], v16 offset:4096
    ds_read_b128 v[196:199], v16 offset:5120
    ds_read_b128 v[200:203], v16 offset:6144
    ds_read_b128 v[204:207], v16 offset:7168
    ds_read_b128 v[208:211], v16 offset:8192
    ds_read_b128 v[212:215], v16 offset:9216
    ds_read_b128 v[216:219], v16 offset:10240
    ds_read_b128 v[220:223], v16 offset:11264
    ds_read_b128 v[224:227], v16 offset:12288
    ds_read_b128 v[228:231], v16 offset:13312
    ds_read_b128 v[232:235], v16 offset:14336
    ds_read_b128 v[236:239], v16 offset:15360
    ds_read_b128 v[240:243], v16 offset:16384
    ds_read_b128 v[244:247], v16 offset:17408
    s_branch C_LJ
C_LWB:
    s_lshl_b32 s37, s32, 7
    s_lshl_b32 s38, s35, 6
    s_add_u32 s37, s37, s38
    s_add_u32 s37, s37, 163840
    buffer_load_dword v32, v21, s[20:23], s37 offen sc1
    v_and_b32 v7, 1, v1
    v_mul_u32_u24 v7, 1152, v7
    v_lshl_add_u32 v7, v4, 4, v7
    v_add_u32 v7, 141312, v7
    s_barrier
    ds_read_b128 v[176:179], v7 offset:0
    ds_read_b128 v[180:183], v7 offset:64
    ds_read_b128 v[184:187], v7 offset:128
    ds_read_b128 v[188:191], v7 offset:192
    ds_read_b128 v[192:195], v7 offset:256
    ds_read_b128 v[196:199], v7 offset:320
    ds_read_b128 v[200:203], v7 offset:384
    ds_read_b128 v[204:207], v7 offset:448
    ds_read_b128 v[208:211], v7 offset:512
    ds_read_b128 v[212:215], v7 offset:576
    ds_read_b128 v[216:219], v7 offset:640
    ds_read_b128 v[220:223], v7 offset:704
    ds_read_b128 v[224:227], v7 offset:768
    ds_read_b128 v[228:231], v7 offset:832
    ds_read_b128 v[232:235], v7 offset:896
    ds_read_b128 v[236:239], v7 offset:960
    ds_read_b128 v[240:243], v7 offset:1024
    ds_read_b128 v[244:247], v7 offset:1088
C_LJ:
    s_lshl_b32 s38, s35, 11
    v_add_u32 v16, s38, v16
    s_lshl_b32 s38, s35, 6
    v_add_u32 v17, s38, v17
    s_waitcnt vmcnt(0) lgkmcnt(0)
    s_cmp_ge_u32 s3, 2
    s_cbranch_scc1 C_LI1
    v_lshlrev_b32 v32, 16, v36
    v_and_b32 v33, 0xffff0000, v36
    v_lshlrev_b32 v34, 16, v37
    v_and_b32 v35, 0xffff0000, v37
    s_branch C_LI2
C_LI1:
    v_mov_b32 v33, 0
    v_mov_b32 v34, 0
    v_mov_b32 v35, 0
C_LI2:
    s_mul_i32 s51, s71, 331776
    s_lshl_b32 s50, s35, 12
    s_add_u32 s51, s51, s50
    s_add_u32 s51, s51, 42967040
    s_cmp_eq_u32 s3, 0
    s_cbranch_scc0 SKIP_34
    s_lshl_b32 s48, s30, 8
    s_add_u32 s48, s48, 4096
    s_lshl_b32 s49, s71, 8
    s_add_u32 s49, s49, 49152
    v_mov_b32 v24, s48
    v_mov_b32 v25, 32
    v_writelane_b32 v24, s49, 1
    v_writelane_b32 v25, 27, 1
    s_mov_b32 s59, 0
POLL_35:
    buffer_load_dword v248, v24, s[20:23], 0 offen sc1
    s_waitcnt vmcnt(0)
POLLC_37:
    v_cmp_lt_u32 vcc, v248, v25
    s_add_u32 s59, s59, 1
    s_cbranch_vccz POLLD_36
    s_sleep 1
    s_cmp_lt_u32 s59, 2000000
    s_cbranch_scc1 POLL_35
POLLD_36:
SKIP_34:
    s_mul_i32 s41, s32, 36864
    s_lshl_b32 s46, s3, 10
    s_add_u32 s41, s41, s46
    s_add_u32 s41, s41, 7413760
    s_barrier
    s_add_u32 m0, s46, 122880
    s_add_u32 s47, s41, 0
    buffer_load_dwordx4 v9, s[20:23], s47 offen sc1 lds
    s_add_u32 m0, s46, 131072
    s_add_u32 s47, s41, 8192
    buffer_load_dwordx4 v9, s[20:23], s47 offen sc1 lds
    s_add_u32 m0, s46, 139264
    s_add_u32 s47, s41, 16384
    buffer_load_dwordx4 v9, s[20:23], s47 offen sc1 lds
    s_add_u32 m0, s46, 147456
    s_add_u32 s47, s41, 24576
    buffer_load_dwordx4 v9, s[20:23], s47 offen sc1 lds
    s_add_u32 m0, s46, 155648
    s_add_u32 s47, s41, 32768
    buffer_load_dwordx4 v9, s[20:23], s47 offen sc1 lds
    s_waitcnt vmcnt(0)
    s_barrier
    ds_read_b128 v[40:43], v16 offset:0
    ds_read_b128 v[44:47], v16 offset:1024
    ds_read_b128 v[48:51], v16 offset:4096
    ds_read_b128 v[52:55], v16 offset:5120
    ds_read_b128 v[56:59], v16 offset:8192
    ds_read_b128 v[60:63], v16 offset:9216
    ds_read_b128 v[64:67], v16 offset:12288
    ds_read_b128 v[68:71], v16 offset:13312
    ds_read_b128 v[72:75], v16 offset:16384
    ds_read_b128 v[76:79], v16 offset:17408
    ds_read_b128 v[80:83], v16 offset:20480
    ds_read_b128 v[84:87], v16 offset:21504
    s_waitcnt lgkmcnt(11)
    v_mfma_f32_16x16x32_bf16 v[32:35], v[176:179], v[40:43], v[32:35]
    ds_read_b128 v[88:91], v16 offset:24576
    s_waitcnt lgkmcnt(11)
    v_mfma_f32_16x16x32_bf16 v[32:35], v[180:183], v[44:47], v[32:35]
    ds_read_b128 v[92:95], v16 offset:25600
    s_waitcnt lgkmcnt(11)
    v_mfma_f32_16x16x32_bf16 v[32:35], v[184:187], v[48:51], v[32:35]
    ds_read_b128 v[96:99], v16 offset:28672
    s_waitcnt lgkmcnt(11)
    v_mfma_f32_16x16x32_bf16 v[32:35], v[188:191], v[52:55], v[32:35]
    ds_read_b128 v[100:103], v16 offset:29696
    s_waitcnt lgkmcnt(11)
    v_mfma_f32_16x16x32_bf16 v[32:35], v[192:195], v[56:59], v[32:35]
    ds_read_b32 v40, v17 offset:0
    ds_read_b32 v41, v17 offset:128
    ds_read_b32 v42, v17 offset:256
    ds_read_b32 v43, v17 offset:384
    s_waitcnt lgkmcnt(14)
    v_mfma_f32_16x16x32_bf16 v[32:35], v[196:199], v[60:63], v[32:35]
    ds_read_b32 v44, v17 offset:2048
    ds_read_b32 v45, v17 offset:2176
    ds_read_b32 v46, v17 offset:2304
    ds_read_b32 v47, v17 offset:2432
    s_waitcnt lgkmcnt(14)
    v_mfma_f32_16x16x32_bf16 v[32:35], v[200:203], v[64:67], v[32:35]
    v_mfma_f32_16x16x32_bf16 v[32:35], v[204:207], v[68:71], v[32:35]
    v_mfma_f32_16x16x32_bf16 v[32:35], v[208:211], v[72:75], v[32:35]
    v_mfma_f32_16x16x32_bf16 v[32:35], v[212:215], v[76:79], v[32:35]
    s_waitcnt lgkmcnt(13)
    v_mfma_f32_16x16x32_bf16 v[32:35], v[216:219], v[80:83], v[32:35]
    s_waitcnt lgkmcnt(12)
    v_mfma_f32_16x16x32_bf16 v[32:35], v[220:223], v[84:87], v[32:35]
    s_waitcnt lgkmcnt(11)
    v_mfma_f32_16x16x32_bf16 v[32:35], v[224:227], v[88:91], v[32:35]
    s_waitcnt lgkmcnt(10)
    v_mfma_f32_16x16x32_bf16 v[32:35], v[228:231], v[92:95], v[32:35]
    s_waitcnt lgkmcnt(9)
    v_mfma_f32_16x16x32_bf16 v[32:35], v[232:235], v[96:99], v[32:35]
    s_waitcnt lgkmcnt(8)
    v_mfma_f32_16x16x32_bf16 v[32:35], v[236:239], v[100:103], v[32:35]
    s_waitcnt lgkmcnt(4)
    v_mfma_f32_16x16x32_bf16 v[32:35], v[240:243], v[40:43], v[32:35]
    s_waitcnt lgkmcnt(0)
    v_mfma_f32_16x16x32_bf16 v[32:35], v[244:247], v[44:47], v[32:35]
    s_cmp_ge_u32 s3, 2
    s_cbranch_scc0 C_L8
    s_lshl_b32 s38, s35, 6
    s_add_u32 s38, s38, 163584
    v_add_u32 v7, s38, v21
    s_nop 3
    v_add_f32 v104, v32, v33
    v_cvt_pk_bf16_f32 v104, v104, v104
    v_lshlrev_b32 v104, 16, v104
    ds_write_b32 v7, v104
    s_waitcnt lgkmcnt(0)
    v_mov_b32 v24, 163332
    v_mov_b32 v25, 1
    s_mov_b64 exec, 1
    ds_add_u32 v24, v25
    s_mov_b64 exec, -1
    s_add_u32 m0, s50, 0
    s_add_u32 s47, s51, 0
    buffer_load_dwordx4 v9, s[20:23], s47 offen offset:0 sc1 lds
    buffer_load_dwordx4 v9, s[20:23], s47 offen offset:1024 sc1 lds
    buffer_load_dwordx4 v9, s[20:23], s47 offen offset:2048 sc1 lds
    buffer_load_dwordx4 v9, s[20:23], s47 offen offset:3072 sc1 lds
    s_add_u32 m0, s50, 8192
    s_add_u32 s47, s51, 8192
    buffer_load_dwordx4 v9, s[20:23], s47 offen offset:0 sc1 lds
    buffer_load_dwordx4 v9, s[20:23], s47 offen offset:1024 sc1 lds
    buffer_load_dwordx4 v9, s[20:23], s47 offen offset:2048 sc1 lds
    buffer_load_dwordx4 v9, s[20:23], s47 offen offset:3072 sc1 lds
    s_add_u32 m0, s50, 16384
    s_add_u32 s47, s51, 16384
    buffer_load_dwordx4 v9, s[20:23], s47 offen offset:0 sc1 lds
    buffer_load_dwordx4 v9, s[20:23], s47 offen offset:1024 sc1 lds
    buffer_load_dwordx4 v9, s[20:23], s47 offen offset:2048 sc1 lds
    buffer_load_dwordx4 v9, s[20:23], s47 offen offset:3072 sc1 lds
    s_add_u32 m0, s50, 24576
    s_add_u32 s47, s51, 24576
    buffer_load_dwordx4 v9, s[20:23], s47 offen offset:0 sc1 lds
    buffer_load_dwordx4 v9, s[20:23], s47 offen offset:1024 sc1 lds
    buffer_load_dwordx4 v9, s[20:23], s47 offen offset:2048 sc1 lds
    buffer_load_dwordx4 v9, s[20:23], s47 offen offset:3072 sc1 lds
    s_add_u32 m0, s50, 32768
    s_add_u32 s47, s51, 32768
    buffer_load_dwordx4 v9, s[20:23], s47 offen offset:0 sc1 lds
    buffer_load_dwordx4 v9, s[20:23], s47 offen offset:1024 sc1 lds
    buffer_load_dwordx4 v9, s[20:23], s47 offen offset:2048 sc1 lds
    buffer_load_dwordx4 v9, s[20:23], s47 offen offset:3072 sc1 lds
    s_add_u32 m0, s50, 40960
    s_add_u32 s47, s51, 40960
    buffer_load_dwordx4 v9, s[20:23], s47 offen offset:0 sc1 lds
    buffer_load_dwordx4 v9, s[20:23], s47 offen offset:1024 sc1 lds
    buffer_load_dwordx4 v9, s[20:23], s47 offen offset:2048 sc1 lds
    buffer_load_dwordx4 v9, s[20:23], s47 offen offset:3072 sc1 lds
    s_add_u32 m0, s50, 49152
    s_add_u32 s47, s51, 49152
    buffer_load_dwordx4 v9, s[20:23], s47 offen offset:0 sc1 lds
    buffer_load_dwordx4 v9, s[20:23], s47 offen offset:1024 sc1 lds
    buffer_load_dwordx4 v9, s[20:23], s47 offen offset:2048 sc1 lds
    buffer_load_dwordx4 v9, s[20:23], s47 offen offset:3072 sc1 lds
    s_add_u32 m0, s50, 57344
    s_add_u32 s47, s51, 57344
    buffer_load_dwordx4 v9, s[20:23], s47 offen offset:0 sc1 lds
    buffer_load_dwordx4 v9, s[20:23], s47 offen offset:1024 sc1 lds
    buffer_load_dwordx4 v9, s[20:23], s47 offen offset:2048 sc1 lds
    buffer_load_dwordx4 v9, s[20:23], s47 offen offset:3072 sc1 lds
    s_add_u32 m0, s50, 65536
    s_add_u32 s47, s51, 65536
    buffer_load_dwordx4 v9, s[20:23], s47 offen offset:0 sc1 lds
    buffer_load_dwordx4 v9, s[20:23], s47 offen offset:1024 sc1 lds
    buffer_load_dwordx4 v9, s[20:23], s47 offen offset:2048 sc1 lds
    buffer_load_dwordx4 v9, s[20:23], s47 offen offset:3072 sc1 lds
    s_branch C_JOIN2
C_L8:
    v_lshrrev_b32 v7, 1, v4
    v_lshlrev_b32 v22, 8, v7
    v_lshl_add_u32 v22, v3, 4, v22
    v_and_b32 v7, 1, v4
    v_lshl_add_u32 v22, v7, 3, v22
    s_mul_i32 s38, s35, 18432
    s_add_u32 s42, s42, s38
    s_add_u32 s46, s42, 9777152
    s_add_u32 s47, s42, 12136448
    v_cvt_pk_bf16_f32 v40, v32, v33
    v_cvt_pk_bf16_f32 v41, v34, v35
    v_lshlrev_b32 v32, 16, v40
    v_and_b32 v33, 0xffff0000, v40
    v_lshlrev_b32 v34, 16, v41
    v_and_b32 v35, 0xffff0000, v41
    v_mov_b32 v24, 163332
    s_mov_b32 s59, 0
LW_38:
    ds_read_b32 v25, v24
    s_waitcnt lgkmcnt(0)
    v_cmp_gt_u32 vcc, 2, v25
    s_add_u32 s59, s59, 1
    s_cbranch_vccz LWD_39
    s_sleep 1
    s_cmp_lt_u32 s59, 16000000
    s_cbranch_scc1 LW_38
LWD_39:
    s_lshl_b32 s38, s35, 6
    s_add_u32 s39, s38, 163584
    v_add_u32 v7, s39, v21
    ds_read_b32 v104, v7
    s_add_u32 s44, s44, s38
    s_waitcnt lgkmcnt(0)
    v_sub_f32 v32, v32, v104
    v_sub_f32 v33, v33, v104
    v_sub_f32 v34, v34, v104
    v_sub_f32 v35, v35, v104
    v_cvt_pk_bf16_f32 v42, v32, v33
    v_cvt_pk_bf16_f32 v43, v34, v35
    buffer_store_dwordx2 v[42:43], v22, s[20:23], s47 offen sc1
    buffer_store_dwordx2 v[40:41], v22, s[20:23], s46 offen sc1
    v_mul_f32 v106, v32, v32
    v_fmac_f32 v106, v33, v33
    v_fmac_f32 v106, v34, v34
    v_fmac_f32 v106, v35, v35
    v_mov_b32 v107, v106
    s_nop 1
    v_permlane32_swap_b32 v106, v107
    s_nop 0
    v_add_f32 v106, v106, v107
    v_mov_b32 v107, v106
    s_nop 1
    v_permlane16_swap_b32 v106, v107
    s_nop 0
    v_add_f32 v106, v106, v107
    buffer_store_dword v106, v21, s[20:23], s44 offen offset:512 sc1
    s_branch C_JOIN
C_UP:
    s_and_b32 s30, s2, 7
    s_lshl_b32 s32, s30, 3
    s_bfe_u32 s31, s2, 0x30003
    s_add_u32 s32, s32, s31
    s_lshr_b32 s33, s2, 6
    s_and_b32 s34, s3, 3
    v_and_b32 v1, 63, v0
    v_and_b32 v3, 15, v1
    v_lshrrev_b32 v4, 4, v1
    v_and_b32 v5, 3, v1
    v_lshlrev_b32 v9, 4, v1
    s_and_b32 s70, s2, 1
    s_lshl_b32 s70, s70, 2
    s_bfe_u32 s71, s2, 0x20003
    s_add_u32 s70, s70, s71
    s_bfe_u32 s71, s2, 0x20001
    s_lshl_b32 s71, s71, 3
    s_lshr_b32 s72, s2, 5
    s_add_u32 s71, s71, s72
    s_mov_b32 s8, s76
    s_mov_b32 s9, s77
    s_mov_b32 s10, 0x240000
    s_mov_b32 s11, 0x00020000
    v_mul_u32_u24 v20, 1152, v3
    v_lshl_add_u32 v20, v4, 3, v20
    s_mul_i32 s36, s32, 36864
    s_mul_i32 s37, s33, 288
    s_add_u32 s36, s36, s37
    s_mul_i32 s42, s32, 36864
    s_mul_i32 s43, s33, 4608
    s_add_u32 s42, s42, s43
    s_mul_i32 s44, s32, 20
    s_mul_i32 s45, s33, 5
    s_add_u32 s44, s44, s45
    s_lshl_b32 s44, s44, 7
    s_add_u32 s44, s44, 14491648
    s_mul_i32 s40, s33, 165888
    s_add_u32 s40, s40, 58908672
    v_add_u32 v16, 122880, v9
    v_lshlrev_b32 v17, 9, v4
    v_lshl_add_u32 v17, v3, 2, v17
    v_add_u32 v17, 155648, v17
    v_lshlrev_b32 v21, 2, v3
    s_lshl_b32 s37, s34, 6
    s_add_u32 s37, s37, s36
    s_add_u32 s39, s37, 18432
    buffer_load_dwordx2 v[80:81], v20, s[8:11], s37 offen offset:0
    buffer_load_dwordx2 v[84:85], v20, s[8:11], s37 offen offset:32
    buffer_load_dwordx2 v[82:83], v20, s[8:11], s39 offen offset:0
    buffer_load_dwordx2 v[86:87], v20, s[8:11], s39 offen offset:32
    s_and_b32 s46, s70, 3
    s_lshl_b32 s46, s46, 2
    s_add_u32 s46, s46, s34
    s_mul_i32 s46, s46, 6912
    s_mul_i32 s47, s71, 331776
    s_add_u32 s46, s46, s47
    s_add_u32 s46, s46, 42967040
    v_lshlrev_b32 v24, 3, v9
    v_min_u32 v24, 6784, v24
    s_waitcnt vmcnt(4)
    v_cmp_gt_u32 vcc, 27, v26
    s_cbranch_vccnz C_NOT
    buffer_load_dword v25, v24, s[20:23], s46 offen sc1
C_NOT:
    s_mul_i32 s41, s34, 4608
    s_add_u32 s46, s40, s41
    s_add_u32 s46, s46, 147456
    s_add_u32 m0, s41, 122880
    s_add_u32 s47, s46, 4096
    buffer_load_dwordx4 v9, s[20:23], s46 offen offset:0 sc1 lds
    buffer_load_dwordx4 v9, s[20:23], s46 offen offset:1024 sc1 lds
    buffer_load_dwordx4 v9, s[20:23], s46 offen offset:2048 sc1 lds
    buffer_load_dwordx4 v9, s[20:23], s46 offen offset:3072 sc1 lds
    s_add_u32 m0, s41, 126976
    s_mov_b32 exec_hi, 0
    buffer_load_dwordx4 v9, s[20:23], s47 offen sc1 lds
    s_mov_b32 exec_hi, -1
    s_lshl_b32 s41, s34, 10
    s_add_u32 m0, s41, 141312
    s_add_u32 s47, s41, 59572224
    buffer_load_dwordx4 v9, s[20:23], s47 offen sc1 lds
    s_mul_i32 s41, s34, 36864
    s_add_u32 s40, s40, s41
    v_add_u32 v15, 18432, v9
    buffer_load_dwordx4 v[112:115], v9, s[20:23], s40 offen offset:0 sc1
    buffer_load_dwordx4 v[116:119], v15, s[20:23], s40 offen offset:0 sc1
    buffer_load_dwordx4 v[120:123], v9, s[20:23], s40 offen offset:1024 sc1
    buffer_load_dwordx4 v[124:127], v15, s[20:23], s40 offen offset:1024 sc1
    buffer_load_dwordx4 v[128:131], v9, s[20:23], s40 offen offset:2048 sc1
    buffer_load_dwordx4 v[132:135], v15, s[20:23], s40 offen offset:2048 sc1
    buffer_load_dwordx4 v[136:139], v9, s[20:23], s40 offen offset:3072 sc1
    buffer_load_dwordx4 v[140:143], v15, s[20:23], s40 offen offset:3072 sc1
    s_add_u32 s40, s40, 4096
    buffer_load_dwordx4 v[144:147], v9, s[20:23], s40 offen offset:0 sc1
    buffer_load_dwordx4 v[148:151], v15, s[20:23], s40 offen offset:0 sc1
    buffer_load_dwordx4 v[152:155], v9, s[20:23], s40 offen offset:1024 sc1
    buffer_load_dwordx4 v[156:159], v15, s[20:23], s40 offen offset:1024 sc1
    buffer_load_dwordx4 v[160:163], v9, s[20:23], s40 offen offset:2048 sc1
    buffer_load_dwordx4 v[164:167], v15, s[20:23], s40 offen offset:2048 sc1
    buffer_load_dwordx4 v[168:171], v9, s[20:23], s40 offen offset:3072 sc1
    buffer_load_dwordx4 v[172:175], v15, s[20:23], s40 offen offset:3072 sc1
    s_add_u32 s40, s40, 4096
    buffer_load_dwordx4 v[176:179], v9, s[20:23], s40 offen offset:0 sc1
    buffer_load_dwordx4 v[180:183], v15, s[20:23], s40 offen offset:0 sc1
    buffer_load_dwordx4 v[184:187], v9, s[20:23], s40 offen offset:1024 sc1
    buffer_load_dwordx4 v[188:191], v15, s[20:23], s40 offen offset:1024 sc1
    buffer_load_dwordx4 v[192:195], v9, s[20:23], s40 offen offset:2048 sc1
    buffer_load_dwordx4 v[196:199], v15, s[20:23], s40 offen offset:2048 sc1
    buffer_load_dwordx4 v[200:203], v9, s[20:23], s40 offen offset:3072 sc1
    buffer_load_dwordx4 v[204:207], v15, s[20:23], s40 offen offset:3072 sc1
    s_add_u32 s40, s40, 4096
    buffer_load_dwordx4 v[208:211], v9, s[20:23], s40 offen offset:0 sc1
    buffer_load_dwordx4 v[212:215], v15, s[20:23], s40 offen offset:0 sc1
    buffer_load_dwordx4 v[216:219], v9, s[20:23], s40 offen offset:1024 sc1
    buffer_load_dwordx4 v[220:223], v15, s[20:23], s40 offen offset:1024 sc1
    buffer_load_dwordx4 v[224:227], v9, s[20:23], s40 offen offset:2048 sc1
    buffer_load_dwordx4 v[228:231], v15, s[20:23], s40 offen offset:2048 sc1
    buffer_load_dwordx4 v[232:235], v9, s[20:23], s40 offen offset:3072 sc1
    buffer_load_dwordx4 v[236:239], v15, s[20:23], s40 offen offset:3072 sc1
    s_add_u32 s40, s40, 4096
    buffer_load_dwordx4 v[240:243], v9, s[20:23], s40 offen offset:0 sc1
    buffer_load_dwordx4 v[244:247], v15, s[20:23], s40 offen offset:0 sc1
    buffer_load_dwordx4 v[248:251], v9, s[20:23], s40 offen offset:1024 sc1
    buffer_load_dwordx4 v[252:255], v15, s[20:23], s40 offen offset:1024 sc1
    v_lshrrev_b32 v7, 1, v4
    v_lshlrev_b32 v22, 8, v7
    v_lshl_add_u32 v22, v3, 4, v22
    v_and_b32 v7, 1, v4
    v_mul_u32_u24 v7, 18432, v7
    v_add_u32 v22, v7, v22
    s_lshl_b32 s43, s34, 10
    s_add_u32 s43, s43, s42
    v_lshrrev_b32 v7, 5, v1
    v_lshl_add_u32 v23, v7, 4, v3
    v_lshlrev_b32 v23, 2, v23
    s_lshl_b32 s45, s34, 7
    s_add_u32 s44, s44, s45
    v_add_u32 v18, 163584, v21
    s_waitcnt vmcnt(36)
    v_lshlrev_b32 v32, 16, v80
    v_and_b32 v33, 0xffff0000, v80
    v_lshlrev_b32 v34, 16, v81
    v_and_b32 v35, 0xffff0000, v81
    v_lshlrev_b32 v36, 16, v82
    v_and_b32 v37, 0xffff0000, v82
    v_lshlrev_b32 v38, 16, v83
    v_and_b32 v39, 0xffff0000, v83
    v_lshlrev_b32 v40, 16, v84
    v_and_b32 v41, 0xffff0000, v84
    v_lshlrev_b32 v42, 16, v85
    v_and_b32 v43, 0xffff0000, v85
    v_lshlrev_b32 v44, 16, v86
    v_and_b32 v45, 0xffff0000, v86
    v_lshlrev_b32 v46, 16, v87
    v_and_b32 v47, 0xffff0000, v87
    s_setprio 0
    s_barrier
    s_mul_i32 s41, s32, 36864
    s_lshl_b32 s46, s3, 10
    s_add_u32 s41, s41, s46
    s_add_u32 s41, s41, 7413760
    s_barrier
    s_add_u32 m0, s46, 122880
    s_add_u32 s47, s41, 0
    buffer_load_dwordx4 v9, s[20:23], s47 offen sc1 lds
    s_add_u32 m0, s46, 131072
    s_add_u32 s47, s41, 8192
    buffer_load_dwordx4 v9, s[20:23], s47 offen sc1 lds
    s_add_u32 m0, s46, 139264
    s_add_u32 s47, s41, 16384
    buffer_load_dwordx4 v9, s[20:23], s47 offen sc1 lds
    s_add_u32 m0, s46, 147456
    s_add_u32 s47, s41, 24576
    buffer_load_dwordx4 v9, s[20:23], s47 offen sc1 lds
    s_waitcnt vmcnt(0)
    s_barrier
    ds_read_b128 v[48:51], v16 offset:0
    ds_read_b128 v[52:55], v16 offset:2048
    ds_read_b128 v[56:59], v16 offset:1024
    ds_read_b128 v[60:63], v16 offset:3072
    ds_read_b128 v[64:67], v16 offset:4096
    ds_read_b128 v[68:71], v16 offset:6144
    ds_read_b128 v[72:75], v16 offset:5120
    ds_read_b128 v[76:79], v16 offset:7168
    ds_read_b128 v[80:83], v16 offset:8192
    ds_read_b128 v[84:87], v16 offset:10240
    ds_read_b128 v[88:91], v16 offset:9216
    ds_read_b128 v[92:95], v16 offset:11264
    s_waitcnt lgkmcnt(10)
    v_mfma_f32_16x16x32_bf16 v[32:35], v[112:115], v[48:51], v[32:35]
    v_mfma_f32_16x16x32_bf16 v[40:43], v[116:119], v[48:51], v[40:43]
    v_mfma_f32_16x16x32_bf16 v[36:39], v[112:115], v[52:55], v[36:39]
    v_mfma_f32_16x16x32_bf16 v[44:47], v[116:119], v[52:55], v[44:47]
    s_waitcnt lgkmcnt(8)
    v_mfma_f32_16x16x32_bf16 v[32:35], v[120:123], v[56:59], v[32:35]
    ds_read_b128 v[48:51], v16 offset:12288
    v_mfma_f32_16x16x32_bf16 v[40:43], v[124:127], v[56:59], v[40:43]
    ds_read_b128 v[52:55], v16 offset:14336
    v_mfma_f32_16x16x32_bf16 v[36:39], v[120:123], v[60:63], v[36:39]
    v_mfma_f32_16x16x32_bf16 v[44:47], v[124:127], v[60:63], v[44:47]
    s_waitcnt lgkmcnt(8)
    v_mfma_f32_16x16x32_bf16 v[32:35], v[128:131], v[64:67], v[32:35]
    ds_read_b128 v[56:59], v16 offset:13312
    v_mfma_f32_16x16x32_bf16 v[40:43], v[132:135], v[64:67], v[40:43]
    ds_read_b128 v[60:63], v16 offset:15360
    v_mfma_f32_16x16x32_bf16 v[36:39], v[128:131], v[68:71], v[36:39]
    v_mfma_f32_16x16x32_bf16 v[44:47], v[132:135], v[68:71], v[44:47]
    s_waitcnt lgkmcnt(8)
    v_mfma_f32_16x16x32_bf16 v[32:35], v[136:139], v[72:75], v[32:35]
    ds_read_b128 v[64:67], v16 offset:16384
    v_mfma_f32_16x16x32_bf16 v[40:43], v[140:143], v[72:75], v[40:43]
    ds_read_b128 v[68:71], v16 offset:18432
    v_mfma_f32_16x16x32_bf16 v[36:39], v[136:139], v[76:79], v[36:39]
    v_mfma_f32_16x16x32_bf16 v[44:47], v[140:143], v[76:79], v[44:47]
    s_waitcnt lgkmcnt(8)
    v_mfma_f32_16x16x32_bf16 v[32:35], v[144:147], v[80:83], v[32:35]
    ds_read_b128 v[72:75], v16 offset:17408
    v_mfma_f32_16x16x32_bf16 v[40:43], v[148:151], v[80:83], v[40:43]
    ds_read_b128 v[76:79], v16 offset:19456
    v_mfma_f32_16x16x32_bf16 v[36:39], v[144:147], v[84:87], v[36:39]
    v_mfma_f32_16x16x32_bf16 v[44:47], v[148:151], v[84:87], v[44:47]
    s_waitcnt lgkmcnt(8)
    v_mfma_f32_16x16x32_bf16 v[32:35], v[152:155], v[88:91], v[32:35]
    ds_read_b128 v[80:83], v16 offset:20480
    v_mfma_f32_16x16x32_bf16 v[40:43], v[156:159], v[88:91], v[40:43]
    ds_read_b128 v[84:87], v16 offset:22528
    v_mfma_f32_16x16x32_bf16 v[36:39], v[152:155], v[92:95], v[36:39]
    v_mfma_f32_16x16x32_bf16 v[44:47], v[156:159], v[92:95], v[44:47]
    s_waitcnt lgkmcnt(8)
    v_mfma_f32_16x16x32_bf16 v[32:35], v[160:163], v[48:51], v[32:35]
    ds_read_b128 v[88:91], v16 offset:21504
    v_mfma_f32_16x16x32_bf16 v[40:43], v[164:167], v[48:51], v[40:43]
    ds_read_b128 v[92:95], v16 offset:23552
    v_mfma_f32_16x16x32_bf16 v[36:39], v[160:163], v[52:55], v[36:39]
    v_mfma_f32_16x16x32_bf16 v[44:47], v[164:167], v[52:55], v[44:47]
    s_waitcnt lgkmcnt(8)
    v_mfma_f32_16x16x32_bf16 v[32:35], v[168:171], v[56:59], v[32:35]
    ds_read_b128 v[48:51], v16 offset:24576
    v_mfma_f32_16x16x32_bf16 v[40:43], v[172:175], v[56:59], v[40:43]
    ds_read_b128 v[52:55], v16 offset:26624
    v_mfma_f32_16x16x32_bf16 v[36:39], v[168:171], v[60:63], v[36:39]
    v_mfma_f32_16x16x32_bf16 v[44:47], v[172:175], v[60:63], v[44:47]
    s_waitcnt lgkmcnt(8)
    v_mfma_f32_16x16x32_bf16 v[32:35], v[176:179], v[64:67], v[32:35]
    ds_read_b128 v[56:59], v16 offset:25600
    v_mfma_f32_16x16x32_bf16 v[40:43], v[180:183], v[64:67], v[40:43]
    ds_read_b128 v[60:63], v16 offset:27648
    v_mfma_f32_16x16x32_bf16 v[36:39], v[176:179], v[68:71], v[36:39]
    v_mfma_f32_16x16x32_bf16 v[44:47], v[180:183], v[68:71], v[44:47]
    s_waitcnt lgkmcnt(8)
    v_mfma_f32_16x16x32_bf16 v[32:35], v[184:187], v[72:75], v[32:35]
    ds_read_b128 v[64:67], v16 offset:28672
    v_mfma_f32_16x16x32_bf16 v[40:43], v[188:191], v[72:75], v[40:43]
    ds_read_b128 v[68:71], v16 offset:30720
    v_mfma_f32_16x16x32_bf16 v[36:39], v[184:187], v[76:79], v[36:39]
    v_mfma_f32_16x16x32_bf16 v[44:47], v[188:191], v[76:79], v[44:47]
    s_waitcnt lgkmcnt(8)
    v_mfma_f32_16x16x32_bf16 v[32:35], v[192:195], v[80:83], v[32:35]
    ds_read_b128 v[72:75], v16 offset:29696
    v_mfma_f32_16x16x32_bf16 v[40:43], v[196:199], v[80:83], v[40:43]
    ds_read_b128 v[76:79], v16 offset:31744
    v_mfma_f32_16x16x32_bf16 v[36:39], v[192:195], v[84:87], v[36:39]
    v_mfma_f32_16x16x32_bf16 v[44:47], v[196:199], v[84:87], v[44:47]
    s_waitcnt lgkmcnt(8)
    v_mfma_f32_16x16x32_bf16 v[32:35], v[200:203], v[88:91], v[32:35]
    ds_read_b32 v80, v17 offset:0
    ds_read_b32 v81, v17 offset:128
    ds_read_b32 v82, v17 offset:256
    ds_read_b32 v83, v17 offset:384
    v_mfma_f32_16x16x32_bf16 v[40:43], v[204:207], v[88:91], v[40:43]
    ds_read_b32 v84, v17 offset:64
    ds_read_b32 v85, v17 offset:192
    ds_read_b32 v86, v17 offset:320
    ds_read_b32 v87, v17 offset:448
    v_mfma_f32_16x16x32_bf16 v[36:39], v[200:203], v[92:95], v[36:39]
    v_mfma_f32_16x16x32_bf16 v[44:47], v[204:207], v[92:95], v[44:47]
    s_waitcnt lgkmcnt(14)
    v_mfma_f32_16x16x32_bf16 v[32:35], v[208:211], v[48:51], v[32:35]
    ds_read_b32 v88, v17 offset:2048
    ds_read_b32 v89, v17 offset:2176
    ds_read_b32 v90, v17 offset:2304
    ds_read_b32 v91, v17 offset:2432
    v_mfma_f32_16x16x32_bf16 v[40:43], v[212:215], v[48:51], v[40:43]
    ds_read_b32 v92, v17 offset:2112
    ds_read_b32 v93, v17 offset:2240
    ds_read_b32 v94, v17 offset:2368
    ds_read_b32 v95, v17 offset:2496
    v_mfma_f32_16x16x32_bf16 v[36:39], v[208:211], v[52:55], v[36:39]
    v_mfma_f32_16x16x32_bf16 v[44:47], v[212:215], v[52:55], v[44:47]
    s_waitcnt lgkmcnt(14)
    v_mfma_f32_16x16x32_bf16 v[32:35], v[216:219], v[56:59], v[32:35]
    v_mfma_f32_16x16x32_bf16 v[40:43], v[220:223], v[56:59], v[40:43]
    v_mfma_f32_16x16x32_bf16 v[36:39], v[216:219], v[60:63], v[36:39]
    v_mfma_f32_16x16x32_bf16 v[44:47], v[220:223], v[60:63], v[44:47]
    v_mfma_f32_16x16x32_bf16 v[32:35], v[224:227], v[64:67], v[32:35]
    v_mfma_f32_16x16x32_bf16 v[40:43], v[228:231], v[64:67], v[40:43]
    v_mfma_f32_16x16x32_bf16 v[36:39], v[224:227], v[68:71], v[36:39]
    v_mfma_f32_16x16x32_bf16 v[44:47], v[228:231], v[68:71], v[44:47]
    v_mfma_f32_16x16x32_bf16 v[32:35], v[232:235], v[72:75], v[32:35]
    v_mfma_f32_16x16x32_bf16 v[40:43], v[236:239], v[72:75], v[40:43]
    v_mfma_f32_16x16x32_bf16 v[36:39], v[232:235], v[76:79], v[36:39]
    v_mfma_f32_16x16x32_bf16 v[44:47], v[236:239], v[76:79], v[44:47]
    s_waitcnt lgkmcnt(8)
    v_mfma_f32_16x16x32_bf16 v[32:35], v[240:243], v[80:83], v[32:35]
    v_mfma_f32_16x16x32_bf16 v[40:43], v[244:247], v[80:83], v[40:43]
    v_mfma_f32_16x16x32_bf16 v[36:39], v[240:243], v[84:87], v[36:39]
    v_mfma_f32_16x16x32_bf16 v[44:47], v[244:247], v[84:87], v[44:47]
    s_waitcnt lgkmcnt(0)
    v_mfma_f32_16x16x32_bf16 v[32:35], v[248:251], v[88:91], v[32:35]
    v_mfma_f32_16x16x32_bf16 v[40:43], v[252:255], v[88:91], v[40:43]
    v_mfma_f32_16x16x32_bf16 v[36:39], v[248:251], v[92:95], v[36:39]
    v_mfma_f32_16x16x32_bf16 v[44:47], v[252:255], v[92:95], v[44:47]
    v_mov_b32 v24, 163332
    s_mov_b32 s59, 0
LW_40:
    ds_read_b32 v25, v24
    s_waitcnt lgkmcnt(0)
    v_cmp_gt_u32 vcc, 2, v25
    s_add_u32 s59, s59, 1
    s_cbranch_vccz LWD_41
    s_sleep 1
    s_cmp_lt_u32 s59, 16000000
    s_cbranch_scc1 LW_40
LWD_41:
    ds_read_b32 v104, v18
    ds_read_b32 v105, v18 offset:64
    v_mov_b32 v106, 0
    v_mov_b32 v107, 0
    s_add_u32 s46, s43, 9773056
    s_add_u32 s47, s43, 12132352
    v_cvt_pk_bf16_f32 v88, v32, v33
    v_cvt_pk_bf16_f32 v89, v34, v35
    v_lshlrev_b32 v32, 16, v88
    v_and_b32 v33, 0xffff0000, v88
    v_lshlrev_b32 v34, 16, v89
    v_and_b32 v35, 0xffff0000, v89
    v_cvt_pk_bf16_f32 v90, v36, v37
    v_cvt_pk_bf16_f32 v91, v38, v39
    v_lshlrev_b32 v36, 16, v90
    v_and_b32 v37, 0xffff0000, v90
    v_lshlrev_b32 v38, 16, v91
    v_and_b32 v39, 0xffff0000, v91
    v_cvt_pk_bf16_f32 v96, v40, v41
    v_cvt_pk_bf16_f32 v97, v42, v43
    v_lshlrev_b32 v40, 16, v96
    v_and_b32 v41, 0xffff0000, v96
    v_lshlrev_b32 v42, 16, v97
    v_and_b32 v43, 0xffff0000, v97
    v_cvt_pk_bf16_f32 v98, v44, v45
    v_cvt_pk_bf16_f32 v99, v46, v47
    v_lshlrev_b32 v44, 16, v98
    v_and_b32 v45, 0xffff0000, v98
    v_lshlrev_b32 v46, 16, v99
    v_and_b32 v47, 0xffff0000, v99
    s_waitcnt lgkmcnt(0)
    v_sub_f32 v32, v32, v104
    v_sub_f32 v33, v33, v104
    v_sub_f32 v34, v34, v104
    v_sub_f32 v35, v35, v104
    v_cvt_pk_bf16_f32 v92, v32, v33
    v_cvt_pk_bf16_f32 v93, v34, v35
    v_sub_f32 v36, v36, v105
    v_sub_f32 v37, v37, v105
    v_sub_f32 v38, v38, v105
    v_sub_f32 v39, v39, v105
    v_cvt_pk_bf16_f32 v94, v36, v37
    v_cvt_pk_bf16_f32 v95, v38, v39
    v_permlane16_swap_b32 v88, v90
    v_permlane16_swap_b32 v89, v91
    v_permlane16_swap_b32 v92, v94
    v_permlane16_swap_b32 v93, v95
    buffer_store_dwordx4 v[92:95], v22, s[20:23], s47 offen offset:0 sc1
    v_sub_f32 v40, v40, v104
    v_sub_f32 v41, v41, v104
    v_sub_f32 v42, v42, v104
    v_sub_f32 v43, v43, v104
    v_cvt_pk_bf16_f32 v100, v40, v41
    v_cvt_pk_bf16_f32 v101, v42, v43
    v_sub_f32 v44, v44, v105
    v_sub_f32 v45, v45, v105
    v_sub_f32 v46, v46, v105
    v_sub_f32 v47, v47, v105
    v_cvt_pk_bf16_f32 v102, v44, v45
    v_cvt_pk_bf16_f32 v103, v46, v47
    v_permlane16_swap_b32 v96, v98
    v_permlane16_swap_b32 v97, v99
    v_permlane16_swap_b32 v100, v102
    v_permlane16_swap_b32 v101, v103
    buffer_store_dwordx4 v[100:103], v22, s[20:23], s47 offen offset:512 sc1
    buffer_store_dwordx4 v[88:91], v22, s[20:23], s46 offen offset:0 sc1
    buffer_store_dwordx4 v[96:99], v22, s[20:23], s46 offen offset:512 sc1
    v_fmac_f32 v106, v32, v32
    v_fmac_f32 v106, v33, v33
    v_fmac_f32 v106, v34, v34
    v_fmac_f32 v106, v35, v35
    v_fmac_f32 v107, v36, v36
    v_fmac_f32 v107, v37, v37
    v_fmac_f32 v107, v38, v38
    v_fmac_f32 v107, v39, v39
    v_fmac_f32 v106, v40, v40
    v_fmac_f32 v106, v41, v41
    v_fmac_f32 v106, v42, v42
    v_fmac_f32 v106, v43, v43
    v_fmac_f32 v107, v44, v44
    v_fmac_f32 v107, v45, v45
    v_fmac_f32 v107, v46, v46
    v_fmac_f32 v107, v47, v47
    s_nop 1
    v_permlane32_swap_b32 v106, v107
    s_nop 0
    v_add_f32 v106, v106, v107
    v_mov_b32 v107, v106
    s_nop 1
    v_permlane16_swap_b32 v106, v107
    s_nop 0
    v_add_f32 v106, v106, v107
    buffer_store_dword v106, v23, s[20:23], s44 offen sc1
C_JOIN:
C_JOIN2:
    s_lshl_b32 s73, s32, 8
    s_add_u32 s73, s73, 131072
PH_D:
    v_and_b32 v1, 63, v0
    v_and_b32 v3, 15, v1
    v_lshrrev_b32 v4, 4, v1
    v_and_b32 v5, 3, v1
    s_lshl_b32 s32, s70, 3
    s_add_u32 s32, s32, s3
    v_lshlrev_b32 v9, 4, v1
    s_mul_i32 s40, s71, 331776
    s_mul_i32 s42, s3, 4608
    s_add_u32 s40, s40, s42
    s_add_u32 s40, s40, 42967040
    s_add_u32 s40, s40, 73728
    s_mul_i32 s41, s32, 36864
    s_add_u32 s41, s41, 12132352
    v_lshrrev_b32 v6, 2, v3
    v_and_b32 v7, 1, v4
    v_lshl_add_u32 v6, v7, 2, v6
    v_lshrrev_b32 v7, 1, v4
    v_lshl_add_u32 v6, v7, 4, v6
    v_mul_u32_u24 v6, 96, v6
    v_lshl_add_u32 v10, v5, 3, v6
    v_mov_b32 v10, v9
    v_add_u32 v11, 61440, v10
    v_add_u32 v12, 122880, v10
    v_lshrrev_b32 v7, 1, v4
    v_lshlrev_b32 v13, 8, v7
    v_lshl_add_u32 v13, v3, 4, v13
    v_and_b32 v7, 1, v4
    v_mul_u32_u24 v7, 1024, v7
    v_add_u32 v13, v7, v13
    v_add_u32 v15, 18432, v9
    s_lshr_b32 s44, s32, 2
    s_mul_i32 s44, s44, 1179648
    s_and_b32 s45, s32, 3
    s_lshl_b32 s45, s45, 11
    s_add_u32 s44, s44, s45
    s_add_u32 s44, s44, 14655488
    s_lshr_b32 s48, s71, 3
    s_mul_i32 s45, s48, 72
    s_and_b32 s46, s71, 7
    s_mul_i32 s46, s46, 3
    s_add_u32 s45, s45, s46
    s_lshl_b32 s49, s70, 2
    s_add_u32 s49, s49, s48
    s_mul_i32 s49, s49, 3
    s_lshl_b32 s49, s49, 8
    s_add_u32 s49, s49, 8192
    s_and_b32 s30, s2, 1
    s_bfe_u32 s31, s2, 0x20001
    s_lshl_b32 s30, s30, 3
    s_lshr_b32 s35, s2, 5
    s_add_u32 s35, s35, s30
    s_bfe_u32 s33, s2, 0x20003
    s_and_b32 s36, s3, 1
    s_bfe_u32 s63, s3, 0x10001
    s_cmp_eq_u32 s63, 0
    s_cselect_b32 s37, s33, s35
    s_mov_b32 s62, 16384
    s_cmov_b32 s62, 18432
    s_mov_b32 s38, 14655488
    s_cmov_b32 s38, 53600256
    s_cselect_b32 s65, 0, 9216
    s_mul_i32 s37, s37, 72
    s_mul_i32 s60, s31, 18
    s_add_u32 s60, s60, s37
    s_mul_i32 s60, s60, s62
    s_add_u32 s60, s60, s38
    s_lshr_b32 s61, s62, 1
    s_mul_i32 s61, s61, s36
    s_add_u32 s60, s60, s61
    s_mul_i32 s61, s36, 17408
    s_add_u32 s61, s61, s65
    s_mov_b32 s66, 36864
    s_lshr_b32 s64, s35, 1
    s_lshl_b32 s64, s64, 2
    s_add_u32 s64, s64, s31
    s_mul_i32 s64, s64, 3
    s_lshl_b32 s64, s64, 8
    s_add_u32 s64, s64, 8192
    s_lshl_b32 s46, s70, 3
    s_lshl_b32 s46, s46, 8
    s_add_u32 s46, s46, 131072
    v_and_b32 v26, 7, v1
    v_lshl_add_u32 v26, v26, 8, s46
    v_mov_b32 v27, 4
    v_mov_b32 v2, 1
    s_and_b32 s46, s3, 6
    s_cmp_eq_u32 s46, 2
    s_cbranch_scc1 C_NOWAIT
    s_waitcnt vmcnt(0)
C_NOWAIT:
    s_barrier
    s_cmp_eq_u32 s3, 4
    s_cbranch_scc0 SKIP_42
    s_mov_b64 exec, 1
    buffer_atomic_add v2, off, s[20:23], s73
    s_mov_b64 exec, -1
SKIP_42:
    s_add_u32 m0, s42, 73728
    s_nop 0
    buffer_load_dwordx4 v9, s[20:23], s40 offen offset:0 sc1 lds
    s_add_u32 m0, s42, 73728
    s_nop 0
    buffer_load_dwordx4 v9, s[20:23], s40 offen offset:1024 sc1 lds
    s_add_u32 m0, s42, 73728
    s_nop 0
    buffer_load_dwordx4 v9, s[20:23], s40 offen offset:2048 sc1 lds
    s_add_u32 m0, s42, 73728
    s_nop 0
    buffer_load_dwordx4 v9, s[20:23], s40 offen offset:3072 sc1 lds
    s_add_u32 m0, s42, 74752
    s_add_u32 s40, s40, 1024
    s_mov_b32 exec_hi, 0
    buffer_load_dwordx4 v9, s[20:23], s40 offen offset:3072 sc1 lds
    s_mov_b32 exec_hi, -1
    s_add_u32 s40, s40, 35840
    s_cmp_eq_u32 s3, 4
    s_cbranch_scc0 SKIP_43
    s_mov_b32 s59, 0
POLL_44:
    buffer_load_dword v28, v26, s[20:23], 0 offen sc1
    s_waitcnt vmcnt(0)
POLLC_46:
    v_cmp_lt_u32 vcc, v28, v27
    s_add_u32 s59, s59, 1
    s_cbranch_vccz POLLD_45
    s_sleep 1
    s_cmp_lt_u32 s59, 2000000
    s_cbranch_scc1 POLL_44
POLLD_45:
SKIP_43:
    s_waitcnt vmcnt(0)
    s_barrier
    s_cmp_ge_u32 s3, 4
    s_cbranch_scc0 D_NP
    s_setprio 1
D_NP:
    buffer_load_dwordx4 v[32:35], v9, s[20:23], s41 offen offset:0 sc1
    buffer_load_dwordx4 v[36:39], v15, s[20:23], s41 offen offset:0 sc1
    buffer_load_dwordx4 v[40:43], v9, s[20:23], s41 offen offset:1024 sc1
    buffer_load_dwordx4 v[44:47], v15, s[20:23], s41 offen offset:1024 sc1
    ds_read_b128 v[224:227], v10 offset:0
    ds_read_b128 v[228:231], v10 offset:3072
    ds_read_b128 v[232:235], v10 offset:6144
    ds_read_b128 v[236:239], v10 offset:9216
    ds_read_b128 v[240:243], v10 offset:1024
    ds_read_b128 v[244:247], v10 offset:4096
    ds_read_b128 v[248:251], v10 offset:7168
    ds_read_b128 v[252:255], v10 offset:10240
    buffer_load_dwordx4 v[48:51], v9, s[20:23], s41 offen offset:2048 sc1
    buffer_load_dwordx4 v[52:55], v15, s[20:23], s41 offen offset:2048 sc1
    buffer_load_dwordx4 v[56:59], v9, s[20:23], s41 offen offset:3072 sc1
    buffer_load_dwordx4 v[60:63], v15, s[20:23], s41 offen offset:3072 sc1
    s_add_u32 s41, s41, 4096
    buffer_load_dwordx4 v[64:67], v9, s[20:23], s41 offen offset:0 sc1
    buffer_load_dwordx4 v[68:71], v15, s[20:23], s41 offen offset:0 sc1
    buffer_load_dwordx4 v[72:75], v9, s[20:23], s41 offen offset:1024 sc1
    buffer_load_dwordx4 v[76:79], v15, s[20:23], s41 offen offset:1024 sc1
    s_waitcnt vmcnt(10)
    s_waitcnt lgkmcnt(6)
    v_mfma_f32_16x16x32_bf16 v[176:179], v[224:227], v[32:35], 0
    s_waitcnt vmcnt(8)
    v_mfma_f32_16x16x32_bf16 v[176:179], v[228:231], v[40:43], v[176:179]
    v_mfma_f32_16x16x32_bf16 v[180:183], v[224:227], v[36:39], 0
    v_mfma_f32_16x16x32_bf16 v[180:183], v[228:231], v[44:47], v[180:183]
    ds_read_b128 v[224:227], v10 offset:2048
    s_waitcnt lgkmcnt(5)
    v_mfma_f32_16x16x32_bf16 v[184:187], v[232:235], v[32:35], 0
    v_mfma_f32_16x16x32_bf16 v[184:187], v[236:239], v[40:43], v[184:187]
    ds_read_b128 v[228:231], v10 offset:5120
    v_mfma_f32_16x16x32_bf16 v[188:191], v[232:235], v[36:39], 0
    v_mfma_f32_16x16x32_bf16 v[188:191], v[236:239], v[44:47], v[188:191]
    ds_read_b128 v[232:235], v10 offset:8192
    buffer_load_dwordx4 v[80:83], v9, s[20:23], s41 offen offset:2048 sc1
    buffer_load_dwordx4 v[84:87], v15, s[20:23], s41 offen offset:2048 sc1
    s_waitcnt lgkmcnt(5)
    v_mfma_f32_16x16x32_bf16 v[192:195], v[240:243], v[32:35], 0
    v_mfma_f32_16x16x32_bf16 v[192:195], v[244:247], v[40:43], v[192:195]
    ds_read_b128 v[236:239], v10 offset:11264
    v_mfma_f32_16x16x32_bf16 v[196:199], v[240:243], v[36:39], 0
    v_mfma_f32_16x16x32_bf16 v[196:199], v[244:247], v[44:47], v[196:199]
    ds_read_b128 v[240:243], v10 offset:12288
    s_waitcnt lgkmcnt(5)
    v_mfma_f32_16x16x32_bf16 v[200:203], v[248:251], v[32:35], 0
    v_mfma_f32_16x16x32_bf16 v[200:203], v[252:255], v[40:43], v[200:203]
    ds_read_b128 v[244:247], v10 offset:15360
    v_mfma_f32_16x16x32_bf16 v[204:207], v[248:251], v[36:39], 0
    v_mfma_f32_16x16x32_bf16 v[204:207], v[252:255], v[44:47], v[204:207]
    ds_read_b128 v[248:251], v10 offset:18432
    buffer_load_dwordx4 v[88:91], v9, s[20:23], s41 offen offset:3072 sc1
    buffer_load_dwordx4 v[92:95], v15, s[20:23], s41 offen offset:3072 sc1
    s_add_u32 s41, s41, 4096
    s_waitcnt lgkmcnt(5)
    v_mfma_f32_16x16x32_bf16 v[208:211], v[224:227], v[32:35], 0
    v_mfma_f32_16x16x32_bf16 v[208:211], v[228:231], v[40:43], v[208:211]
    ds_read_b128 v[252:255], v10 offset:21504
    v_mfma_f32_16x16x32_bf16 v[212:215], v[224:227], v[36:39], 0
    v_mfma_f32_16x16x32_bf16 v[212:215], v[228:231], v[44:47], v[212:215]
    ds_read_b128 v[224:227], v10 offset:13312
    s_waitcnt lgkmcnt(5)
    v_mfma_f32_16x16x32_bf16 v[216:219], v[232:235], v[32:35], 0
    v_mfma_f32_16x16x32_bf16 v[216:219], v[236:239], v[40:43], v[216:219]
    ds_read_b128 v[228:231], v10 offset:16384
    v_mfma_f32_16x16x32_bf16 v[220:223], v[232:235], v[36:39], 0
    v_mfma_f32_16x16x32_bf16 v[220:223], v[236:239], v[44:47], v[220:223]
    ds_read_b128 v[232:235], v10 offset:19456
    s_waitcnt vmcnt(10)
    s_waitcnt lgkmcnt(5)
    v_mfma_f32_16x16x32_bf16 v[176:179], v[240:243], v[48:51], v[176:179]
    s_waitcnt vmcnt(8)
    v_mfma_f32_16x16x32_bf16 v[176:179], v[244:247], v[56:59], v[176:179]
    ds_read_b128 v[236:239], v10 offset:22528
    v_mfma_f32_16x16x32_bf16 v[180:183], v[240:243], v[52:55], v[180:183]
    v_mfma_f32_16x16x32_bf16 v[180:183], v[244:247], v[60:63], v[180:183]
    ds_read_b128 v[240:243], v10 offset:14336
    s_waitcnt lgkmcnt(5)
    v_mfma_f32_16x16x32_bf16 v[184:187], v[248:251], v[48:51], v[184:187]
    v_mfma_f32_16x16x32_bf16 v[184:187], v[252:255], v[56:59], v[184:187]
    ds_read_b128 v[244:247], v10 offset:17408
    v_mfma_f32_16x16x32_bf16 v[188:191], v[248:251], v[52:55], v[188:191]
    v_mfma_f32_16x16x32_bf16 v[188:191], v[252:255], v[60:63], v[188:191]
    ds_read_b128 v[248:251], v10 offset:20480
    buffer_load_dwordx4 v[96:99], v9, s[20:23], s41 offen offset:0 sc1
    buffer_load_dwordx4 v[100:103], v15, s[20:23], s41 offen offset:0 sc1
    s_waitcnt lgkmcnt(5)
    v_mfma_f32_16x16x32_bf16 v[192:195], v[224:227], v[48:51], v[192:195]
    v_mfma_f32_16x16x32_bf16 v[192:195], v[228:231], v[56:59], v[192:195]
    ds_read_b128 v[252:255], v10 offset:23552
    v_mfma_f32_16x16x32_bf16 v[196:199], v[224:227], v[52:55], v[196:199]
    v_mfma_f32_16x16x32_bf16 v[196:199], v[228:231], v[60:63], v[196:199]
    ds_read_b128 v[224:227], v10 offset:24576
    s_waitcnt lgkmcnt(5)
    v_mfma_f32_16x16x32_bf16 v[200:203], v[232:235], v[48:51], v[200:203]
    v_mfma_f32_16x16x32_bf16 v[200:203], v[236:239], v[56:59], v[200:203]
    ds_read_b128 v[228:231], v10 offset:27648
    v_mfma_f32_16x16x32_bf16 v[204:207], v[232:235], v[52:55], v[204:207]
    v_mfma_f32_16x16x32_bf16 v[204:207], v[236:239], v[60:63], v[204:207]
    ds_read_b128 v[232:235], v10 offset:30720
    buffer_load_dwordx4 v[104:107], v9, s[20:23], s41 offen offset:1024 sc1
    buffer_load_dwordx4 v[108:111], v15, s[20:23], s41 offen offset:1024 sc1
    s_waitcnt lgkmcnt(5)
    v_mfma_f32_16x16x32_bf16 v[208:211], v[240:243], v[48:51], v[208:211]
    v_mfma_f32_16x16x32_bf16 v[208:211], v[244:247], v[56:59], v[208:211]
    ds_read_b128 v[236:239], v10 offset:33792
    v_mfma_f32_16x16x32_bf16 v[212:215], v[240:243], v[52:55], v[212:215]
    v_mfma_f32_16x16x32_bf16 v[212:215], v[244:247], v[60:63], v[212:215]
    ds_read_b128 v[240:243], v10 offset:25600
    s_waitcnt lgkmcnt(5)
    v_mfma_f32_16x16x32_bf16 v[216:219], v[248:251], v[48:51], v[216:219]
    v_mfma_f32_16x16x32_bf16 v[216:219], v[252:255], v[56:59], v[216:219]
    ds_read_b128 v[244:247], v10 offset:28672
    v_mfma_f32_16x16x32_bf16 v[220:223], v[248:251], v[52:55], v[220:223]
    v_mfma_f32_16x16x32_bf16 v[220:223], v[252:255], v[60:63], v[220:223]
    ds_read_b128 v[248:251], v10 offset:31744
    s_waitcnt vmcnt(10)
    s_waitcnt lgkmcnt(5)
    v_mfma_f32_16x16x32_bf16 v[176:179], v[224:227], v[64:67], v[176:179]
    s_waitcnt vmcnt(8)
    v_mfma_f32_16x16x32_bf16 v[176:179], v[228:231], v[72:75], v[176:179]
    ds_read_b128 v[252:255], v10 offset:34816
    v_mfma_f32_16x16x32_bf16 v[180:183], v[224:227], v[68:71], v[180:183]
    v_mfma_f32_16x16x32_bf16 v[180:183], v[228:231], v[76:79], v[180:183]
    ds_read_b128 v[224:227], v10 offset:26624
    s_waitcnt lgkmcnt(5)
    v_mfma_f32_16x16x32_bf16 v[184:187], v[232:235], v[64:67], v[184:187]
    v_mfma_f32_16x16x32_bf16 v[184:187], v[236:239], v[72:75], v[184:187]
    ds_read_b128 v[228:231], v10 offset:29696
    v_mfma_f32_16x16x32_bf16 v[188:191], v[232:235], v[68:71], v[188:191]
    v_mfma_f32_16x16x32_bf16 v[188:191], v[236:239], v[76:79], v[188:191]
    ds_read_b128 v[232:235], v10 offset:32768
    buffer_load_dwordx4 v[112:115], v9, s[20:23], s41 offen offset:2048 sc1
    buffer_load_dwordx4 v[116:119], v15, s[20:23], s41 offen offset:2048 sc1
    s_waitcnt lgkmcnt(5)
    v_mfma_f32_16x16x32_bf16 v[192:195], v[240:243], v[64:67], v[192:195]
    v_mfma_f32_16x16x32_bf16 v[192:195], v[244:247], v[72:75], v[192:195]
    ds_read_b128 v[236:239], v10 offset:35840
    v_mfma_f32_16x16x32_bf16 v[196:199], v[240:243], v[68:71], v[196:199]
    v_mfma_f32_16x16x32_bf16 v[196:199], v[244:247], v[76:79], v[196:199]
    ds_read_b128 v[240:243], v10 offset:36864
    s_waitcnt lgkmcnt(5)
    v_mfma_f32_16x16x32_bf16 v[200:203], v[248:251], v[64:67], v[200:203]
    v_mfma_f32_16x16x32_bf16 v[200:203], v[252:255], v[72:75], v[200:203]
    ds_read_b128 v[244:247], v10 offset:39936
    v_mfma_f32_16x16x32_bf16 v[204:207], v[248:251], v[68:71], v[204:207]
    v_mfma_f32_16x16x32_bf16 v[204:207], v[252:255], v[76:79], v[204:207]
    ds_read_b128 v[248:251], v10 offset:43008
    buffer_load_dwordx4 v[120:123], v9, s[20:23], s41 offen offset:3072 sc1
    buffer_load_dwordx4 v[124:127], v15, s[20:23], s41 offen offset:3072 sc1
    s_add_u32 s41, s41, 4096
    s_waitcnt lgkmcnt(5)
    v_mfma_f32_16x16x32_bf16 v[208:211], v[224:227], v[64:67], v[208:211]
    v_mfma_f32_16x16x32_bf16 v[208:211], v[228:231], v[72:75], v[208:211]
    ds_read_b128 v[252:255], v10 offset:46080
    v_mfma_f32_16x16x32_bf16 v[212:215], v[224:227], v[68:71], v[212:215]
    v_mfma_f32_16x16x32_bf16 v[212:215], v[228:231], v[76:79], v[212:215]
    ds_read_b128 v[224:227], v10 offset:37888
    s_waitcnt lgkmcnt(5)
    v_mfma_f32_16x16x32_bf16 v[216:219], v[232:235], v[64:67], v[216:219]
    v_mfma_f32_16x16x32_bf16 v[216:219], v[236:239], v[72:75], v[216:219]
    ds_read_b128 v[228:231], v10 offset:40960
    v_mfma_f32_16x16x32_bf16 v[220:223], v[232:235], v[68:71], v[220:223]
    v_mfma_f32_16x16x32_bf16 v[220:223], v[236:239], v[76:79], v[220:223]
    ds_read_b128 v[232:235], v10 offset:44032
    s_waitcnt vmcnt(10)
    s_waitcnt lgkmcnt(5)
    v_mfma_f32_16x16x32_bf16 v[176:179], v[240:243], v[80:83], v[176:179]
    s_waitcnt vmcnt(8)
    v_mfma_f32_16x16x32_bf16 v[176:179], v[244:247], v[88:91], v[176:179]
    ds_read_b128 v[236:239], v10 offset:47104
    v_mfma_f32_16x16x32_bf16 v[180:183], v[240:243], v[84:87], v[180:183]
    v_mfma_f32_16x16x32_bf16 v[180:183], v[244:247], v[92:95], v[180:183]
    ds_read_b128 v[240:243], v10 offset:38912
    s_waitcnt lgkmcnt(5)
    v_mfma_f32_16x16x32_bf16 v[184:187], v[248:251], v[80:83], v[184:187]
    v_mfma_f32_16x16x32_bf16 v[184:187], v[252:255], v[88:91], v[184:187]
    ds_read_b128 v[244:247], v10 offset:41984
    v_mfma_f32_16x16x32_bf16 v[188:191], v[248:251], v[84:87], v[188:191]
    v_mfma_f32_16x16x32_bf16 v[188:191], v[252:255], v[92:95], v[188:191]
    ds_read_b128 v[248:251], v10 offset:45056
    buffer_load_dwordx4 v[128:131], v9, s[20:23], s41 offen offset:0 sc1
    buffer_load_dwordx4 v[132:135], v15, s[20:23], s41 offen offset:0 sc1
    s_waitcnt lgkmcnt(5)
    v_mfma_f32_16x16x32_bf16 v[192:195], v[224:227], v[80:83], v[192:195]
    v_mfma_f32_16x16x32_bf16 v[192:195], v[228:231], v[88:91], v[192:195]
    ds_read_b128 v[252:255], v10 offset:48128
    v_mfma_f32_16x16x32_bf16 v[196:199], v[224:227], v[84:87], v[196:199]
    v_mfma_f32_16x16x32_bf16 v[196:199], v[228:231], v[92:95], v[196:199]
    ds_read_b128 v[224:227], v10 offset:49152
    s_waitcnt lgkmcnt(5)
    v_mfma_f32_16x16x32_bf16 v[200:203], v[232:235], v[80:83], v[200:203]
    v_mfma_f32_16x16x32_bf16 v[200:203], v[236:239], v[88:91], v[200:203]
    ds_read_b128 v[228:231], v10 offset:52224
    v_mfma_f32_16x16x32_bf16 v[204:207], v[232:235], v[84:87], v[204:207]
    v_mfma_f32_16x16x32_bf16 v[204:207], v[236:239], v[92:95], v[204:207]
    ds_read_b128 v[232:235], v10 offset:55296
    buffer_load_dwordx4 v[136:139], v9, s[20:23], s41 offen offset:1024 sc1
    buffer_load_dwordx4 v[140:143], v15, s[20:23], s41 offen offset:1024 sc1
    s_waitcnt lgkmcnt(5)
    v_mfma_f32_16x16x32_bf16 v[208:211], v[240:243], v[80:83], v[208:211]
    v_mfma_f32_16x16x32_bf16 v[208:211], v[244:247], v[88:91], v[208:211]
    ds_read_b128 v[236:239], v10 offset:58368
    v_mfma_f32_16x16x32_bf16 v[212:215], v[240:243], v[84:87], v[212:215]
    v_mfma_f32_16x16x32_bf16 v[212:215], v[244:247], v[92:95], v[212:215]
    ds_read_b128 v[240:243], v10 offset:50176
    s_waitcnt lgkmcnt(5)
    v_mfma_f32_16x16x32_bf16 v[216:219], v[248:251], v[80:83], v[216:219]
    v_mfma_f32_16x16x32_bf16 v[216:219], v[252:255], v[88:91], v[216:219]
    ds_read_b128 v[244:247], v10 offset:53248
    v_mfma_f32_16x16x32_bf16 v[220:223], v[248:251], v[84:87], v[220:223]
    v_mfma_f32_16x16x32_bf16 v[220:223], v[252:255], v[92:95], v[220:223]
    ds_read_b128 v[248:251], v10 offset:56320
    s_waitcnt vmcnt(10)
    s_waitcnt lgkmcnt(5)
    v_mfma_f32_16x16x32_bf16 v[176:179], v[224:227], v[96:99], v[176:179]
    s_waitcnt vmcnt(8)
    v_mfma_f32_16x16x32_bf16 v[176:179], v[228:231], v[104:107], v[176:179]
    ds_read_b128 v[252:255], v10 offset:59392
    v_mfma_f32_16x16x32_bf16 v[180:183], v[224:227], v[100:103], v[180:183]
    v_mfma_f32_16x16x32_bf16 v[180:183], v[228:231], v[108:111], v[180:183]
    ds_read_b128 v[224:227], v10 offset:51200
    s_waitcnt lgkmcnt(5)
    v_mfma_f32_16x16x32_bf16 v[184:187], v[232:235], v[96:99], v[184:187]
    v_mfma_f32_16x16x32_bf16 v[184:187], v[236:239], v[104:107], v[184:187]
    ds_read_b128 v[228:231], v10 offset:54272
    v_mfma_f32_16x16x32_bf16 v[188:191], v[232:235], v[100:103], v[188:191]
    v_mfma_f32_16x16x32_bf16 v[188:191], v[236:239], v[108:111], v[188:191]
    ds_read_b128 v[232:235], v10 offset:57344
    buffer_load_dwordx4 v[144:147], v9, s[20:23], s41 offen offset:2048 sc1
    buffer_load_dwordx4 v[148:151], v15, s[20:23], s41 offen offset:2048 sc1
    s_waitcnt lgkmcnt(5)
    v_mfma_f32_16x16x32_bf16 v[192:195], v[240:243], v[96:99], v[192:195]
    v_mfma_f32_16x16x32_bf16 v[192:195], v[244:247], v[104:107], v[192:195]
    ds_read_b128 v[236:239], v10 offset:60416
    v_mfma_f32_16x16x32_bf16 v[196:199], v[240:243], v[100:103], v[196:199]
    v_mfma_f32_16x16x32_bf16 v[196:199], v[244:247], v[108:111], v[196:199]
    ds_read_b128 v[240:243], v10 offset:61440
    s_waitcnt lgkmcnt(5)
    v_mfma_f32_16x16x32_bf16 v[200:203], v[248:251], v[96:99], v[200:203]
    v_mfma_f32_16x16x32_bf16 v[200:203], v[252:255], v[104:107], v[200:203]
    ds_read_b128 v[244:247], v10 offset:64512
    v_mfma_f32_16x16x32_bf16 v[204:207], v[248:251], v[100:103], v[204:207]
    v_mfma_f32_16x16x32_bf16 v[204:207], v[252:255], v[108:111], v[204:207]
    ds_read_b128 v[248:251], v11 offset:6144
    buffer_load_dwordx4 v[152:155], v9, s[20:23], s41 offen offset:3072 sc1
    buffer_load_dwordx4 v[156:159], v15, s[20:23], s41 offen offset:3072 sc1
    s_add_u32 s41, s41, 4096
    s_waitcnt lgkmcnt(5)
    v_mfma_f32_16x16x32_bf16 v[208:211], v[224:227], v[96:99], v[208:211]
    v_mfma_f32_16x16x32_bf16 v[208:211], v[228:231], v[104:107], v[208:211]
    ds_read_b128 v[252:255], v11 offset:9216
    v_mfma_f32_16x16x32_bf16 v[212:215], v[224:227], v[100:103], v[212:215]
    v_mfma_f32_16x16x32_bf16 v[212:215], v[228:231], v[108:111], v[212:215]
    ds_read_b128 v[224:227], v10 offset:62464
    s_waitcnt lgkmcnt(5)
    v_mfma_f32_16x16x32_bf16 v[216:219], v[232:235], v[96:99], v[216:219]
    v_mfma_f32_16x16x32_bf16 v[216:219], v[236:239], v[104:107], v[216:219]
    ds_read_b128 v[228:231], v11 offset:4096
    v_mfma_f32_16x16x32_bf16 v[220:223], v[232:235], v[100:103], v[220:223]
    v_mfma_f32_16x16x32_bf16 v[220:223], v[236:239], v[108:111], v[220:223]
    ds_read_b128 v[232:235], v11 offset:7168
    s_waitcnt vmcnt(10)
    s_waitcnt lgkmcnt(5)
    v_mfma_f32_16x16x32_bf16 v[176:179], v[240:243], v[112:115], v[176:179]
    s_waitcnt vmcnt(8)
    v_mfma_f32_16x16x32_bf16 v[176:179], v[244:247], v[120:123], v[176:179]
    ds_read_b128 v[236:239], v11 offset:10240
    v_mfma_f32_16x16x32_bf16 v[180:183], v[240:243], v[116:119], v[180:183]
    v_mfma_f32_16x16x32_bf16 v[180:183], v[244:247], v[124:127], v[180:183]
    ds_read_b128 v[240:243], v10 offset:63488
    s_waitcnt lgkmcnt(5)
    v_mfma_f32_16x16x32_bf16 v[184:187], v[248:251], v[112:115], v[184:187]
    v_mfma_f32_16x16x32_bf16 v[184:187], v[252:255], v[120:123], v[184:187]
    ds_read_b128 v[244:247], v11 offset:5120
    v_mfma_f32_16x16x32_bf16 v[188:191], v[248:251], v[116:119], v[188:191]
    v_mfma_f32_16x16x32_bf16 v[188:191], v[252:255], v[124:127], v[188:191]
    ds_read_b128 v[248:251], v11 offset:8192
    buffer_load_dwordx4 v[160:163], v9, s[20:23], s41 offen offset:0 sc1
    buffer_load_dwordx4 v[164:167], v15, s[20:23], s41 offen offset:0 sc1
    s_waitcnt lgkmcnt(5)
    v_mfma_f32_16x16x32_bf16 v[192:195], v[224:227], v[112:115], v[192:195]
    v_mfma_f32_16x16x32_bf16 v[192:195], v[228:231], v[120:123], v[192:195]
    ds_read_b128 v[252:255], v11 offset:11264
    v_mfma_f32_16x16x32_bf16 v[196:199], v[224:227], v[116:119], v[196:199]
    v_mfma_f32_16x16x32_bf16 v[196:199], v[228:231], v[124:127], v[196:199]
    ds_read_b128 v[224:227], v11 offset:12288
    s_waitcnt lgkmcnt(5)
    v_mfma_f32_16x16x32_bf16 v[200:203], v[232:235], v[112:115], v[200:203]
    v_mfma_f32_16x16x32_bf16 v[200:203], v[236:239], v[120:123], v[200:203]
    ds_read_b128 v[228:231], v11 offset:15360
    s_add_u32 m0, s42, 110592
    s_nop 0
    buffer_load_dwordx4 v9, s[20:23], s40 offen offset:0 sc1 lds
    v_mfma_f32_16x16x32_bf16 v[204:207], v[232:235], v[116:119], v[204:207]
    v_mfma_f32_16x16x32_bf16 v[204:207], v[236:239], v[124:127], v[204:207]
    ds_read_b128 v[232:235], v11 offset:24576
    buffer_load_dwordx4 v[168:171], v9, s[20:23], s41 offen offset:1024 sc1
    buffer_load_dwordx4 v[172:175], v15, s[20:23], s41 offen offset:1024 sc1
    s_waitcnt lgkmcnt(5)
    v_mfma_f32_16x16x32_bf16 v[208:211], v[240:243], v[112:115], v[208:211]
    v_mfma_f32_16x16x32_bf16 v[208:211], v[244:247], v[120:123], v[208:211]
    ds_read_b128 v[236:239], v11 offset:18432
    v_mfma_f32_16x16x32_bf16 v[212:215], v[240:243], v[116:119], v[212:215]
    v_mfma_f32_16x16x32_bf16 v[212:215], v[244:247], v[124:127], v[212:215]
    ds_read_b128 v[240:243], v11 offset:21504
    s_add_u32 m0, s42, 110592
    s_nop 0
    buffer_load_dwordx4 v9, s[20:23], s40 offen offset:1024 sc1 lds
    s_waitcnt lgkmcnt(5)
    v_mfma_f32_16x16x32_bf16 v[216:219], v[248:251], v[112:115], v[216:219]
    v_mfma_f32_16x16x32_bf16 v[216:219], v[252:255], v[120:123], v[216:219]
    ds_read_b128 v[244:247], v11 offset:30720
    v_mfma_f32_16x16x32_bf16 v[220:223], v[248:251], v[116:119], v[220:223]
    v_mfma_f32_16x16x32_bf16 v[220:223], v[252:255], v[124:127], v[220:223]
    ds_read_b128 v[248:251], v11 offset:27648
    s_waitcnt vmcnt(12)
    s_waitcnt lgkmcnt(4)
    v_mfma_f32_16x16x32_bf16 v[176:179], v[224:227], v[128:131], v[176:179]
    s_waitcnt vmcnt(10)
    v_mfma_f32_16x16x32_bf16 v[176:179], v[228:231], v[136:139], v[176:179]
    ds_read_b128 v[252:255], v11 offset:36864
    s_add_u32 m0, s42, 110592
    s_nop 0
    buffer_load_dwordx4 v9, s[20:23], s40 offen offset:2048 sc1 lds
    s_waitcnt vmcnt(9)
    v_mfma_f32_16x16x32_bf16 v[176:179], v[232:235], v[144:147], v[176:179]
    v_mfma_f32_16x16x32_bf16 v[180:183], v[224:227], v[132:135], v[180:183]
    v_mfma_f32_16x16x32_bf16 v[180:183], v[228:231], v[140:143], v[180:183]
    ds_read_b128 v[224:227], v11 offset:39936
    v_mfma_f32_16x16x32_bf16 v[180:183], v[232:235], v[148:151], v[180:183]
    s_waitcnt lgkmcnt(3)
    v_mfma_f32_16x16x32_bf16 v[184:187], v[236:239], v[128:131], v[184:187]
    ds_read_b128 v[228:231], v11 offset:33792
    v_mfma_f32_16x16x32_bf16 v[184:187], v[240:243], v[136:139], v[184:187]
    s_add_u32 m0, s42, 110592
    s_nop 0
    buffer_load_dwordx4 v9, s[20:23], s40 offen offset:3072 sc1 lds
    v_mfma_f32_16x16x32_bf16 v[184:187], v[244:247], v[144:147], v[184:187]
    ds_read_b128 v[232:235], v11 offset:43008
    v_mfma_f32_16x16x32_bf16 v[188:191], v[236:239], v[132:135], v[188:191]
    v_mfma_f32_16x16x32_bf16 v[188:191], v[240:243], v[140:143], v[188:191]
    ds_read_b128 v[236:239], v11 offset:46080
    v_mfma_f32_16x16x32_bf16 v[188:191], v[244:247], v[148:151], v[188:191]
    s_waitcnt vmcnt(8)
    s_waitcnt lgkmcnt(3)
    v_mfma_f32_16x16x32_bf16 v[176:179], v[248:251], v[152:155], v[176:179]
    ds_read_b128 v[240:243], v11 offset:13312
    s_waitcnt vmcnt(6)
    v_mfma_f32_16x16x32_bf16 v[176:179], v[252:255], v[160:163], v[176:179]
    s_add_u32 m0, s42, 111616
    s_add_u32 s40, s40, 1024
    s_mov_b32 exec_hi, 0
    buffer_load_dwordx4 v9, s[20:23], s40 offen offset:3072 sc1 lds
    s_mov_b32 exec_hi, -1
    s_add_u32 s40, s40, 35840
    s_waitcnt vmcnt(4)
    v_mfma_f32_16x16x32_bf16 v[176:179], v[224:227], v[168:171], v[176:179]
    ds_read_b128 v[244:247], v11 offset:16384
    v_mfma_f32_16x16x32_bf16 v[180:183], v[248:251], v[156:159], v[180:183]
    v_mfma_f32_16x16x32_bf16 v[180:183], v[252:255], v[164:167], v[180:183]
    ds_read_b128 v[248:251], v11 offset:25600
    v_mfma_f32_16x16x32_bf16 v[180:183], v[224:227], v[172:175], v[180:183]
    s_waitcnt lgkmcnt(3)
    v_mfma_f32_16x16x32_bf16 v[184:187], v[228:231], v[152:155], v[184:187]
    ds_read_b128 v[252:255], v11 offset:19456
    v_mfma_f32_16x16x32_bf16 v[184:187], v[232:235], v[160:163], v[184:187]
    v_mfma_f32_16x16x32_bf16 v[184:187], v[236:239], v[168:171], v[184:187]
    ds_read_b128 v[224:227], v11 offset:22528
    v_mfma_f32_16x16x32_bf16 v[188:191], v[228:231], v[156:159], v[188:191]
    v_mfma_f32_16x16x32_bf16 v[188:191], v[232:235], v[164:167], v[188:191]
    ds_read_b128 v[228:231], v11 offset:31744
    v_mfma_f32_16x16x32_bf16 v[188:191], v[236:239], v[172:175], v[188:191]
    s_waitcnt lgkmcnt(3)
    v_mfma_f32_16x16x32_bf16 v[192:195], v[240:243], v[128:131], v[192:195]
    ds_read_b128 v[232:235], v11 offset:28672
    v_mfma_f32_16x16x32_bf16 v[192:195], v[244:247], v[136:139], v[192:195]
    v_mfma_f32_16x16x32_bf16 v[192:195], v[248:251], v[144:147], v[192:195]
    ds_read_b128 v[236:239], v11 offset:37888
    v_mfma_f32_16x16x32_bf16 v[196:199], v[240:243], v[132:135], v[196:199]
    v_mfma_f32_16x16x32_bf16 v[196:199], v[244:247], v[140:143], v[196:199]
    ds_read_b128 v[240:243], v11 offset:40960
    v_mfma_f32_16x16x32_bf16 v[196:199], v[248:251], v[148:151], v[196:199]
    s_waitcnt lgkmcnt(3)
    v_mfma_f32_16x16x32_bf16 v[200:203], v[252:255], v[128:131], v[200:203]
    ds_read_b128 v[244:247], v11 offset:34816
    v_mfma_f32_16x16x32_bf16 v[200:203], v[224:227], v[136:139], v[200:203]
    v_mfma_f32_16x16x32_bf16 v[200:203], v[228:231], v[144:147], v[200:203]
    ds_read_b128 v[248:251], v11 offset:44032
    s_lshr_b32 s46, s45, 1
    s_lshl_b32 s46, s46, 13
    v_mfma_f32_16x16x32_bf16 v[204:207], v[252:255], v[132:135], v[204:207]
    s_and_b32 s47, s45, 1
    s_lshl_b32 s47, s47, 9
    v_mfma_f32_16x16x32_bf16 v[204:207], v[224:227], v[140:143], v[204:207]
    ds_read_b128 v[252:255], v11 offset:47104
    s_add_u32 s46, s46, s47
    s_add_u32 s46, s46, s44
    s_add_u32 s45, s45, 1
    v_mfma_f32_16x16x32_bf16 v[204:207], v[228:231], v[148:151], v[204:207]
    v_max_f32 v176, 0, v176
    s_waitcnt lgkmcnt(3)
    v_mfma_f32_16x16x32_bf16 v[192:195], v[232:235], v[152:155], v[192:195]
    ds_read_b128 v[224:227], v11 offset:14336
    v_max_f32 v177, 0, v177
    v_mfma_f32_16x16x32_bf16 v[192:195], v[236:239], v[160:163], v[192:195]
    v_max_f32 v178, 0, v178
    v_mfma_f32_16x16x32_bf16 v[192:195], v[240:243], v[168:171], v[192:195]
    ds_read_b128 v[228:231], v11 offset:17408
    v_max_f32 v179, 0, v179
    v_mfma_f32_16x16x32_bf16 v[196:199], v[232:235], v[156:159], v[196:199]
    v_mul_f32 v176, v176, v184
    v_mfma_f32_16x16x32_bf16 v[196:199], v[236:239], v[164:167], v[196:199]
    ds_read_b128 v[232:235], v11 offset:26624
    v_mul_f32 v177, v177, v185
    v_mfma_f32_16x16x32_bf16 v[196:199], v[240:243], v[172:175], v[196:199]
    v_mul_f32 v178, v178, v186
    s_waitcnt lgkmcnt(3)
    v_mfma_f32_16x16x32_bf16 v[200:203], v[244:247], v[152:155], v[200:203]
    ds_read_b128 v[236:239], v11 offset:20480
    v_mul_f32 v179, v179, v187
    v_mfma_f32_16x16x32_bf16 v[200:203], v[248:251], v[160:163], v[200:203]
    v_cvt_pk_bf16_f32 v16, v176, v177
    v_mfma_f32_16x16x32_bf16 v[200:203], v[252:255], v[168:171], v[200:203]
    ds_read_b128 v[240:243], v11 offset:23552
    v_cvt_pk_bf16_f32 v17, v178, v179
    v_mfma_f32_16x16x32_bf16 v[204:207], v[244:247], v[156:159], v[204:207]
    v_max_f32 v180, 0, v180
    v_mfma_f32_16x16x32_bf16 v[204:207], v[248:251], v[164:167], v[204:207]
    ds_read_b128 v[244:247], v11 offset:32768
    v_max_f32 v181, 0, v181
    v_mfma_f32_16x16x32_bf16 v[204:207], v[252:255], v[172:175], v[204:207]
    v_max_f32 v182, 0, v182
    s_waitcnt lgkmcnt(3)
    v_mfma_f32_16x16x32_bf16 v[208:211], v[224:227], v[128:131], v[208:211]
    ds_read_b128 v[248:251], v11 offset:29696
    v_max_f32 v183, 0, v183
    v_mfma_f32_16x16x32_bf16 v[208:211], v[228:231], v[136:139], v[208:211]
    v_mul_f32 v180, v180, v188
    v_mfma_f32_16x16x32_bf16 v[208:211], v[232:235], v[144:147], v[208:211]
    ds_read_b128 v[252:255], v11 offset:38912
    v_mul_f32 v181, v181, v189
    v_mfma_f32_16x16x32_bf16 v[212:215], v[224:227], v[132:135], v[212:215]
    v_mul_f32 v182, v182, v190
    v_mfma_f32_16x16x32_bf16 v[212:215], v[228:231], v[140:143], v[212:215]
    ds_read_b128 v[224:227], v11 offset:41984
    v_mul_f32 v183, v183, v191
    v_mfma_f32_16x16x32_bf16 v[212:215], v[232:235], v[148:151], v[212:215]
    v_cvt_pk_bf16_f32 v18, v180, v181
    s_waitcnt lgkmcnt(3)
    v_mfma_f32_16x16x32_bf16 v[216:219], v[236:239], v[128:131], v[216:219]
    ds_read_b128 v[228:231], v11 offset:35840
    v_cvt_pk_bf16_f32 v19, v182, v183
    v_mfma_f32_16x16x32_bf16 v[216:219], v[240:243], v[136:139], v[216:219]
    s_nop 1
    v_permlane16_swap_b32 v16, v18
    v_permlane16_swap_b32 v17, v19
    buffer_store_dwordx4 v[16:19], v13, s[20:23], s46 offen sc1
    v_mfma_f32_16x16x32_bf16 v[216:219], v[244:247], v[144:147], v[216:219]
    ds_read_b128 v[232:235], v11 offset:45056
    v_mfma_f32_16x16x32_bf16 v[220:223], v[236:239], v[132:135], v[220:223]
    s_lshr_b32 s46, s45, 1
    s_lshl_b32 s46, s46, 13
    v_mfma_f32_16x16x32_bf16 v[220:223], v[240:243], v[140:143], v[220:223]
    ds_read_b128 v[236:239], v11 offset:48128
    s_and_b32 s47, s45, 1
    s_lshl_b32 s47, s47, 9
    v_mfma_f32_16x16x32_bf16 v[220:223], v[244:247], v[148:151], v[220:223]
    s_add_u32 s46, s46, s47
    s_add_u32 s46, s46, s44
    s_add_u32 s45, s45, 1
    s_waitcnt lgkmcnt(3)
    v_mfma_f32_16x16x32_bf16 v[208:211], v[248:251], v[152:155], v[208:211]
    s_waitcnt vmcnt(1)
    s_barrier
    ds_read_b128 v[240:243], v11 offset:49152
    v_max_f32 v192, 0, v192
    v_mfma_f32_16x16x32_bf16 v[208:211], v[252:255], v[160:163], v[208:211]
    v_max_f32 v193, 0, v193
    v_mfma_f32_16x16x32_bf16 v[208:211], v[224:227], v[168:171], v[208:211]
    ds_read_b128 v[244:247], v11 offset:52224
    s_add_u32 m0, s42, 0
    s_nop 0
    buffer_load_dwordx4 v9, s[20:23], s40 offen offset:0 sc1 lds
    v_max_f32 v194, 0, v194
    v_mfma_f32_16x16x32_bf16 v[212:215], v[248:251], v[156:159], v[212:215]
    v_max_f32 v195, 0, v195
    v_mfma_f32_16x16x32_bf16 v[212:215], v[252:255], v[164:167], v[212:215]
    ds_read_b128 v[248:251], v11 offset:61440
    v_mul_f32 v192, v192, v200
    v_mfma_f32_16x16x32_bf16 v[212:215], v[224:227], v[172:175], v[212:215]
    v_mul_f32 v193, v193, v201
    s_waitcnt lgkmcnt(3)
    v_mfma_f32_16x16x32_bf16 v[216:219], v[228:231], v[152:155], v[216:219]
    ds_read_b128 v[252:255], v11 offset:55296
    v_mul_f32 v194, v194, v202
    v_mfma_f32_16x16x32_bf16 v[216:219], v[232:235], v[160:163], v[216:219]
    v_mul_f32 v195, v195, v203
    v_mfma_f32_16x16x32_bf16 v[216:219], v[236:239], v[168:171], v[216:219]
    ds_read_b128 v[224:227], v11 offset:58368
    s_add_u32 m0, s42, 0
    s_nop 0
    buffer_load_dwordx4 v9, s[20:23], s40 offen offset:1024 sc1 lds
    v_cvt_pk_bf16_f32 v20, v192, v193
    v_mfma_f32_16x16x32_bf16 v[220:223], v[228:231], v[156:159], v[220:223]
    v_cvt_pk_bf16_f32 v21, v194, v195
    v_mfma_f32_16x16x32_bf16 v[220:223], v[232:235], v[164:167], v[220:223]
    ds_read_b128 v[228:231], v12 offset:6144
    v_max_f32 v196, 0, v196
    v_mfma_f32_16x16x32_bf16 v[220:223], v[236:239], v[172:175], v[220:223]
    v_max_f32 v197, 0, v197
    s_waitcnt lgkmcnt(3)
    v_mfma_f32_16x16x32_bf16 v[176:179], v[240:243], v[32:35], 0
    ds_read_b128 v[232:235], v11 offset:64512
    v_max_f32 v198, 0, v198
    v_mfma_f32_16x16x32_bf16 v[176:179], v[244:247], v[40:43], v[176:179]
    v_max_f32 v199, 0, v199
    v_mfma_f32_16x16x32_bf16 v[176:179], v[248:251], v[48:51], v[176:179]
    ds_read_b128 v[236:239], v12 offset:12288
    s_add_u32 m0, s42, 0
    s_nop 0
    buffer_load_dwordx4 v9, s[20:23], s40 offen offset:2048 sc1 lds
    v_mul_f32 v196, v196, v204
    v_mfma_f32_16x16x32_bf16 v[180:183], v[240:243], v[36:39], 0
    v_mul_f32 v197, v197, v205
    v_mfma_f32_16x16x32_bf16 v[180:183], v[244:247], v[44:47], v[180:183]
    ds_read_b128 v[240:243], v12 offset:15360
    v_mul_f32 v198, v198, v206
    v_mfma_f32_16x16x32_bf16 v[180:183], v[248:251], v[52:55], v[180:183]
    v_mul_f32 v199, v199, v207
    s_waitcnt lgkmcnt(3)
    v_mfma_f32_16x16x32_bf16 v[184:187], v[252:255], v[32:35], 0
    ds_read_b128 v[244:247], v12 offset:9216
    v_cvt_pk_bf16_f32 v22, v196, v197
    v_mfma_f32_16x16x32_bf16 v[184:187], v[224:227], v[40:43], v[184:187]
    v_cvt_pk_bf16_f32 v23, v198, v199
    v_mfma_f32_16x16x32_bf16 v[184:187], v[228:231], v[48:51], v[184:187]
    ds_read_b128 v[248:251], v12 offset:18432
    s_add_u32 m0, s42, 0
    s_nop 0
    buffer_load_dwordx4 v9, s[20:23], s40 offen offset:3072 sc1 lds
    s_nop 1
    v_permlane16_swap_b32 v20, v22
    v_permlane16_swap_b32 v21, v23
    buffer_store_dwordx4 v[20:23], v13, s[20:23], s46 offen sc1
    v_mfma_f32_16x16x32_bf16 v[188:191], v[252:255], v[36:39], 0
    s_lshr_b32 s46, s45, 1
    s_lshl_b32 s46, s46, 13
    v_mfma_f32_16x16x32_bf16 v[188:191], v[224:227], v[44:47], v[188:191]
    ds_read_b128 v[252:255], v12 offset:21504
    s_and_b32 s47, s45, 1
    s_lshl_b32 s47, s47, 9
    v_mfma_f32_16x16x32_bf16 v[188:191], v[228:231], v[52:55], v[188:191]
    s_add_u32 s46, s46, s47
    s_add_u32 s46, s46, s44
    s_add_u32 s45, s45, 22
    s_waitcnt lgkmcnt(3)
    v_mfma_f32_16x16x32_bf16 v[176:179], v[232:235], v[56:59], v[176:179]
    ds_read_b128 v[224:227], v11 offset:50176
    v_max_f32 v208, 0, v208
    v_mfma_f32_16x16x32_bf16 v[176:179], v[236:239], v[64:67], v[176:179]
    v_max_f32 v209, 0, v209
    v_mfma_f32_16x16x32_bf16 v[176:179], v[240:243], v[72:75], v[176:179]
    ds_read_b128 v[228:231], v11 offset:53248
    s_add_u32 m0, s42, 1024
    s_add_u32 s40, s40, 1024
    s_mov_b32 exec_hi, 0
    buffer_load_dwordx4 v9, s[20:23], s40 offen offset:3072 sc1 lds
    s_mov_b32 exec_hi, -1
    s_add_u32 s40, s40, 35840
    v_max_f32 v210, 0, v210
    v_mfma_f32_16x16x32_bf16 v[180:183], v[232:235], v[60:63], v[180:183]
    v_max_f32 v211, 0, v211
    v_mfma_f32_16x16x32_bf16 v[180:183], v[236:239], v[68:71], v[180:183]
    ds_read_b128 v[232:235], v11 offset:62464
    v_mul_f32 v208, v208, v216
    v_mfma_f32_16x16x32_bf16 v[180:183], v[240:243], v[76:79], v[180:183]
    v_mul_f32 v209, v209, v217
    s_waitcnt lgkmcnt(3)
    v_mfma_f32_16x16x32_bf16 v[184:187], v[244:247], v[56:59], v[184:187]
    ds_read_b128 v[236:239], v11 offset:56320
    v_mul_f32 v210, v210, v218
    v_mfma_f32_16x16x32_bf16 v[184:187], v[248:251], v[64:67], v[184:187]
    v_mul_f32 v211, v211, v219
    v_mfma_f32_16x16x32_bf16 v[184:187], v[252:255], v[72:75], v[184:187]
    ds_read_b128 v[240:243], v11 offset:59392
    s_add_u32 m0, s42, 36864
    s_nop 0
    buffer_load_dwordx4 v9, s[20:23], s40 offen offset:0 sc1 lds
    v_cvt_pk_bf16_f32 v16, v208, v209
    v_mfma_f32_16x16x32_bf16 v[188:191], v[244:247], v[60:63], v[188:191]
    v_cvt_pk_bf16_f32 v17, v210, v211
    v_mfma_f32_16x16x32_bf16 v[188:191], v[248:251], v[68:71], v[188:191]
    ds_read_b128 v[244:247], v12 offset:7168
    v_max_f32 v212, 0, v212
    v_mfma_f32_16x16x32_bf16 v[188:191], v[252:255], v[76:79], v[188:191]
    v_max_f32 v213, 0, v213
    s_waitcnt lgkmcnt(3)
    v_mfma_f32_16x16x32_bf16 v[192:195], v[224:227], v[32:35], 0
    ds_read_b128 v[248:251], v12 offset:4096
    v_max_f32 v214, 0, v214
    v_mfma_f32_16x16x32_bf16 v[192:195], v[228:231], v[40:43], v[192:195]
    v_max_f32 v215, 0, v215
    v_mfma_f32_16x16x32_bf16 v[192:195], v[232:235], v[48:51], v[192:195]
    ds_read_b128 v[252:255], v12 offset:13312
    s_add_u32 m0, s42, 36864
    s_nop 0
    buffer_load_dwordx4 v9, s[20:23], s40 offen offset:1024 sc1 lds
    v_mul_f32 v212, v212, v220
    v_mfma_f32_16x16x32_bf16 v[196:199], v[224:227], v[36:39], 0
    v_mul_f32 v213, v213, v221
    v_mfma_f32_16x16x32_bf16 v[196:199], v[228:231], v[44:47], v[196:199]
    ds_read_b128 v[224:227], v12 offset:16384
    v_mul_f32 v214, v214, v222
    v_mfma_f32_16x16x32_bf16 v[196:199], v[232:235], v[52:55], v[196:199]
    v_mul_f32 v215, v215, v223
    s_waitcnt lgkmcnt(3)
    v_mfma_f32_16x16x32_bf16 v[200:203], v[236:239], v[32:35], 0
    ds_read_b128 v[228:231], v12 offset:10240
    v_cvt_pk_bf16_f32 v18, v212, v213
    v_mfma_f32_16x16x32_bf16 v[200:203], v[240:243], v[40:43], v[200:203]
    v_cvt_pk_bf16_f32 v19, v214, v215
    v_mfma_f32_16x16x32_bf16 v[200:203], v[244:247], v[48:51], v[200:203]
    ds_read_b128 v[232:235], v12 offset:19456
    s_add_u32 m0, s42, 36864
    s_nop 0
    buffer_load_dwordx4 v9, s[20:23], s40 offen offset:2048 sc1 lds
    s_nop 1
    v_permlane16_swap_b32 v16, v18
    v_permlane16_swap_b32 v17, v19
    buffer_store_dwordx4 v[16:19], v13, s[20:23], s46 offen sc1
    v_mfma_f32_16x16x32_bf16 v[204:207], v[236:239], v[36:39], 0
    v_mfma_f32_16x16x32_bf16 v[204:207], v[240:243], v[44:47], v[204:207]
    ds_read_b128 v[236:239], v12 offset:22528
    v_mfma_f32_16x16x32_bf16 v[204:207], v[244:247], v[52:55], v[204:207]
    s_waitcnt lgkmcnt(3)
    v_mfma_f32_16x16x32_bf16 v[192:195], v[248:251], v[56:59], v[192:195]
    ds_read_b128 v[240:243], v11 offset:51200
    v_mfma_f32_16x16x32_bf16 v[192:195], v[252:255], v[64:67], v[192:195]
    v_mfma_f32_16x16x32_bf16 v[192:195], v[224:227], v[72:75], v[192:195]
    ds_read_b128 v[244:247], v11 offset:54272
    s_add_u32 m0, s42, 36864
    s_nop 0
    buffer_load_dwordx4 v9, s[20:23], s40 offen offset:3072 sc1 lds
    v_mfma_f32_16x16x32_bf16 v[196:199], v[248:251], v[60:63], v[196:199]
    v_mfma_f32_16x16x32_bf16 v[196:199], v[252:255], v[68:71], v[196:199]
    ds_read_b128 v[248:251], v11 offset:63488
    v_mfma_f32_16x16x32_bf16 v[196:199], v[224:227], v[76:79], v[196:199]
    s_waitcnt lgkmcnt(3)
    v_mfma_f32_16x16x32_bf16 v[200:203], v[228:231], v[56:59], v[200:203]
    ds_read_b128 v[252:255], v11 offset:57344
    v_mfma_f32_16x16x32_bf16 v[200:203], v[232:235], v[64:67], v[200:203]
    v_mfma_f32_16x16x32_bf16 v[200:203], v[236:239], v[72:75], v[200:203]
    ds_read_b128 v[224:227], v11 offset:60416
    s_add_u32 m0, s42, 37888
    s_add_u32 s40, s40, 1024
    s_mov_b32 exec_hi, 0
    buffer_load_dwordx4 v9, s[20:23], s40 offen offset:3072 sc1 lds
    s_mov_b32 exec_hi, -1
    s_add_u32 s40, s40, 35840
    v_mfma_f32_16x16x32_bf16 v[204:207], v[228:231], v[60:63], v[204:207]
    v_mfma_f32_16x16x32_bf16 v[204:207], v[232:235], v[68:71], v[204:207]
    ds_read_b128 v[228:231], v12 offset:8192
    v_mfma_f32_16x16x32_bf16 v[204:207], v[236:239], v[76:79], v[204:207]
    s_waitcnt lgkmcnt(3)
    v_mfma_f32_16x16x32_bf16 v[208:211], v[240:243], v[32:35], 0
    ds_read_b128 v[232:235], v12 offset:5120
    v_mfma_f32_16x16x32_bf16 v[208:211], v[244:247], v[40:43], v[208:211]
    v_mfma_f32_16x16x32_bf16 v[208:211], v[248:251], v[48:51], v[208:211]
    ds_read_b128 v[236:239], v12 offset:14336
    v_mfma_f32_16x16x32_bf16 v[212:215], v[240:243], v[36:39], 0
    v_mfma_f32_16x16x32_bf16 v[212:215], v[244:247], v[44:47], v[212:215]
    ds_read_b128 v[240:243], v12 offset:17408
    v_mfma_f32_16x16x32_bf16 v[212:215], v[248:251], v[52:55], v[212:215]
    s_waitcnt lgkmcnt(3)
    v_mfma_f32_16x16x32_bf16 v[216:219], v[252:255], v[32:35], 0
    ds_read_b128 v[244:247], v12 offset:11264
    v_mfma_f32_16x16x32_bf16 v[216:219], v[224:227], v[40:43], v[216:219]
    v_mfma_f32_16x16x32_bf16 v[216:219], v[228:231], v[48:51], v[216:219]
    ds_read_b128 v[248:251], v12 offset:20480
    v_mfma_f32_16x16x32_bf16 v[220:223], v[252:255], v[36:39], 0
    v_mfma_f32_16x16x32_bf16 v[220:223], v[224:227], v[44:47], v[220:223]
    ds_read_b128 v[252:255], v12 offset:23552
    v_mfma_f32_16x16x32_bf16 v[220:223], v[228:231], v[52:55], v[220:223]
    s_waitcnt lgkmcnt(3)
    v_mfma_f32_16x16x32_bf16 v[208:211], v[232:235], v[56:59], v[208:211]
    s_waitcnt vmcnt(6)
    s_waitcnt vmcnt(2)
    s_barrier
    s_cmp_eq_u32 s3, 5
    s_cbranch_scc0 SKIP_47
    s_getpc_b64 s[4:5]
PC_48:
    s_add_u32 s4, s4, PH_E-PC_48
    s_addc_u32 s5, s5, 0
    v_and_b32 v24, 63, v0
    v_min_u32 v24, 11, v24
    s_bfe_u32 s58, s2, 0x40003
    s_mul_i32 s58, s58, 1536
    v_lshl_add_u32 v24, v24, 7, s58
    v_min_u32 v24, PH_END-PH_E-4, v24
    v_mov_b32 v25, s5
    v_add_co_u32 v24, vcc, s4, v24
    s_nop 1
    v_addc_co_u32 v25, vcc, 0, v25, vcc
    global_load_dword v2, v[24:25], off
SKIP_47:
    s_cmp_eq_u32 s3, 0
    s_cbranch_scc0 SKIP_49
    v_mov_b32 v14, 1
    s_mov_b64 exec, 1
    buffer_atomic_add v14, off, s[20:23], s49
    s_mov_b64 exec, -1
SKIP_49:
    s_add_u32 s49, s49, 256
    ds_read_b128 v[224:227], v10 offset:0
    v_mfma_f32_16x16x32_bf16 v[208:211], v[236:239], v[64:67], v[208:211]
    v_mfma_f32_16x16x32_bf16 v[208:211], v[240:243], v[72:75], v[208:211]
    ds_read_b128 v[228:231], v10 offset:3072
    s_add_u32 m0, s42, 73728
    s_nop 0
    buffer_load_dwordx4 v9, s[20:23], s40 offen offset:0 sc1 lds
    v_mfma_f32_16x16x32_bf16 v[212:215], v[232:235], v[60:63], v[212:215]
    v_mfma_f32_16x16x32_bf16 v[212:215], v[236:239], v[68:71], v[212:215]
    ds_read_b128 v[232:235], v10 offset:12288
    v_mfma_f32_16x16x32_bf16 v[212:215], v[240:243], v[76:79], v[212:215]
    s_waitcnt lgkmcnt(3)
    v_mfma_f32_16x16x32_bf16 v[216:219], v[244:247], v[56:59], v[216:219]
    ds_read_b128 v[236:239], v10 offset:6144
    v_mfma_f32_16x16x32_bf16 v[216:219], v[248:251], v[64:67], v[216:219]
    v_mfma_f32_16x16x32_bf16 v[216:219], v[252:255], v[72:75], v[216:219]
    ds_read_b128 v[240:243], v10 offset:9216
    s_add_u32 m0, s42, 73728
    s_nop 0
    buffer_load_dwordx4 v9, s[20:23], s40 offen offset:1024 sc1 lds
    v_mfma_f32_16x16x32_bf16 v[220:223], v[244:247], v[60:63], v[220:223]
    v_mfma_f32_16x16x32_bf16 v[220:223], v[248:251], v[68:71], v[220:223]
    ds_read_b128 v[244:247], v10 offset:18432
    v_mfma_f32_16x16x32_bf16 v[220:223], v[252:255], v[76:79], v[220:223]
    s_waitcnt lgkmcnt(3)
    v_mfma_f32_16x16x32_bf16 v[176:179], v[224:227], v[80:83], v[176:179]
    ds_read_b128 v[248:251], v10 offset:15360
    v_mfma_f32_16x16x32_bf16 v[176:179], v[228:231], v[88:91], v[176:179]
    v_mfma_f32_16x16x32_bf16 v[176:179], v[232:235], v[96:99], v[176:179]
    ds_read_b128 v[252:255], v10 offset:24576
    s_add_u32 m0, s42, 73728
    s_nop 0
    buffer_load_dwordx4 v9, s[20:23], s40 offen offset:2048 sc1 lds
    v_mfma_f32_16x16x32_bf16 v[180:183], v[224:227], v[84:87], v[180:183]
    v_mfma_f32_16x16x32_bf16 v[180:183], v[228:231], v[92:95], v[180:183]
    ds_read_b128 v[224:227], v10 offset:27648
    v_mfma_f32_16x16x32_bf16 v[180:183], v[232:235], v[100:103], v[180:183]
    s_waitcnt lgkmcnt(3)
    v_mfma_f32_16x16x32_bf16 v[184:187], v[236:239], v[80:83], v[184:187]
    ds_read_b128 v[228:231], v10 offset:21504
    v_mfma_f32_16x16x32_bf16 v[184:187], v[240:243], v[88:91], v[184:187]
    v_mfma_f32_16x16x32_bf16 v[184:187], v[244:247], v[96:99], v[184:187]
    ds_read_b128 v[232:235], v10 offset:30720
    s_add_u32 m0, s42, 73728
    s_nop 0
    buffer_load_dwordx4 v9, s[20:23], s40 offen offset:3072 sc1 lds
    v_mfma_f32_16x16x32_bf16 v[188:191], v[236:239], v[84:87], v[188:191]
    v_mfma_f32_16x16x32_bf16 v[188:191], v[240:243], v[92:95], v[188:191]
    ds_read_b128 v[236:239], v10 offset:33792
    v_mfma_f32_16x16x32_bf16 v[188:191], v[244:247], v[100:103], v[188:191]
    s_waitcnt lgkmcnt(3)
    v_mfma_f32_16x16x32_bf16 v[176:179], v[248:251], v[104:107], v[176:179]
    ds_read_b128 v[240:243], v10 offset:1024
    v_mfma_f32_16x16x32_bf16 v[176:179], v[252:255], v[112:115], v[176:179]
    v_mfma_f32_16x16x32_bf16 v[176:179], v[224:227], v[120:123], v[176:179]
    ds_read_b128 v[244:247], v10 offset:4096
    s_add_u32 m0, s42, 74752
    s_add_u32 s40, s40, 1024
    s_mov_b32 exec_hi, 0
    buffer_load_dwordx4 v9, s[20:23], s40 offen offset:3072 sc1 lds
    s_mov_b32 exec_hi, -1
    s_add_u32 s40, s40, 35840
    v_mfma_f32_16x16x32_bf16 v[180:183], v[248:251], v[108:111], v[180:183]
    v_mfma_f32_16x16x32_bf16 v[180:183], v[252:255], v[116:119], v[180:183]
    ds_read_b128 v[248:251], v10 offset:13312
    v_mfma_f32_16x16x32_bf16 v[180:183], v[224:227], v[124:127], v[180:183]
    s_waitcnt lgkmcnt(3)
    v_mfma_f32_16x16x32_bf16 v[184:187], v[228:231], v[104:107], v[184:187]
    ds_read_b128 v[252:255], v10 offset:7168
    v_mfma_f32_16x16x32_bf16 v[184:187], v[232:235], v[112:115], v[184:187]
    v_mfma_f32_16x16x32_bf16 v[184:187], v[236:239], v[120:123], v[184:187]
    ds_read_b128 v[224:227], v10 offset:10240
    v_mfma_f32_16x16x32_bf16 v[188:191], v[228:231], v[108:111], v[188:191]
    v_mfma_f32_16x16x32_bf16 v[188:191], v[232:235], v[116:119], v[188:191]
    ds_read_b128 v[228:231], v10 offset:19456
    v_mfma_f32_16x16x32_bf16 v[188:191], v[236:239], v[124:127], v[188:191]
    s_waitcnt lgkmcnt(3)
    v_mfma_f32_16x16x32_bf16 v[192:195], v[240:243], v[80:83], v[192:195]
    ds_read_b128 v[232:235], v10 offset:16384
    v_mfma_f32_16x16x32_bf16 v[192:195], v[244:247], v[88:91], v[192:195]
    v_mfma_f32_16x16x32_bf16 v[192:195], v[248:251], v[96:99], v[192:195]
    ds_read_b128 v[236:239], v10 offset:25600
    v_mfma_f32_16x16x32_bf16 v[196:199], v[240:243], v[84:87], v[196:199]
    v_mfma_f32_16x16x32_bf16 v[196:199], v[244:247], v[92:95], v[196:199]
    ds_read_b128 v[240:243], v10 offset:28672
    v_mfma_f32_16x16x32_bf16 v[196:199], v[248:251], v[100:103], v[196:199]
    s_waitcnt lgkmcnt(3)
    v_mfma_f32_16x16x32_bf16 v[200:203], v[252:255], v[80:83], v[200:203]
    ds_read_b128 v[244:247], v10 offset:22528
    v_mfma_f32_16x16x32_bf16 v[200:203], v[224:227], v[88:91], v[200:203]
    v_mfma_f32_16x16x32_bf16 v[200:203], v[228:231], v[96:99], v[200:203]
    ds_read_b128 v[248:251], v10 offset:31744
    v_mfma_f32_16x16x32_bf16 v[204:207], v[252:255], v[84:87], v[204:207]
    v_mfma_f32_16x16x32_bf16 v[204:207], v[224:227], v[92:95], v[204:207]
    ds_read_b128 v[252:255], v10 offset:34816
    v_mfma_f32_16x16x32_bf16 v[204:207], v[228:231], v[100:103], v[204:207]
    s_waitcnt lgkmcnt(3)
    v_mfma_f32_16x16x32_bf16 v[192:195], v[232:235], v[104:107], v[192:195]
    ds_read_b128 v[224:227], v10 offset:2048
    v_mfma_f32_16x16x32_bf16 v[192:195], v[236:239], v[112:115], v[192:195]
    v_mfma_f32_16x16x32_bf16 v[192:195], v[240:243], v[120:123], v[192:195]
    ds_read_b128 v[228:231], v10 offset:5120
    v_mfma_f32_16x16x32_bf16 v[196:199], v[232:235], v[108:111], v[196:199]
    v_mfma_f32_16x16x32_bf16 v[196:199], v[236:239], v[116:119], v[196:199]
    ds_read_b128 v[232:235], v10 offset:14336
    v_mfma_f32_16x16x32_bf16 v[196:199], v[240:243], v[124:127], v[196:199]
    s_waitcnt lgkmcnt(3)
    v_mfma_f32_16x16x32_bf16 v[200:203], v[244:247], v[104:107], v[200:203]
    ds_read_b128 v[236:239], v10 offset:8192
    v_mfma_f32_16x16x32_bf16 v[200:203], v[248:251], v[112:115], v[200:203]
    v_mfma_f32_16x16x32_bf16 v[200:203], v[252:255], v[120:123], v[200:203]
    ds_read_b128 v[240:243], v10 offset:11264
    v_mfma_f32_16x16x32_bf16 v[204:207], v[244:247], v[108:111], v[204:207]
    v_mfma_f32_16x16x32_bf16 v[204:207], v[248:251], v[116:119], v[204:207]
    ds_read_b128 v[244:247], v10 offset:20480
    v_mfma_f32_16x16x32_bf16 v[204:207], v[252:255], v[124:127], v[204:207]
    s_waitcnt lgkmcnt(3)
    v_mfma_f32_16x16x32_bf16 v[208:211], v[224:227], v[80:83], v[208:211]
    ds_read_b128 v[248:251], v10 offset:17408
    v_mfma_f32_16x16x32_bf16 v[208:211], v[228:231], v[88:91], v[208:211]
    v_mfma_f32_16x16x32_bf16 v[208:211], v[232:235], v[96:99], v[208:211]
    ds_read_b128 v[252:255], v10 offset:26624
    v_mfma_f32_16x16x32_bf16 v[212:215], v[224:227], v[84:87], v[212:215]
    v_mfma_f32_16x16x32_bf16 v[212:215], v[228:231], v[92:95], v[212:215]
    ds_read_b128 v[224:227], v10 offset:29696
    v_mfma_f32_16x16x32_bf16 v[212:215], v[232:235], v[100:103], v[212:215]
    s_waitcnt lgkmcnt(3)
    v_mfma_f32_16x16x32_bf16 v[216:219], v[236:239], v[80:83], v[216:219]
    ds_read_b128 v[228:231], v10 offset:23552
    v_mfma_f32_16x16x32_bf16 v[216:219], v[240:243], v[88:91], v[216:219]
    v_mfma_f32_16x16x32_bf16 v[216:219], v[244:247], v[96:99], v[216:219]
    ds_read_b128 v[232:235], v10 offset:32768
    v_mfma_f32_16x16x32_bf16 v[220:223], v[236:239], v[84:87], v[220:223]
    v_mfma_f32_16x16x32_bf16 v[220:223], v[240:243], v[92:95], v[220:223]
    ds_read_b128 v[236:239], v10 offset:35840
    v_mfma_f32_16x16x32_bf16 v[220:223], v[244:247], v[100:103], v[220:223]
    s_waitcnt lgkmcnt(3)
    v_mfma_f32_16x16x32_bf16 v[208:211], v[248:251], v[104:107], v[208:211]
    s_waitcnt vmcnt(5)
    s_barrier
    v_mov_b32 v26, s64
    v_mov_b32 v27, 8
    s_mov_b32 s59, 0
    v_writelane_b32 v26, s59, 1
    s_mov_b32 s59, 160
    v_writelane_b32 v27, s59, 1
    buffer_load_dword v28, v26, s[20:23], 0 offen sc1
    ds_read_b128 v[240:243], v10 offset:36864
    v_mfma_f32_16x16x32_bf16 v[208:211], v[252:255], v[112:115], v[208:211]
    v_mfma_f32_16x16x32_bf16 v[208:211], v[224:227], v[120:123], v[208:211]
    ds_read_b128 v[244:247], v10 offset:39936
    s_add_u32 m0, s42, 110592
    s_nop 0
    buffer_load_dwordx4 v9, s[20:23], s40 offen offset:0 sc1 lds
    v_mfma_f32_16x16x32_bf16 v[212:215], v[248:251], v[108:111], v[212:215]
    v_mfma_f32_16x16x32_bf16 v[212:215], v[252:255], v[116:119], v[212:215]
    ds_read_b128 v[248:251], v10 offset:49152
    v_mfma_f32_16x16x32_bf16 v[212:215], v[224:227], v[124:127], v[212:215]
    s_waitcnt lgkmcnt(3)
    v_mfma_f32_16x16x32_bf16 v[216:219], v[228:231], v[104:107], v[216:219]
    ds_read_b128 v[252:255], v10 offset:43008
    v_mfma_f32_16x16x32_bf16 v[216:219], v[232:235], v[112:115], v[216:219]
    v_mfma_f32_16x16x32_bf16 v[216:219], v[236:239], v[120:123], v[216:219]
    ds_read_b128 v[224:227], v10 offset:46080
    s_add_u32 m0, s42, 110592
    s_nop 0
    buffer_load_dwordx4 v9, s[20:23], s40 offen offset:1024 sc1 lds
    v_mfma_f32_16x16x32_bf16 v[220:223], v[228:231], v[108:111], v[220:223]
    v_mfma_f32_16x16x32_bf16 v[220:223], v[232:235], v[116:119], v[220:223]
    ds_read_b128 v[228:231], v10 offset:55296
    v_mfma_f32_16x16x32_bf16 v[220:223], v[236:239], v[124:127], v[220:223]
    s_waitcnt lgkmcnt(3)
    v_mfma_f32_16x16x32_bf16 v[176:179], v[240:243], v[128:131], v[176:179]
    ds_read_b128 v[232:235], v10 offset:52224
    v_mfma_f32_16x16x32_bf16 v[176:179], v[244:247], v[136:139], v[176:179]
    v_mfma_f32_16x16x32_bf16 v[176:179], v[248:251], v[144:147], v[176:179]
    ds_read_b128 v[236:239], v10 offset:61440
    s_add_u32 m0, s42, 110592
    s_nop 0
    buffer_load_dwordx4 v9, s[20:23], s40 offen offset:2048 sc1 lds
    v_mfma_f32_16x16x32_bf16 v[180:183], v[240:243], v[132:135], v[180:183]
    v_mfma_f32_16x16x32_bf16 v[180:183], v[244:247], v[140:143], v[180:183]
    ds_read_b128 v[240:243], v10 offset:64512
    v_mfma_f32_16x16x32_bf16 v[180:183], v[248:251], v[148:151], v[180:183]
    s_waitcnt lgkmcnt(3)
    v_mfma_f32_16x16x32_bf16 v[184:187], v[252:255], v[128:131], v[184:187]
    ds_read_b128 v[244:247], v10 offset:58368
    v_mfma_f32_16x16x32_bf16 v[184:187], v[224:227], v[136:139], v[184:187]
    v_mfma_f32_16x16x32_bf16 v[184:187], v[228:231], v[144:147], v[184:187]
    ds_read_b128 v[248:251], v11 offset:6144
    s_add_u32 m0, s42, 110592
    s_nop 0
    buffer_load_dwordx4 v9, s[20:23], s40 offen offset:3072 sc1 lds
    v_mfma_f32_16x16x32_bf16 v[188:191], v[252:255], v[132:135], v[188:191]
    v_mfma_f32_16x16x32_bf16 v[188:191], v[224:227], v[140:143], v[188:191]
    ds_read_b128 v[252:255], v11 offset:9216
    v_mfma_f32_16x16x32_bf16 v[188:191], v[228:231], v[148:151], v[188:191]
    s_waitcnt lgkmcnt(3)
    v_mfma_f32_16x16x32_bf16 v[176:179], v[232:235], v[152:155], v[176:179]
    ds_read_b128 v[224:227], v10 offset:37888
    v_mfma_f32_16x16x32_bf16 v[176:179], v[236:239], v[160:163], v[176:179]
    v_mfma_f32_16x16x32_bf16 v[176:179], v[240:243], v[168:171], v[176:179]
    ds_read_b128 v[228:231], v10 offset:40960
    s_add_u32 m0, s42, 111616
    s_add_u32 s40, s40, 1024
    s_mov_b32 exec_hi, 0
    buffer_load_dwordx4 v9, s[20:23], s40 offen offset:3072 sc1 lds
    s_mov_b32 exec_hi, -1
    s_add_u32 s40, s40, 35840
    v_mfma_f32_16x16x32_bf16 v[180:183], v[232:235], v[156:159], v[180:183]
    v_mfma_f32_16x16x32_bf16 v[180:183], v[236:239], v[164:167], v[180:183]
    ds_read_b128 v[232:235], v10 offset:50176
    v_mfma_f32_16x16x32_bf16 v[180:183], v[240:243], v[172:175], v[180:183]
    s_waitcnt lgkmcnt(3)
    v_mfma_f32_16x16x32_bf16 v[184:187], v[244:247], v[152:155], v[184:187]
    ds_read_b128 v[236:239], v10 offset:44032
    v_mfma_f32_16x16x32_bf16 v[184:187], v[248:251], v[160:163], v[184:187]
    v_mfma_f32_16x16x32_bf16 v[184:187], v[252:255], v[168:171], v[184:187]
    ds_read_b128 v[240:243], v10 offset:47104
    v_mfma_f32_16x16x32_bf16 v[188:191], v[244:247], v[156:159], v[188:191]
    v_mfma_f32_16x16x32_bf16 v[188:191], v[248:251], v[164:167], v[188:191]
    ds_read_b128 v[244:247], v10 offset:56320
    v_mfma_f32_16x16x32_bf16 v[188:191], v[252:255], v[172:175], v[188:191]
    s_waitcnt lgkmcnt(3)
    v_mfma_f32_16x16x32_bf16 v[192:195], v[224:227], v[128:131], v[192:195]
    ds_read_b128 v[248:251], v10 offset:53248
    v_mfma_f32_16x16x32_bf16 v[192:195], v[228:231], v[136:139], v[192:195]
    v_mfma_f32_16x16x32_bf16 v[192:195], v[232:235], v[144:147], v[192:195]
    ds_read_b128 v[252:255], v10 offset:62464
    v_mfma_f32_16x16x32_bf16 v[196:199], v[224:227], v[132:135], v[196:199]
    v_mfma_f32_16x16x32_bf16 v[196:199], v[228:231], v[140:143], v[196:199]
    ds_read_b128 v[224:227], v11 offset:4096
    v_mfma_f32_16x16x32_bf16 v[196:199], v[232:235], v[148:151], v[196:199]
    s_waitcnt lgkmcnt(3)
    v_mfma_f32_16x16x32_bf16 v[200:203], v[236:239], v[128:131], v[200:203]
    ds_read_b128 v[228:231], v10 offset:59392
    v_mfma_f32_16x16x32_bf16 v[200:203], v[240:243], v[136:139], v[200:203]
    v_mfma_f32_16x16x32_bf16 v[200:203], v[244:247], v[144:147], v[200:203]
    ds_read_b128 v[232:235], v11 offset:7168
    s_lshr_b32 s46, s45, 1
    s_lshl_b32 s46, s46, 13
    v_mfma_f32_16x16x32_bf16 v[204:207], v[236:239], v[132:135], v[204:207]
    s_and_b32 s47, s45, 1
    s_lshl_b32 s47, s47, 9
    v_mfma_f32_16x16x32_bf16 v[204:207], v[240:243], v[140:143], v[204:207]
    ds_read_b128 v[236:239], v11 offset:10240
    s_add_u32 s46, s46, s47
    s_add_u32 s46, s46, s44
    s_add_u32 s45, s45, 1
    v_mfma_f32_16x16x32_bf16 v[204:207], v[244:247], v[148:151], v[204:207]
    v_max_f32 v176, 0, v176
    s_waitcnt lgkmcnt(3)
    v_mfma_f32_16x16x32_bf16 v[192:195], v[248:251], v[152:155], v[192:195]
    ds_read_b128 v[240:243], v10 offset:38912
    v_max_f32 v177, 0, v177
    v_mfma_f32_16x16x32_bf16 v[192:195], v[252:255], v[160:163], v[192:195]
    v_max_f32 v178, 0, v178
    v_mfma_f32_16x16x32_bf16 v[192:195], v[224:227], v[168:171], v[192:195]
    ds_read_b128 v[244:247], v10 offset:41984
    v_max_f32 v179, 0, v179
    v_mfma_f32_16x16x32_bf16 v[196:199], v[248:251], v[156:159], v[196:199]
    v_mul_f32 v176, v176, v184
    v_mfma_f32_16x16x32_bf16 v[196:199], v[252:255], v[164:167], v[196:199]
    ds_read_b128 v[248:251], v10 offset:51200
    v_mul_f32 v177, v177, v185
    v_mfma_f32_16x16x32_bf16 v[196:199], v[224:227], v[172:175], v[196:199]
    v_mul_f32 v178, v178, v186
    s_waitcnt lgkmcnt(3)
    v_mfma_f32_16x16x32_bf16 v[200:203], v[228:231], v[152:155], v[200:203]
    ds_read_b128 v[252:255], v10 offset:45056
    v_mul_f32 v179, v179, v187
    v_mfma_f32_16x16x32_bf16 v[200:203], v[232:235], v[160:163], v[200:203]
    v_cvt_pk_bf16_f32 v16, v176, v177
    v_mfma_f32_16x16x32_bf16 v[200:203], v[236:239], v[168:171], v[200:203]
    ds_read_b128 v[224:227], v10 offset:48128
    v_cvt_pk_bf16_f32 v17, v178, v179
    v_mfma_f32_16x16x32_bf16 v[204:207], v[228:231], v[156:159], v[204:207]
    v_max_f32 v180, 0, v180
    v_mfma_f32_16x16x32_bf16 v[204:207], v[232:235], v[164:167], v[204:207]
    ds_read_b128 v[228:231], v10 offset:57344
    v_max_f32 v181, 0, v181
    v_mfma_f32_16x16x32_bf16 v[204:207], v[236:239], v[172:175], v[204:207]
    v_max_f32 v182, 0, v182
    s_waitcnt lgkmcnt(3)
    v_mfma_f32_16x16x32_bf16 v[208:211], v[240:243], v[128:131], v[208:211]
    ds_read_b128 v[232:235], v10 offset:54272
    v_max_f32 v183, 0, v183
    v_mfma_f32_16x16x32_bf16 v[208:211], v[244:247], v[136:139], v[208:211]
    v_mul_f32 v180, v180, v188
    v_mfma_f32_16x16x32_bf16 v[208:211], v[248:251], v[144:147], v[208:211]
    ds_read_b128 v[236:239], v10 offset:63488
    v_mul_f32 v181, v181, v189
    v_mfma_f32_16x16x32_bf16 v[212:215], v[240:243], v[132:135], v[212:215]
    v_mul_f32 v182, v182, v190
    v_mfma_f32_16x16x32_bf16 v[212:215], v[244:247], v[140:143], v[212:215]
    ds_read_b128 v[240:243], v11 offset:5120
    v_mul_f32 v183, v183, v191
    v_mfma_f32_16x16x32_bf16 v[212:215], v[248:251], v[148:151], v[212:215]
    v_cvt_pk_bf16_f32 v18, v180, v181
    s_waitcnt lgkmcnt(3)
    v_mfma_f32_16x16x32_bf16 v[216:219], v[252:255], v[128:131], v[216:219]
    ds_read_b128 v[244:247], v10 offset:60416
    v_cvt_pk_bf16_f32 v19, v182, v183
    v_mfma_f32_16x16x32_bf16 v[216:219], v[224:227], v[136:139], v[216:219]
    s_nop 1
    v_permlane16_swap_b32 v16, v18
    v_permlane16_swap_b32 v17, v19
    buffer_store_dwordx4 v[16:19], v13, s[20:23], s46 offen sc1
    v_mfma_f32_16x16x32_bf16 v[216:219], v[228:231], v[144:147], v[216:219]
    ds_read_b128 v[248:251], v11 offset:8192
    v_mfma_f32_16x16x32_bf16 v[220:223], v[252:255], v[132:135], v[220:223]
    s_lshr_b32 s46, s45, 1
    s_lshl_b32 s46, s46, 13
    v_mfma_f32_16x16x32_bf16 v[220:223], v[224:227], v[140:143], v[220:223]
    ds_read_b128 v[252:255], v11 offset:11264
    s_and_b32 s47, s45, 1
    s_lshl_b32 s47, s47, 9
    v_mfma_f32_16x16x32_bf16 v[220:223], v[228:231], v[148:151], v[220:223]
    s_add_u32 s46, s46, s47
    s_add_u32 s46, s46, s44
    s_add_u32 s45, s45, 1
    s_waitcnt lgkmcnt(3)
    v_mfma_f32_16x16x32_bf16 v[208:211], v[232:235], v[152:155], v[208:211]
    s_waitcnt vmcnt(7)
    s_waitcnt vmcnt(6)
    s_cmp_eq_u32 s3, 4
    s_cbranch_scc0 SKIP_50
    s_mov_b32 s59, 0
    s_branch POLLC_53
POLL_51:
    buffer_load_dword v28, v26, s[20:23], 0 offen sc1
    s_waitcnt vmcnt(0)
POLLC_53:
    v_cmp_lt_u32 vcc, v28, v27
    s_add_u32 s59, s59, 1
    s_cbranch_vccz POLLD_52
    s_sleep 1
    s_cmp_lt_u32 s59, 2000000
    s_cbranch_scc1 POLL_51
POLLD_52:
SKIP_50:
    s_barrier
    ds_read_b128 v[224:227], v11 offset:12288
    v_max_f32 v192, 0, v192
    v_mfma_f32_16x16x32_bf16 v[208:211], v[236:239], v[160:163], v[208:211]
    v_max_f32 v193, 0, v193
    v_mfma_f32_16x16x32_bf16 v[208:211], v[240:243], v[168:171], v[208:211]
    ds_read_b128 v[228:231], v11 offset:15360
    s_add_u32 m0, s42, 0
    s_nop 0
    buffer_load_dwordx4 v9, s[20:23], s40 offen offset:0 sc1 lds
    v_max_f32 v194, 0, v194
    v_mfma_f32_16x16x32_bf16 v[212:215], v[232:235], v[156:159], v[212:215]
    v_max_f32 v195, 0, v195
    v_mfma_f32_16x16x32_bf16 v[212:215], v[236:239], v[164:167], v[212:215]
    ds_read_b128 v[232:235], v11 offset:24576
    v_mul_f32 v192, v192, v200
    v_mfma_f32_16x16x32_bf16 v[212:215], v[240:243], v[172:175], v[212:215]
    v_mul_f32 v193, v193, v201
    s_waitcnt lgkmcnt(3)
    v_mfma_f32_16x16x32_bf16 v[216:219], v[244:247], v[152:155], v[216:219]
    ds_read_b128 v[236:239], v11 offset:18432
    v_mul_f32 v194, v194, v202
    v_mfma_f32_16x16x32_bf16 v[216:219], v[248:251], v[160:163], v[216:219]
    v_mul_f32 v195, v195, v203
    v_mfma_f32_16x16x32_bf16 v[216:219], v[252:255], v[168:171], v[216:219]
    ds_read_b128 v[240:243], v11 offset:21504
    s_add_u32 m0, s42, 0
    s_nop 0
    buffer_load_dwordx4 v9, s[20:23], s40 offen offset:1024 sc1 lds
    v_cvt_pk_bf16_f32 v20, v192, v193
    v_mfma_f32_16x16x32_bf16 v[220:223], v[244:247], v[156:159], v[220:223]
    v_cvt_pk_bf16_f32 v21, v194, v195
    v_mfma_f32_16x16x32_bf16 v[220:223], v[248:251], v[164:167], v[220:223]
    ds_read_b128 v[244:247], v11 offset:30720
    v_max_f32 v196, 0, v196
    v_mfma_f32_16x16x32_bf16 v[220:223], v[252:255], v[172:175], v[220:223]
    v_max_f32 v197, 0, v197
    s_waitcnt lgkmcnt(3)
    v_mfma_f32_16x16x32_bf16 v[176:179], v[224:227], v[32:35], 0
    ds_read_b128 v[248:251], v11 offset:27648
    v_max_f32 v198, 0, v198
    v_mfma_f32_16x16x32_bf16 v[176:179], v[228:231], v[40:43], v[176:179]
    v_max_f32 v199, 0, v199
    v_mfma_f32_16x16x32_bf16 v[176:179], v[232:235], v[48:51], v[176:179]
    ds_read_b128 v[252:255], v11 offset:36864
    s_add_u32 m0, s42, 0
    s_nop 0
    buffer_load_dwordx4 v9, s[20:23], s40 offen offset:2048 sc1 lds
    v_mul_f32 v196, v196, v204
    v_mfma_f32_16x16x32_bf16 v[180:183], v[224:227], v[36:39], 0
    v_mul_f32 v197, v197, v205
    v_mfma_f32_16x16x32_bf16 v[180:183], v[228:231], v[44:47], v[180:183]
    ds_read_b128 v[224:227], v11 offset:39936
    v_mul_f32 v198, v198, v206
    v_mfma_f32_16x16x32_bf16 v[180:183], v[232:235], v[52:55], v[180:183]
    v_mul_f32 v199, v199, v207
    s_waitcnt lgkmcnt(3)
    v_mfma_f32_16x16x32_bf16 v[184:187], v[236:239], v[32:35], 0
    ds_read_b128 v[228:231], v11 offset:33792
    v_cvt_pk_bf16_f32 v22, v196, v197
    v_mfma_f32_16x16x32_bf16 v[184:187], v[240:243], v[40:43], v[184:187]
    v_cvt_pk_bf16_f32 v23, v198, v199
    v_mfma_f32_16x16x32_bf16 v[184:187], v[244:247], v[48:51], v[184:187]
    ds_read_b128 v[232:235], v11 offset:43008
    s_add_u32 m0, s42, 0
    s_nop 0
    buffer_load_dwordx4 v9, s[20:23], s40 offen offset:3072 sc1 lds
    s_nop 1
    v_permlane16_swap_b32 v20, v22
    v_permlane16_swap_b32 v21, v23
    buffer_store_dwordx4 v[20:23], v13, s[20:23], s46 offen sc1
    v_mfma_f32_16x16x32_bf16 v[188:191], v[236:239], v[36:39], 0
    s_lshr_b32 s46, s45, 1
    s_lshl_b32 s46, s46, 13
    v_mfma_f32_16x16x32_bf16 v[188:191], v[240:243], v[44:47], v[188:191]
    ds_read_b128 v[236:239], v11 offset:46080
    s_and_b32 s47, s45, 1
    s_lshl_b32 s47, s47, 9
    v_mfma_f32_16x16x32_bf16 v[188:191], v[244:247], v[52:55], v[188:191]
    s_add_u32 s46, s46, s47
    s_add_u32 s46, s46, s44
    s_add_u32 s45, s45, 22
    s_waitcnt lgkmcnt(3)
    v_mfma_f32_16x16x32_bf16 v[176:179], v[248:251], v[56:59], v[176:179]
    ds_read_b128 v[240:243], v11 offset:13312
    v_max_f32 v208, 0, v208
    v_mfma_f32_16x16x32_bf16 v[176:179], v[252:255], v[64:67], v[176:179]
    v_max_f32 v209, 0, v209
    v_mfma_f32_16x16x32_bf16 v[176:179], v[224:227], v[72:75], v[176:179]
    ds_read_b128 v[244:247], v11 offset:16384
    s_add_u32 m0, s42, 1024
    s_add_u32 s40, s40, 1024
    s_mov_b32 exec_hi, 0
    buffer_load_dwordx4 v9, s[20:23], s40 offen offset:3072 sc1 lds
    s_mov_b32 exec_hi, -1
    s_add_u32 s40, s40, 35840
    v_max_f32 v210, 0, v210
    v_mfma_f32_16x16x32_bf16 v[180:183], v[248:251], v[60:63], v[180:183]
    v_max_f32 v211, 0, v211
    v_mfma_f32_16x16x32_bf16 v[180:183], v[252:255], v[68:71], v[180:183]
    ds_read_b128 v[248:251], v11 offset:25600
    v_mul_f32 v208, v208, v216
    v_mfma_f32_16x16x32_bf16 v[180:183], v[224:227], v[76:79], v[180:183]
    v_mul_f32 v209, v209, v217
    s_waitcnt lgkmcnt(3)
    v_mfma_f32_16x16x32_bf16 v[184:187], v[228:231], v[56:59], v[184:187]
    ds_read_b128 v[252:255], v11 offset:19456
    v_mul_f32 v210, v210, v218
    v_mfma_f32_16x16x32_bf16 v[184:187], v[232:235], v[64:67], v[184:187]
    v_mul_f32 v211, v211, v219
    v_mfma_f32_16x16x32_bf16 v[184:187], v[236:239], v[72:75], v[184:187]
    ds_read_b128 v[224:227], v11 offset:22528
    v_cvt_pk_bf16_f32 v16, v208, v209
    v_mfma_f32_16x16x32_bf16 v[188:191], v[228:231], v[60:63], v[188:191]
    v_cvt_pk_bf16_f32 v17, v210, v211
    v_mfma_f32_16x16x32_bf16 v[188:191], v[232:235], v[68:71], v[188:191]
    ds_read_b128 v[228:231], v11 offset:31744
    v_max_f32 v212, 0, v212
    v_mfma_f32_16x16x32_bf16 v[188:191], v[236:239], v[76:79], v[188:191]
    v_max_f32 v213, 0, v213
    s_waitcnt lgkmcnt(3)
    v_mfma_f32_16x16x32_bf16 v[192:195], v[240:243], v[32:35], 0
    ds_read_b128 v[232:235], v11 offset:28672
    v_max_f32 v214, 0, v214
    v_mfma_f32_16x16x32_bf16 v[192:195], v[244:247], v[40:43], v[192:195]
    v_max_f32 v215, 0, v215
    v_mfma_f32_16x16x32_bf16 v[192:195], v[248:251], v[48:51], v[192:195]
    ds_read_b128 v[236:239], v11 offset:37888
    v_mul_f32 v212, v212, v220
    v_mfma_f32_16x16x32_bf16 v[196:199], v[240:243], v[36:39], 0
    v_mul_f32 v213, v213, v221
    v_mfma_f32_16x16x32_bf16 v[196:199], v[244:247], v[44:47], v[196:199]
    ds_read_b128 v[240:243], v11 offset:40960
    v_mul_f32 v214, v214, v222
    v_mfma_f32_16x16x32_bf16 v[196:199], v[248:251], v[52:55], v[196:199]
    v_mul_f32 v215, v215, v223
    s_waitcnt lgkmcnt(3)
    v_mfma_f32_16x16x32_bf16 v[200:203], v[252:255], v[32:35], 0
    ds_read_b128 v[244:247], v11 offset:34816
    v_cvt_pk_bf16_f32 v18, v212, v213
    v_mfma_f32_16x16x32_bf16 v[200:203], v[224:227], v[40:43], v[200:203]
    v_cvt_pk_bf16_f32 v19, v214, v215
    v_mfma_f32_16x16x32_bf16 v[200:203], v[228:231], v[48:51], v[200:203]
    ds_read_b128 v[248:251], v11 offset:44032
    s_nop 1
    v_permlane16_swap_b32 v16, v18
    v_permlane16_swap_b32 v17, v19
    buffer_store_dwordx4 v[16:19], v13, s[20:23], s46 offen sc1
    v_mfma_f32_16x16x32_bf16 v[204:207], v[252:255], v[36:39], 0
    v_mfma_f32_16x16x32_bf16 v[204:207], v[224:227], v[44:47], v[204:207]
    ds_read_b128 v[252:255], v11 offset:47104
    v_mfma_f32_16x16x32_bf16 v[204:207], v[228:231], v[52:55], v[204:207]
    s_waitcnt lgkmcnt(3)
    v_mfma_f32_16x16x32_bf16 v[192:195], v[232:235], v[56:59], v[192:195]
    ds_read_b128 v[224:227], v11 offset:14336
    v_mfma_f32_16x16x32_bf16 v[192:195], v[236:239], v[64:67], v[192:195]
    v_mfma_f32_16x16x32_bf16 v[192:195], v[240:243], v[72:75], v[192:195]
    ds_read_b128 v[228:231], v11 offset:17408
    v_mfma_f32_16x16x32_bf16 v[196:199], v[232:235], v[60:63], v[196:199]
    v_mfma_f32_16x16x32_bf16 v[196:199], v[236:239], v[68:71], v[196:199]
    ds_read_b128 v[232:235], v11 offset:26624
    v_mfma_f32_16x16x32_bf16 v[196:199], v[240:243], v[76:79], v[196:199]
    s_waitcnt lgkmcnt(3)
    v_mfma_f32_16x16x32_bf16 v[200:203], v[244:247], v[56:59], v[200:203]
    ds_read_b128 v[236:239], v11 offset:20480
    v_mfma_f32_16x16x32_bf16 v[200:203], v[248:251], v[64:67], v[200:203]
    v_mfma_f32_16x16x32_bf16 v[200:203], v[252:255], v[72:75], v[200:203]
    ds_read_b128 v[240:243], v11 offset:23552
    v_mfma_f32_16x16x32_bf16 v[204:207], v[244:247], v[60:63], v[204:207]
    v_mfma_f32_16x16x32_bf16 v[204:207], v[248:251], v[68:71], v[204:207]
    ds_read_b128 v[244:247], v11 offset:32768
    v_mfma_f32_16x16x32_bf16 v[204:207], v[252:255], v[76:79], v[204:207]
    s_waitcnt lgkmcnt(3)
    v_mfma_f32_16x16x32_bf16 v[208:211], v[224:227], v[32:35], 0
    ds_read_b128 v[248:251], v11 offset:29696
    v_mfma_f32_16x16x32_bf16 v[208:211], v[228:231], v[40:43], v[208:211]
    v_mfma_f32_16x16x32_bf16 v[208:211], v[232:235], v[48:51], v[208:211]
    ds_read_b128 v[252:255], v11 offset:38912
    v_mfma_f32_16x16x32_bf16 v[212:215], v[224:227], v[36:39], 0
    v_mfma_f32_16x16x32_bf16 v[212:215], v[228:231], v[44:47], v[212:215]
    ds_read_b128 v[224:227], v11 offset:41984
    v_mfma_f32_16x16x32_bf16 v[212:215], v[232:235], v[52:55], v[212:215]
    s_waitcnt lgkmcnt(3)
    v_mfma_f32_16x16x32_bf16 v[216:219], v[236:239], v[32:35], 0
    ds_read_b128 v[228:231], v11 offset:35840
    v_mfma_f32_16x16x32_bf16 v[216:219], v[240:243], v[40:43], v[216:219]
    v_mfma_f32_16x16x32_bf16 v[216:219], v[244:247], v[48:51], v[216:219]
    ds_read_b128 v[232:235], v11 offset:45056
    v_mfma_f32_16x16x32_bf16 v[220:223], v[236:239], v[36:39], 0
    v_mfma_f32_16x16x32_bf16 v[220:223], v[240:243], v[44:47], v[220:223]
    ds_read_b128 v[236:239], v11 offset:48128
    v_mfma_f32_16x16x32_bf16 v[220:223], v[244:247], v[52:55], v[220:223]
    s_waitcnt lgkmcnt(3)
    v_mfma_f32_16x16x32_bf16 v[208:211], v[248:251], v[56:59], v[208:211]
    s_waitcnt vmcnt(8)
    s_waitcnt vmcnt(0)
    s_waitcnt lgkmcnt(0)
    s_barrier
    s_cmp_eq_u32 s3, 0
    s_cbranch_scc0 SKIP_54
    v_mov_b32 v14, 1
    s_mov_b64 exec, 1
    buffer_atomic_add v14, off, s[20:23], s49
    s_mov_b64 exec, -1
SKIP_54:
    s_add_u32 s49, s49, 256
    s_cmp_ge_u32 s3, 4
    s_cbranch_scc0 NOE_55
    s_add_u32 s67, s66, s61
    s_cmp_eq_u32 s63, 0
    s_cbranch_scc0 E8_56
    s_add_u32 m0, s67, 8192
    s_add_u32 s65, s60, 8192
    buffer_load_dwordx4 v9, s[20:23], s65 offen sc1 lds
E8_56:
    s_add_u32 m0, s67, 0
    s_add_u32 s65, s60, 0
    buffer_load_dwordx4 v9, s[20:23], s65 offen offset:0 sc1 lds
    buffer_load_dwordx4 v9, s[20:23], s65 offen offset:1024 sc1 lds
    buffer_load_dwordx4 v9, s[20:23], s65 offen offset:2048 sc1 lds
    buffer_load_dwordx4 v9, s[20:23], s65 offen offset:3072 sc1 lds
    s_add_u32 m0, s67, 4096
    s_add_u32 s65, s60, 4096
    buffer_load_dwordx4 v9, s[20:23], s65 offen offset:0 sc1 lds
    buffer_load_dwordx4 v9, s[20:23], s65 offen offset:1024 sc1 lds
    buffer_load_dwordx4 v9, s[20:23], s65 offen offset:2048 sc1 lds
    buffer_load_dwordx4 v9, s[20:23], s65 offen offset:3072 sc1 lds
    s_add_u32 s60, s60, s62
    s_add_u32 s66, s66, 34816
    s_cmp_eq_u32 s66, 34816
    s_cmov_b32 s66, 36864
    s_cmp_eq_u32 s66, 141312
    s_cmov_b32 s66, 0
    s_add_u32 s67, s66, s61
    s_cmp_eq_u32 s63, 0
    s_cbranch_scc0 E8_57
    s_add_u32 m0, s67, 8192
    s_add_u32 s65, s60, 8192
    buffer_load_dwordx4 v9, s[20:23], s65 offen sc1 lds
E8_57:
    s_add_u32 m0, s67, 0
    s_add_u32 s65, s60, 0
    buffer_load_dwordx4 v9, s[20:23], s65 offen offset:0 sc1 lds
    buffer_load_dwordx4 v9, s[20:23], s65 offen offset:1024 sc1 lds
    buffer_load_dwordx4 v9, s[20:23], s65 offen offset:2048 sc1 lds
    buffer_load_dwordx4 v9, s[20:23], s65 offen offset:3072 sc1 lds
    s_add_u32 m0, s67, 4096
    s_add_u32 s65, s60, 4096
    buffer_load_dwordx4 v9, s[20:23], s65 offen offset:0 sc1 lds
    buffer_load_dwordx4 v9, s[20:23], s65 offen offset:1024 sc1 lds
    buffer_load_dwordx4 v9, s[20:23], s65 offen offset:2048 sc1 lds
    buffer_load_dwordx4 v9, s[20:23], s65 offen offset:3072 sc1 lds
    s_add_u32 s60, s60, s62
    s_add_u32 s66, s66, 34816
    s_cmp_eq_u32 s66, 34816
    s_cmov_b32 s66, 36864
    s_cmp_eq_u32 s66, 141312
    s_cmov_b32 s66, 0
NOE_55:
    ds_read_b128 v[240:243], v11 offset:49152
    v_mfma_f32_16x16x32_bf16 v[208:211], v[252:255], v[64:67], v[208:211]
    v_mfma_f32_16x16x32_bf16 v[208:211], v[224:227], v[72:75], v[208:211]
    ds_read_b128 v[244:247], v11 offset:52224
    v_mfma_f32_16x16x32_bf16 v[212:215], v[248:251], v[60:63], v[212:215]
    v_mfma_f32_16x16x32_bf16 v[212:215], v[252:255], v[68:71], v[212:215]
    ds_read_b128 v[248:251], v11 offset:61440
    v_mfma_f32_16x16x32_bf16 v[212:215], v[224:227], v[76:79], v[212:215]
    v_mfma_f32_16x16x32_bf16 v[216:219], v[228:231], v[56:59], v[216:219]
    ds_read_b128 v[252:255], v11 offset:55296
    v_mfma_f32_16x16x32_bf16 v[216:219], v[232:235], v[64:67], v[216:219]
    v_mfma_f32_16x16x32_bf16 v[216:219], v[236:239], v[72:75], v[216:219]
    ds_read_b128 v[224:227], v11 offset:58368
    v_mfma_f32_16x16x32_bf16 v[220:223], v[228:231], v[60:63], v[220:223]
    v_mfma_f32_16x16x32_bf16 v[220:223], v[232:235], v[68:71], v[220:223]
    ds_read_b128 v[228:231], v12 offset:6144
    v_mfma_f32_16x16x32_bf16 v[220:223], v[236:239], v[76:79], v[220:223]
    s_waitcnt lgkmcnt(3)
    v_mfma_f32_16x16x32_bf16 v[176:179], v[240:243], v[80:83], v[176:179]
    ds_read_b128 v[232:235], v11 offset:64512
    v_mfma_f32_16x16x32_bf16 v[176:179], v[244:247], v[88:91], v[176:179]
    v_mfma_f32_16x16x32_bf16 v[176:179], v[248:251], v[96:99], v[176:179]
    ds_read_b128 v[236:239], v12 offset:12288
    v_mfma_f32_16x16x32_bf16 v[180:183], v[240:243], v[84:87], v[180:183]
    v_mfma_f32_16x16x32_bf16 v[180:183], v[244:247], v[92:95], v[180:183]
    ds_read_b128 v[240:243], v12 offset:15360
    v_mfma_f32_16x16x32_bf16 v[180:183], v[248:251], v[100:103], v[180:183]
    s_waitcnt lgkmcnt(3)
    v_mfma_f32_16x16x32_bf16 v[184:187], v[252:255], v[80:83], v[184:187]
    ds_read_b128 v[244:247], v12 offset:9216
    v_mfma_f32_16x16x32_bf16 v[184:187], v[224:227], v[88:91], v[184:187]
    v_mfma_f32_16x16x32_bf16 v[184:187], v[228:231], v[96:99], v[184:187]
    ds_read_b128 v[248:251], v12 offset:18432
    v_mfma_f32_16x16x32_bf16 v[188:191], v[252:255], v[84:87], v[188:191]
    v_mfma_f32_16x16x32_bf16 v[188:191], v[224:227], v[92:95], v[188:191]
    ds_read_b128 v[252:255], v12 offset:21504
    v_mfma_f32_16x16x32_bf16 v[188:191], v[228:231], v[100:103], v[188:191]
    s_waitcnt lgkmcnt(3)
    v_mfma_f32_16x16x32_bf16 v[176:179], v[232:235], v[104:107], v[176:179]
    ds_read_b128 v[224:227], v11 offset:50176
    v_mfma_f32_16x16x32_bf16 v[176:179], v[236:239], v[112:115], v[176:179]
    v_mfma_f32_16x16x32_bf16 v[176:179], v[240:243], v[120:123], v[176:179]
    ds_read_b128 v[228:231], v11 offset:53248
    v_mfma_f32_16x16x32_bf16 v[180:183], v[232:235], v[108:111], v[180:183]
    v_mfma_f32_16x16x32_bf16 v[180:183], v[236:239], v[116:119], v[180:183]
    ds_read_b128 v[232:235], v11 offset:62464
    v_mfma_f32_16x16x32_bf16 v[180:183], v[240:243], v[124:127], v[180:183]
    s_waitcnt lgkmcnt(3)
    v_mfma_f32_16x16x32_bf16 v[184:187], v[244:247], v[104:107], v[184:187]
    ds_read_b128 v[236:239], v11 offset:56320
    v_mfma_f32_16x16x32_bf16 v[184:187], v[248:251], v[112:115], v[184:187]
    v_mfma_f32_16x16x32_bf16 v[184:187], v[252:255], v[120:123], v[184:187]
    ds_read_b128 v[240:243], v11 offset:59392
    v_mfma_f32_16x16x32_bf16 v[188:191], v[244:247], v[108:111], v[188:191]
    v_mfma_f32_16x16x32_bf16 v[188:191], v[248:251], v[116:119], v[188:191]
    ds_read_b128 v[244:247], v12 offset:7168
    v_mfma_f32_16x16x32_bf16 v[188:191], v[252:255], v[124:127], v[188:191]
    s_waitcnt lgkmcnt(3)
    v_mfma_f32_16x16x32_bf16 v[192:195], v[224:227], v[80:83], v[192:195]
    ds_read_b128 v[248:251], v12 offset:4096
    v_mfma_f32_16x16x32_bf16 v[192:195], v[228:231], v[88:91], v[192:195]
    v_mfma_f32_16x16x32_bf16 v[192:195], v[232:235], v[96:99], v[192:195]
    ds_read_b128 v[252:255], v12 offset:13312
    v_mfma_f32_16x16x32_bf16 v[196:199], v[224:227], v[84:87], v[196:199]
    v_mfma_f32_16x16x32_bf16 v[196:199], v[228:231], v[92:95], v[196:199]
    ds_read_b128 v[224:227], v12 offset:16384
    v_mfma_f32_16x16x32_bf16 v[196:199], v[232:235], v[100:103], v[196:199]
    s_waitcnt lgkmcnt(3)
    v_mfma_f32_16x16x32_bf16 v[200:203], v[236:239], v[80:83], v[200:203]
    ds_read_b128 v[228:231], v12 offset:10240
    v_mfma_f32_16x16x32_bf16 v[200:203], v[240:243], v[88:91], v[200:203]
    v_mfma_f32_16x16x32_bf16 v[200:203], v[244:247], v[96:99], v[200:203]
    ds_read_b128 v[232:235], v12 offset:19456
    v_mfma_f32_16x16x32_bf16 v[204:207], v[236:239], v[84:87], v[204:207]
    v_mfma_f32_16x16x32_bf16 v[204:207], v[240:243], v[92:95], v[204:207]
    ds_read_b128 v[236:239], v12 offset:22528
    v_mfma_f32_16x16x32_bf16 v[204:207], v[244:247], v[100:103], v[204:207]
    s_waitcnt lgkmcnt(3)
    v_mfma_f32_16x16x32_bf16 v[192:195], v[248:251], v[104:107], v[192:195]
    ds_read_b128 v[240:243], v11 offset:51200
    v_mfma_f32_16x16x32_bf16 v[192:195], v[252:255], v[112:115], v[192:195]
    v_mfma_f32_16x16x32_bf16 v[192:195], v[224:227], v[120:123], v[192:195]
    ds_read_b128 v[244:247], v11 offset:54272
    v_mfma_f32_16x16x32_bf16 v[196:199], v[248:251], v[108:111], v[196:199]
    v_mfma_f32_16x16x32_bf16 v[196:199], v[252:255], v[116:119], v[196:199]
    ds_read_b128 v[248:251], v11 offset:63488
    v_mfma_f32_16x16x32_bf16 v[196:199], v[224:227], v[124:127], v[196:199]
    s_waitcnt lgkmcnt(3)
    v_mfma_f32_16x16x32_bf16 v[200:203], v[228:231], v[104:107], v[200:203]
    ds_read_b128 v[252:255], v11 offset:57344
    v_mfma_f32_16x16x32_bf16 v[200:203], v[232:235], v[112:115], v[200:203]
    v_mfma_f32_16x16x32_bf16 v[200:203], v[236:239], v[120:123], v[200:203]
    ds_read_b128 v[224:227], v11 offset:60416
    v_mfma_f32_16x16x32_bf16 v[204:207], v[228:231], v[108:111], v[204:207]
    v_mfma_f32_16x16x32_bf16 v[204:207], v[232:235], v[116:119], v[204:207]
    ds_read_b128 v[228:231], v12 offset:8192
    v_mfma_f32_16x16x32_bf16 v[204:207], v[236:239], v[124:127], v[204:207]
    s_waitcnt lgkmcnt(3)
    v_mfma_f32_16x16x32_bf16 v[208:211], v[240:243], v[80:83], v[208:211]
    ds_read_b128 v[232:235], v12 offset:5120
    v_mfma_f32_16x16x32_bf16 v[208:211], v[244:247], v[88:91], v[208:211]
    v_mfma_f32_16x16x32_bf16 v[208:211], v[248:251], v[96:99], v[208:211]
    ds_read_b128 v[236:239], v12 offset:14336
    v_mfma_f32_16x16x32_bf16 v[212:215], v[240:243], v[84:87], v[212:215]
    v_mfma_f32_16x16x32_bf16 v[212:215], v[244:247], v[92:95], v[212:215]
    ds_read_b128 v[240:243], v12 offset:17408
    v_mfma_f32_16x16x32_bf16 v[212:215], v[248:251], v[100:103], v[212:215]
    s_waitcnt lgkmcnt(3)
    v_mfma_f32_16x16x32_bf16 v[216:219], v[252:255], v[80:83], v[216:219]
    ds_read_b128 v[244:247], v12 offset:11264
    v_mfma_f32_16x16x32_bf16 v[216:219], v[224:227], v[88:91], v[216:219]
    v_mfma_f32_16x16x32_bf16 v[216:219], v[228:231], v[96:99], v[216:219]
    ds_read_b128 v[248:251], v12 offset:20480
    v_mfma_f32_16x16x32_bf16 v[220:223], v[252:255], v[84:87], v[220:223]
    v_mfma_f32_16x16x32_bf16 v[220:223], v[224:227], v[92:95], v[220:223]
    ds_read_b128 v[252:255], v12 offset:23552
    v_mfma_f32_16x16x32_bf16 v[220:223], v[228:231], v[100:103], v[220:223]
    s_waitcnt lgkmcnt(3)
    v_mfma_f32_16x16x32_bf16 v[208:211], v[232:235], v[104:107], v[208:211]
    s_cmp_ge_u32 s3, 4
    s_cbranch_scc0 NW_58
    s_waitcnt vmcnt(0)
NW_58:
    s_waitcnt lgkmcnt(0)
    s_barrier
    s_cmp_ge_u32 s3, 4
    s_cbranch_scc0 NOE_59
    s_add_u32 s67, s66, s61
    s_cmp_eq_u32 s63, 0
    s_cbranch_scc0 E8_60
    s_add_u32 m0, s67, 8192
    s_add_u32 s65, s60, 8192
    buffer_load_dwordx4 v9, s[20:23], s65 offen sc1 lds
E8_60:
    s_add_u32 m0, s67, 0
    s_add_u32 s65, s60, 0
    buffer_load_dwordx4 v9, s[20:23], s65 offen offset:0 sc1 lds
    buffer_load_dwordx4 v9, s[20:23], s65 offen offset:1024 sc1 lds
    buffer_load_dwordx4 v9, s[20:23], s65 offen offset:2048 sc1 lds
    buffer_load_dwordx4 v9, s[20:23], s65 offen offset:3072 sc1 lds
    s_add_u32 m0, s67, 4096
    s_add_u32 s65, s60, 4096
    buffer_load_dwordx4 v9, s[20:23], s65 offen offset:0 sc1 lds
    buffer_load_dwordx4 v9, s[20:23], s65 offen offset:1024 sc1 lds
    buffer_load_dwordx4 v9, s[20:23], s65 offen offset:2048 sc1 lds
    buffer_load_dwordx4 v9, s[20:23], s65 offen offset:3072 sc1 lds
    s_add_u32 s60, s60, s62
    s_add_u32 s66, s66, 34816
    s_cmp_eq_u32 s66, 34816
    s_cmov_b32 s66, 36864
    s_cmp_eq_u32 s66, 141312
    s_cmov_b32 s66, 0
NOE_59:
    ds_read_b128 v[224:227], v10 offset:0
    v_mfma_f32_16x16x32_bf16 v[208:211], v[236:239], v[112:115], v[208:211]
    v_mfma_f32_16x16x32_bf16 v[208:211], v[240:243], v[120:123], v[208:211]
    ds_read_b128 v[228:231], v10 offset:3072
    v_mfma_f32_16x16x32_bf16 v[212:215], v[232:235], v[108:111], v[212:215]
    v_mfma_f32_16x16x32_bf16 v[212:215], v[236:239], v[116:119], v[212:215]
    ds_read_b128 v[232:235], v10 offset:12288
    v_mfma_f32_16x16x32_bf16 v[212:215], v[240:243], v[124:127], v[212:215]
    v_mfma_f32_16x16x32_bf16 v[216:219], v[244:247], v[104:107], v[216:219]
    ds_read_b128 v[236:239], v10 offset:6144
    v_mfma_f32_16x16x32_bf16 v[216:219], v[248:251], v[112:115], v[216:219]
    v_mfma_f32_16x16x32_bf16 v[216:219], v[252:255], v[120:123], v[216:219]
    ds_read_b128 v[240:243], v10 offset:9216
    v_mfma_f32_16x16x32_bf16 v[220:223], v[244:247], v[108:111], v[220:223]
    v_mfma_f32_16x16x32_bf16 v[220:223], v[248:251], v[116:119], v[220:223]
    ds_read_b128 v[244:247], v10 offset:18432
    v_mfma_f32_16x16x32_bf16 v[220:223], v[252:255], v[124:127], v[220:223]
    s_waitcnt lgkmcnt(3)
    v_mfma_f32_16x16x32_bf16 v[176:179], v[224:227], v[128:131], v[176:179]
    ds_read_b128 v[248:251], v10 offset:15360
    v_mfma_f32_16x16x32_bf16 v[176:179], v[228:231], v[136:139], v[176:179]
    v_mfma_f32_16x16x32_bf16 v[176:179], v[232:235], v[144:147], v[176:179]
    ds_read_b128 v[252:255], v10 offset:24576
    v_mfma_f32_16x16x32_bf16 v[180:183], v[224:227], v[132:135], v[180:183]
    v_mfma_f32_16x16x32_bf16 v[180:183], v[228:231], v[140:143], v[180:183]
    ds_read_b128 v[224:227], v10 offset:27648
    v_mfma_f32_16x16x32_bf16 v[180:183], v[232:235], v[148:151], v[180:183]
    s_waitcnt lgkmcnt(3)
    v_mfma_f32_16x16x32_bf16 v[184:187], v[236:239], v[128:131], v[184:187]
    ds_read_b128 v[228:231], v10 offset:21504
    v_mfma_f32_16x16x32_bf16 v[184:187], v[240:243], v[136:139], v[184:187]
    v_mfma_f32_16x16x32_bf16 v[184:187], v[244:247], v[144:147], v[184:187]
    ds_read_b128 v[232:235], v10 offset:30720
    v_mfma_f32_16x16x32_bf16 v[188:191], v[236:239], v[132:135], v[188:191]
    v_mfma_f32_16x16x32_bf16 v[188:191], v[240:243], v[140:143], v[188:191]
    ds_read_b128 v[236:239], v10 offset:33792
    v_mfma_f32_16x16x32_bf16 v[188:191], v[244:247], v[148:151], v[188:191]
    s_waitcnt lgkmcnt(3)
    v_mfma_f32_16x16x32_bf16 v[176:179], v[248:251], v[152:155], v[176:179]
    ds_read_b128 v[240:243], v10 offset:1024
    v_mfma_f32_16x16x32_bf16 v[176:179], v[252:255], v[160:163], v[176:179]
    v_mfma_f32_16x16x32_bf16 v[176:179], v[224:227], v[168:171], v[176:179]
    ds_read_b128 v[244:247], v10 offset:4096
    v_mfma_f32_16x16x32_bf16 v[180:183], v[248:251], v[156:159], v[180:183]
    v_mfma_f32_16x16x32_bf16 v[180:183], v[252:255], v[164:167], v[180:183]
    ds_read_b128 v[248:251], v10 offset:13312
    v_mfma_f32_16x16x32_bf16 v[180:183], v[224:227], v[172:175], v[180:183]
    s_waitcnt lgkmcnt(3)
    v_mfma_f32_16x16x32_bf16 v[184:187], v[228:231], v[152:155], v[184:187]
    ds_read_b128 v[252:255], v10 offset:7168
    v_mfma_f32_16x16x32_bf16 v[184:187], v[232:235], v[160:163], v[184:187]
    v_mfma_f32_16x16x32_bf16 v[184:187], v[236:239], v[168:171], v[184:187]
    ds_read_b128 v[224:227], v10 offset:10240
    v_mfma_f32_16x16x32_bf16 v[188:191], v[228:231], v[156:159], v[188:191]
    v_mfma_f32_16x16x32_bf16 v[188:191], v[232:235], v[164:167], v[188:191]
    ds_read_b128 v[228:231], v10 offset:19456
    v_mfma_f32_16x16x32_bf16 v[188:191], v[236:239], v[172:175], v[188:191]
    s_waitcnt lgkmcnt(3)
    v_mfma_f32_16x16x32_bf16 v[192:195], v[240:243], v[128:131], v[192:195]
    ds_read_b128 v[232:235], v10 offset:16384
    v_mfma_f32_16x16x32_bf16 v[192:195], v[244:247], v[136:139], v[192:195]
    v_mfma_f32_16x16x32_bf16 v[192:195], v[248:251], v[144:147], v[192:195]
    ds_read_b128 v[236:239], v10 offset:25600
    v_mfma_f32_16x16x32_bf16 v[196:199], v[240:243], v[132:135], v[196:199]
    v_mfma_f32_16x16x32_bf16 v[196:199], v[244:247], v[140:143], v[196:199]
    ds_read_b128 v[240:243], v10 offset:28672
    v_mfma_f32_16x16x32_bf16 v[196:199], v[248:251], v[148:151], v[196:199]
    s_waitcnt lgkmcnt(3)
    v_mfma_f32_16x16x32_bf16 v[200:203], v[252:255], v[128:131], v[200:203]
    ds_read_b128 v[244:247], v10 offset:22528
    v_mfma_f32_16x16x32_bf16 v[200:203], v[224:227], v[136:139], v[200:203]
    v_mfma_f32_16x16x32_bf16 v[200:203], v[228:231], v[144:147], v[200:203]
    ds_read_b128 v[248:251], v10 offset:31744
    s_lshr_b32 s46, s45, 1
    s_lshl_b32 s46, s46, 13
    v_mfma_f32_16x16x32_bf16 v[204:207], v[252:255], v[132:135], v[204:207]
    s_and_b32 s47, s45, 1
    s_lshl_b32 s47, s47, 9
    v_mfma_f32_16x16x32_bf16 v[204:207], v[224:227], v[140:143], v[204:207]
    ds_read_b128 v[252:255], v10 offset:34816
    s_add_u32 s46, s46, s47
    s_add_u32 s46, s46, s44
    s_add_u32 s45, s45, 1
    v_mfma_f32_16x16x32_bf16 v[204:207], v[228:231], v[148:151], v[204:207]
    v_max_f32 v176, 0, v176
    s_waitcnt lgkmcnt(3)
    v_mfma_f32_16x16x32_bf16 v[192:195], v[232:235], v[152:155], v[192:195]
    ds_read_b128 v[224:227], v10 offset:2048
    v_max_f32 v177, 0, v177
    v_mfma_f32_16x16x32_bf16 v[192:195], v[236:239], v[160:163], v[192:195]
    v_max_f32 v178, 0, v178
    v_mfma_f32_16x16x32_bf16 v[192:195], v[240:243], v[168:171], v[192:195]
    ds_read_b128 v[228:231], v10 offset:5120
    v_max_f32 v179, 0, v179
    v_mfma_f32_16x16x32_bf16 v[196:199], v[232:235], v[156:159], v[196:199]
    v_mul_f32 v176, v176, v184
    v_mfma_f32_16x16x32_bf16 v[196:199], v[236:239], v[164:167], v[196:199]
    ds_read_b128 v[232:235], v10 offset:14336
    v_mul_f32 v177, v177, v185
    v_mfma_f32_16x16x32_bf16 v[196:199], v[240:243], v[172:175], v[196:199]
    v_mul_f32 v178, v178, v186
    s_waitcnt lgkmcnt(3)
    v_mfma_f32_16x16x32_bf16 v[200:203], v[244:247], v[152:155], v[200:203]
    ds_read_b128 v[236:239], v10 offset:8192
    v_mul_f32 v179, v179, v187
    v_mfma_f32_16x16x32_bf16 v[200:203], v[248:251], v[160:163], v[200:203]
    v_cvt_pk_bf16_f32 v16, v176, v177
    v_mfma_f32_16x16x32_bf16 v[200:203], v[252:255], v[168:171], v[200:203]
    ds_read_b128 v[240:243], v10 offset:11264
    v_cvt_pk_bf16_f32 v17, v178, v179
    v_mfma_f32_16x16x32_bf16 v[204:207], v[244:247], v[156:159], v[204:207]
    v_max_f32 v180, 0, v180
    v_mfma_f32_16x16x32_bf16 v[204:207], v[248:251], v[164:167], v[204:207]
    ds_read_b128 v[244:247], v10 offset:20480
    v_max_f32 v181, 0, v181
    v_mfma_f32_16x16x32_bf16 v[204:207], v[252:255], v[172:175], v[204:207]
    v_max_f32 v182, 0, v182
    s_waitcnt lgkmcnt(3)
    v_mfma_f32_16x16x32_bf16 v[208:211], v[224:227], v[128:131], v[208:211]
    ds_read_b128 v[248:251], v10 offset:17408
    v_max_f32 v183, 0, v183
    v_mfma_f32_16x16x32_bf16 v[208:211], v[228:231], v[136:139], v[208:211]
    v_mul_f32 v180, v180, v188
    v_mfma_f32_16x16x32_bf16 v[208:211], v[232:235], v[144:147], v[208:211]
    ds_read_b128 v[252:255], v10 offset:26624
    v_mul_f32 v181, v181, v189
    v_mfma_f32_16x16x32_bf16 v[212:215], v[224:227], v[132:135], v[212:215]
    v_mul_f32 v182, v182, v190
    v_mfma_f32_16x16x32_bf16 v[212:215], v[228:231], v[140:143], v[212:215]
    ds_read_b128 v[224:227], v10 offset:29696
    v_mul_f32 v183, v183, v191
    v_mfma_f32_16x16x32_bf16 v[212:215], v[232:235], v[148:151], v[212:215]
    v_cvt_pk_bf16_f32 v18, v180, v181
    s_waitcnt lgkmcnt(3)
    v_mfma_f32_16x16x32_bf16 v[216:219], v[236:239], v[128:131], v[216:219]
    ds_read_b128 v[228:231], v10 offset:23552
    v_cvt_pk_bf16_f32 v19, v182, v183
    v_mfma_f32_16x16x32_bf16 v[216:219], v[240:243], v[136:139], v[216:219]
    s_nop 1
    v_permlane16_swap_b32 v16, v18
    v_permlane16_swap_b32 v17, v19
    buffer_store_dwordx4 v[16:19], v13, s[20:23], s46 offen sc1
    v_mfma_f32_16x16x32_bf16 v[216:219], v[244:247], v[144:147], v[216:219]
    ds_read_b128 v[232:235], v10 offset:32768
    v_mfma_f32_16x16x32_bf16 v[220:223], v[236:239], v[132:135], v[220:223]
    s_lshr_b32 s46, s45, 1
    s_lshl_b32 s46, s46, 13
    v_mfma_f32_16x16x32_bf16 v[220:223], v[240:243], v[140:143], v[220:223]
    ds_read_b128 v[236:239], v10 offset:35840
    s_and_b32 s47, s45, 1
    s_lshl_b32 s47, s47, 9
    v_mfma_f32_16x16x32_bf16 v[220:223], v[244:247], v[148:151], v[220:223]
    s_add_u32 s46, s46, s47
    s_add_u32 s46, s46, s44
    s_add_u32 s45, s45, 1
    s_waitcnt lgkmcnt(3)
    v_mfma_f32_16x16x32_bf16 v[208:211], v[248:251], v[152:155], v[208:211]
    v_max_f32 v192, 0, v192
    v_mfma_f32_16x16x32_bf16 v[208:211], v[252:255], v[160:163], v[208:211]
    v_max_f32 v193, 0, v193
    v_mfma_f32_16x16x32_bf16 v[208:211], v[224:227], v[168:171], v[208:211]
    v_max_f32 v194, 0, v194
    v_mfma_f32_16x16x32_bf16 v[212:215], v[248:251], v[156:159], v[212:215]
    v_max_f32 v195, 0, v195
    v_mfma_f32_16x16x32_bf16 v[212:215], v[252:255], v[164:167], v[212:215]
    v_mul_f32 v192, v192, v200
    v_mfma_f32_16x16x32_bf16 v[212:215], v[224:227], v[172:175], v[212:215]
    v_mul_f32 v193, v193, v201
    s_waitcnt lgkmcnt(0)
    v_mfma_f32_16x16x32_bf16 v[216:219], v[228:231], v[152:155], v[216:219]
    v_mul_f32 v194, v194, v202
    v_mfma_f32_16x16x32_bf16 v[216:219], v[232:235], v[160:163], v[216:219]
    v_mul_f32 v195, v195, v203
    v_mfma_f32_16x16x32_bf16 v[216:219], v[236:239], v[168:171], v[216:219]
    v_cvt_pk_bf16_f32 v20, v192, v193
    v_mfma_f32_16x16x32_bf16 v[220:223], v[228:231], v[156:159], v[220:223]
    v_cvt_pk_bf16_f32 v21, v194, v195
    v_mfma_f32_16x16x32_bf16 v[220:223], v[232:235], v[164:167], v[220:223]
    v_max_f32 v196, 0, v196
    v_mfma_f32_16x16x32_bf16 v[220:223], v[236:239], v[172:175], v[220:223]
    v_max_f32 v197, 0, v197
    s_nop 7
    v_max_f32 v198, 0, v198
    v_max_f32 v199, 0, v199
    v_mul_f32 v196, v196, v204
    v_mul_f32 v197, v197, v205
    v_mul_f32 v198, v198, v206
    v_mul_f32 v199, v199, v207
    v_cvt_pk_bf16_f32 v22, v196, v197
    v_cvt_pk_bf16_f32 v23, v198, v199
    s_nop 1
    v_permlane16_swap_b32 v20, v22
    v_permlane16_swap_b32 v21, v23
    buffer_store_dwordx4 v[20:23], v13, s[20:23], s46 offen sc1
    s_lshr_b32 s46, s45, 1
    s_lshl_b32 s46, s46, 13
    s_and_b32 s47, s45, 1
    s_lshl_b32 s47, s47, 9
    s_add_u32 s46, s46, s47
    s_add_u32 s46, s46, s44
    s_add_u32 s45, s45, 22
    v_max_f32 v208, 0, v208
    v_max_f32 v209, 0, v209
    v_max_f32 v210, 0, v210
    v_max_f32 v211, 0, v211
    v_mul_f32 v208, v208, v216
    v_mul_f32 v209, v209, v217
    v_mul_f32 v210, v210, v218
    v_mul_f32 v211, v211, v219
    v_cvt_pk_bf16_f32 v16, v208, v209
    v_cvt_pk_bf16_f32 v17, v210, v211
    v_max_f32 v212, 0, v212
    v_max_f32 v213, 0, v213
    v_max_f32 v214, 0, v214
    v_max_f32 v215, 0, v215
    v_mul_f32 v212, v212, v220
    v_mul_f32 v213, v213, v221
    v_mul_f32 v214, v214, v222
    v_mul_f32 v215, v215, v223
    v_cvt_pk_bf16_f32 v18, v212, v213
    v_cvt_pk_bf16_f32 v19, v214, v215
    s_nop 1
    v_permlane16_swap_b32 v16, v18
    v_permlane16_swap_b32 v17, v19
    buffer_store_dwordx4 v[16:19], v13, s[20:23], s46 offen sc1
PH_E:
    s_and_b32 s30, s2, 1
    s_bfe_u32 s31, s2, 0x20001
    s_lshl_b32 s30, s30, 3
    s_lshr_b32 s35, s2, 5
    s_add_u32 s35, s35, s30
    s_bfe_u32 s33, s2, 0x20003
    s_and_b32 s34, s3, 3
    s_lshl_b32 s46, s35, 2
    s_add_u32 s47, s46, s33
    s_lshl_b32 s47, s47, 2
    s_lshl_b32 s47, s47, 8
    s_add_u32 s47, s47, 65536
    s_add_u32 s46, s46, s31
    s_setprio 0
    s_cmp_ge_u32 s3, 4
    s_cbranch_scc0 E_CONS
    s_cmp_eq_u32 s63, 0
    s_cbranch_scc0 E_LH
    s_add_u32 m0, s61, 0
    s_add_u32 s65, s60, 4096
    s_add_u32 s67, s61, 4096
    s_barrier
    buffer_load_dwordx4 v9, s[20:23], s60 offen offset:0 sc1 lds
    buffer_load_dwordx4 v9, s[20:23], s60 offen offset:1024 sc1 lds
    buffer_load_dwordx4 v9, s[20:23], s60 offen offset:2048 sc1 lds
    buffer_load_dwordx4 v9, s[20:23], s60 offen offset:3072 sc1 lds
    s_mov_b32 m0, s67
    s_add_u32 s60, s60, 8192
    buffer_load_dwordx4 v9, s[20:23], s65 offen offset:0 sc1 lds
    buffer_load_dwordx4 v9, s[20:23], s65 offen offset:1024 sc1 lds
    buffer_load_dwordx4 v9, s[20:23], s65 offen offset:2048 sc1 lds
    buffer_load_dwordx4 v9, s[20:23], s65 offen offset:3072 sc1 lds
    s_add_u32 m0, s67, 4096
    s_nop 0
    buffer_load_dwordx4 v9, s[20:23], s60 offen sc1 lds
    s_add_u32 s60, s60, 10240
    s_add_u32 m0, s61, 36864
    s_add_u32 s65, s60, 4096
    s_add_u32 s67, s61, 40960
    s_waitcnt vmcnt(9)
    s_barrier
    s_cmp_eq_u32 s3, 4
    s_cbranch_scc0 SKIP_61
    v_mov_b32 v14, 1
    s_mov_b64 exec, 1
    buffer_atomic_add v14, off, s[20:23], s49
    s_mov_b64 exec, -1
SKIP_61:
    buffer_load_dwordx4 v9, s[20:23], s60 offen offset:0 sc1 lds
    buffer_load_dwordx4 v9, s[20:23], s60 offen offset:1024 sc1 lds
    buffer_load_dwordx4 v9, s[20:23], s60 offen offset:2048 sc1 lds
    buffer_load_dwordx4 v9, s[20:23], s60 offen offset:3072 sc1 lds
    s_mov_b32 m0, s67
    s_add_u32 s60, s60, 8192
    buffer_load_dwordx4 v9, s[20:23], s65 offen offset:0 sc1 lds
    buffer_load_dwordx4 v9, s[20:23], s65 offen offset:1024 sc1 lds
    buffer_load_dwordx4 v9, s[20:23], s65 offen offset:2048 sc1 lds
    buffer_load_dwordx4 v9, s[20:23], s65 offen offset:3072 sc1 lds
    s_add_u32 m0, s67, 4096
    s_nop 0
    buffer_load_dwordx4 v9, s[20:23], s60 offen sc1 lds
    s_add_u32 s60, s60, 10240
    s_add_u32 m0, s61, 71680
    s_add_u32 s65, s60, 4096
    s_add_u32 s67, s61, 75776
    s_waitcnt vmcnt(9)
    s_barrier
    buffer_load_dwordx4 v9, s[20:23], s60 offen offset:0 sc1 lds
    buffer_load_dwordx4 v9, s[20:23], s60 offen offset:1024 sc1 lds
    buffer_load_dwordx4 v9, s[20:23], s60 offen offset:2048 sc1 lds
    buffer_load_dwordx4 v9, s[20:23], s60 offen offset:3072 sc1 lds
    s_mov_b32 m0, s67
    s_add_u32 s60, s60, 8192
    buffer_load_dwordx4 v9, s[20:23], s65 offen offset:0 sc1 lds
    buffer_load_dwordx4 v9, s[20:23], s65 offen offset:1024 sc1 lds
    buffer_load_dwordx4 v9, s[20:23], s65 offen offset:2048 sc1 lds
    buffer_load_dwordx4 v9, s[20:23], s65 offen offset:3072 sc1 lds
    s_add_u32 m0, s67, 4096
    s_nop 0
    buffer_load_dwordx4 v9, s[20:23], s60 offen sc1 lds
    s_add_u32 s60, s60, 10240
    s_add_u32 m0, s61, 106496
    s_add_u32 s65, s60, 4096
    s_add_u32 s67, s61, 110592
    s_waitcnt vmcnt(9)
    s_barrier
    buffer_load_dwordx4 v9, s[20:23], s60 offen offset:0 sc1 lds
    buffer_load_dwordx4 v9, s[20:23], s60 offen offset:1024 sc1 lds
    buffer_load_dwordx4 v9, s[20:23], s60 offen offset:2048 sc1 lds
    buffer_load_dwordx4 v9, s[20:23], s60 offen offset:3072 sc1 lds
    s_mov_b32 m0, s67
    s_add_u32 s60, s60, 8192
    buffer_load_dwordx4 v9, s[20:23], s65 offen offset:0 sc1 lds
    buffer_load_dwordx4 v9, s[20:23], s65 offen offset:1024 sc1 lds
    buffer_load_dwordx4 v9, s[20:23], s65 offen offset:2048 sc1 lds
    buffer_load_dwordx4 v9, s[20:23], s65 offen offset:3072 sc1 lds
    s_add_u32 m0, s67, 4096
    s_nop 0
    buffer_load_dwordx4 v9, s[20:23], s60 offen sc1 lds
    s_add_u32 s60, s60, 10240
    s_add_u32 m0, s61, 0
    s_add_u32 s65, s60, 4096
    s_add_u32 s67, s61, 4096
    s_waitcnt vmcnt(9)
    s_barrier
    buffer_load_dwordx4 v9, s[20:23], s60 offen offset:0 sc1 lds
    buffer_load_dwordx4 v9, s[20:23], s60 offen offset:1024 sc1 lds
    buffer_load_dwordx4 v9, s[20:23], s60 offen offset:2048 sc1 lds
    buffer_load_dwordx4 v9, s[20:23], s60 offen offset:3072 sc1 lds
    s_mov_b32 m0, s67
    s_add_u32 s60, s60, 8192
    buffer_load_dwordx4 v9, s[20:23], s65 offen offset:0 sc1 lds
    buffer_load_dwordx4 v9, s[20:23], s65 offen offset:1024 sc1 lds
    buffer_load_dwordx4 v9, s[20:23], s65 offen offset:2048 sc1 lds
    buffer_load_dwordx4 v9, s[20:23], s65 offen offset:3072 sc1 lds
    s_add_u32 m0, s67, 4096
    s_nop 0
    buffer_load_dwordx4 v9, s[20:23], s60 offen sc1 lds
    s_add_u32 s60, s60, 10240
    s_add_u32 m0, s61, 36864
    s_add_u32 s65, s60, 4096
    s_add_u32 s67, s61, 40960
    s_waitcnt vmcnt(9)
    s_barrier
    buffer_load_dwordx4 v9, s[20:23], s60 offen offset:0 sc1 lds
    buffer_load_dwordx4 v9, s[20:23], s60 offen offset:1024 sc1 lds
    buffer_load_dwordx4 v9, s[20:23], s60 offen offset:2048 sc1 lds
    buffer_load_dwordx4 v9, s[20:23], s60 offen offset:3072 sc1 lds
    s_mov_b32 m0, s67
    s_add_u32 s60, s60, 8192
    buffer_load_dwordx4 v9, s[20:23], s65 offen offset:0 sc1 lds
    buffer_load_dwordx4 v9, s[20:23], s65 offen offset:1024 sc1 lds
    buffer_load_dwordx4 v9, s[20:23], s65 offen offset:2048 sc1 lds
    buffer_load_dwordx4 v9, s[20:23], s65 offen offset:3072 sc1 lds
    s_add_u32 m0, s67, 4096
    s_nop 0
    buffer_load_dwordx4 v9, s[20:23], s60 offen sc1 lds
    s_add_u32 s60, s60, 10240
    s_add_u32 m0, s61, 71680
    s_add_u32 s65, s60, 4096
    s_add_u32 s67, s61, 75776
    s_waitcnt vmcnt(9)
    s_barrier
    buffer_load_dwordx4 v9, s[20:23], s60 offen offset:0 sc1 lds
    buffer_load_dwordx4 v9, s[20:23], s60 offen offset:1024 sc1 lds
    buffer_load_dwordx4 v9, s[20:23], s60 offen offset:2048 sc1 lds
    buffer_load_dwordx4 v9, s[20:23], s60 offen offset:3072 sc1 lds
    s_mov_b32 m0, s67
    s_add_u32 s60, s60, 8192
    buffer_load_dwordx4 v9, s[20:23], s65 offen offset:0 sc1 lds
    buffer_load_dwordx4 v9, s[20:23], s65 offen offset:1024 sc1 lds
    buffer_load_dwordx4 v9, s[20:23], s65 offen offset:2048 sc1 lds
    buffer_load_dwordx4 v9, s[20:23], s65 offen offset:3072 sc1 lds
    s_add_u32 m0, s67, 4096
    s_nop 0
    buffer_load_dwordx4 v9, s[20:23], s60 offen sc1 lds
    s_add_u32 s60, s60, 10240
    s_add_u32 m0, s61, 106496
    s_add_u32 s65, s60, 4096
    s_add_u32 s67, s61, 110592
    s_waitcnt vmcnt(9)
    s_barrier
    buffer_load_dwordx4 v9, s[20:23], s60 offen offset:0 sc1 lds
    buffer_load_dwordx4 v9, s[20:23], s60 offen offset:1024 sc1 lds
    buffer_load_dwordx4 v9, s[20:23], s60 offen offset:2048 sc1 lds
    buffer_load_dwordx4 v9, s[20:23], s60 offen offset:3072 sc1 lds
    s_mov_b32 m0, s67
    s_add_u32 s60, s60, 8192
    buffer_load_dwordx4 v9, s[20:23], s65 offen offset:0 sc1 lds
    buffer_load_dwordx4 v9, s[20:23], s65 offen offset:1024 sc1 lds
    buffer_load_dwordx4 v9, s[20:23], s65 offen offset:2048 sc1 lds
    buffer_load_dwordx4 v9, s[20:23], s65 offen offset:3072 sc1 lds
    s_add_u32 m0, s67, 4096
    s_nop 0
    buffer_load_dwordx4 v9, s[20:23], s60 offen sc1 lds
    s_add_u32 s60, s60, 10240
    s_add_u32 m0, s61, 0
    s_add_u32 s65, s60, 4096
    s_add_u32 s67, s61, 4096
    s_waitcnt vmcnt(9)
    s_barrier
    buffer_load_dwordx4 v9, s[20:23], s60 offen offset:0 sc1 lds
    buffer_load_dwordx4 v9, s[20:23], s60 offen offset:1024 sc1 lds
    buffer_load_dwordx4 v9, s[20:23], s60 offen offset:2048 sc1 lds
    buffer_load_dwordx4 v9, s[20:23], s60 offen offset:3072 sc1 lds
    s_mov_b32 m0, s67
    s_add_u32 s60, s60, 8192
    buffer_load_dwordx4 v9, s[20:23], s65 offen offset:0 sc1 lds
    buffer_load_dwordx4 v9, s[20:23], s65 offen offset:1024 sc1 lds
    buffer_load_dwordx4 v9, s[20:23], s65 offen offset:2048 sc1 lds
    buffer_load_dwordx4 v9, s[20:23], s65 offen offset:3072 sc1 lds
    s_add_u32 m0, s67, 4096
    s_nop 0
    buffer_load_dwordx4 v9, s[20:23], s60 offen sc1 lds
    s_add_u32 s60, s60, 10240
    s_add_u32 m0, s61, 36864
    s_add_u32 s65, s60, 4096
    s_add_u32 s67, s61, 40960
    s_waitcnt vmcnt(9)
    s_barrier
    buffer_load_dwordx4 v9, s[20:23], s60 offen offset:0 sc1 lds
    buffer_load_dwordx4 v9, s[20:23], s60 offen offset:1024 sc1 lds
    buffer_load_dwordx4 v9, s[20:23], s60 offen offset:2048 sc1 lds
    buffer_load_dwordx4 v9, s[20:23], s60 offen offset:3072 sc1 lds
    s_mov_b32 m0, s67
    s_add_u32 s60, s60, 8192
    buffer_load_dwordx4 v9, s[20:23], s65 offen offset:0 sc1 lds
    buffer_load_dwordx4 v9, s[20:23], s65 offen offset:1024 sc1 lds
    buffer_load_dwordx4 v9, s[20:23], s65 offen offset:2048 sc1 lds
    buffer_load_dwordx4 v9, s[20:23], s65 offen offset:3072 sc1 lds
    s_add_u32 m0, s67, 4096
    s_nop 0
    buffer_load_dwordx4 v9, s[20:23], s60 offen sc1 lds
    s_add_u32 s60, s60, 10240
    s_add_u32 m0, s61, 71680
    s_add_u32 s65, s60, 4096
    s_add_u32 s67, s61, 75776
    s_waitcnt vmcnt(9)
    s_barrier
    buffer_load_dwordx4 v9, s[20:23], s60 offen offset:0 sc1 lds
    buffer_load_dwordx4 v9, s[20:23], s60 offen offset:1024 sc1 lds
    buffer_load_dwordx4 v9, s[20:23], s60 offen offset:2048 sc1 lds
    buffer_load_dwordx4 v9, s[20:23], s60 offen offset:3072 sc1 lds
    s_mov_b32 m0, s67
    s_add_u32 s60, s60, 8192
    buffer_load_dwordx4 v9, s[20:23], s65 offen offset:0 sc1 lds
    buffer_load_dwordx4 v9, s[20:23], s65 offen offset:1024 sc1 lds
    buffer_load_dwordx4 v9, s[20:23], s65 offen offset:2048 sc1 lds
    buffer_load_dwordx4 v9, s[20:23], s65 offen offset:3072 sc1 lds
    s_add_u32 m0, s67, 4096
    s_nop 0
    buffer_load_dwordx4 v9, s[20:23], s60 offen sc1 lds
    s_add_u32 s60, s60, 10240
    s_add_u32 m0, s61, 106496
    s_add_u32 s65, s60, 4096
    s_add_u32 s67, s61, 110592
    s_waitcnt vmcnt(9)
    s_barrier
    buffer_load_dwordx4 v9, s[20:23], s60 offen offset:0 sc1 lds
    buffer_load_dwordx4 v9, s[20:23], s60 offen offset:1024 sc1 lds
    buffer_load_dwordx4 v9, s[20:23], s60 offen offset:2048 sc1 lds
    buffer_load_dwordx4 v9, s[20:23], s60 offen offset:3072 sc1 lds
    s_mov_b32 m0, s67
    s_add_u32 s60, s60, 8192
    buffer_load_dwordx4 v9, s[20:23], s65 offen offset:0 sc1 lds
    buffer_load_dwordx4 v9, s[20:23], s65 offen offset:1024 sc1 lds
    buffer_load_dwordx4 v9, s[20:23], s65 offen offset:2048 sc1 lds
    buffer_load_dwordx4 v9, s[20:23], s65 offen offset:3072 sc1 lds
    s_add_u32 m0, s67, 4096
    s_nop 0
    buffer_load_dwordx4 v9, s[20:23], s60 offen sc1 lds
    s_add_u32 s60, s60, 10240
    s_add_u32 m0, s61, 0
    s_add_u32 s65, s60, 4096
    s_add_u32 s67, s61, 4096
    s_waitcnt vmcnt(9)
    s_barrier
    buffer_load_dwordx4 v9, s[20:23], s60 offen offset:0 sc1 lds
    buffer_load_dwordx4 v9, s[20:23], s60 offen offset:1024 sc1 lds
    buffer_load_dwordx4 v9, s[20:23], s60 offen offset:2048 sc1 lds
    buffer_load_dwordx4 v9, s[20:23], s60 offen offset:3072 sc1 lds
    s_mov_b32 m0, s67
    s_add_u32 s60, s60, 8192
    buffer_load_dwordx4 v9, s[20:23], s65 offen offset:0 sc1 lds
    buffer_load_dwordx4 v9, s[20:23], s65 offen offset:1024 sc1 lds
    buffer_load_dwordx4 v9, s[20:23], s65 offen offset:2048 sc1 lds
    buffer_load_dwordx4 v9, s[20:23], s65 offen offset:3072 sc1 lds
    s_add_u32 m0, s67, 4096
    s_nop 0
    buffer_load_dwordx4 v9, s[20:23], s60 offen sc1 lds
    s_add_u32 s60, s60, 10240
    s_add_u32 m0, s61, 36864
    s_add_u32 s65, s60, 4096
    s_add_u32 s67, s61, 40960
    s_waitcnt vmcnt(9)
    s_barrier
    buffer_load_dwordx4 v9, s[20:23], s60 offen offset:0 sc1 lds
    buffer_load_dwordx4 v9, s[20:23], s60 offen offset:1024 sc1 lds
    buffer_load_dwordx4 v9, s[20:23], s60 offen offset:2048 sc1 lds
    buffer_load_dwordx4 v9, s[20:23], s60 offen offset:3072 sc1 lds
    s_mov_b32 m0, s67
    s_add_u32 s60, s60, 8192
    buffer_load_dwordx4 v9, s[20:23], s65 offen offset:0 sc1 lds
    buffer_load_dwordx4 v9, s[20:23], s65 offen offset:1024 sc1 lds
    buffer_load_dwordx4 v9, s[20:23], s65 offen offset:2048 sc1 lds
    buffer_load_dwordx4 v9, s[20:23], s65 offen offset:3072 sc1 lds
    s_add_u32 m0, s67, 4096
    s_nop 0
    buffer_load_dwordx4 v9, s[20:23], s60 offen sc1 lds
    s_add_u32 s60, s60, 10240
    s_add_u32 m0, s61, 71680
    s_add_u32 s65, s60, 4096
    s_add_u32 s67, s61, 75776
    s_waitcnt vmcnt(9)
    s_barrier
    buffer_load_dwordx4 v9, s[20:23], s60 offen offset:0 sc1 lds
    buffer_load_dwordx4 v9, s[20:23], s60 offen offset:1024 sc1 lds
    buffer_load_dwordx4 v9, s[20:23], s60 offen offset:2048 sc1 lds
    buffer_load_dwordx4 v9, s[20:23], s60 offen offset:3072 sc1 lds
    s_mov_b32 m0, s67
    s_add_u32 s60, s60, 8192
    buffer_load_dwordx4 v9, s[20:23], s65 offen offset:0 sc1 lds
    buffer_load_dwordx4 v9, s[20:23], s65 offen offset:1024 sc1 lds
    buffer_load_dwordx4 v9, s[20:23], s65 offen offset:2048 sc1 lds
    buffer_load_dwordx4 v9, s[20:23], s65 offen offset:3072 sc1 lds
    s_add_u32 m0, s67, 4096
    s_nop 0
    buffer_load_dwordx4 v9, s[20:23], s60 offen sc1 lds
    s_add_u32 s60, s60, 10240
    s_waitcnt vmcnt(9)
    s_barrier
    s_waitcnt vmcnt(0)
    s_barrier
    s_branch E_JOIN
E_LH:
    s_add_u32 s42, s64, 256
    v_mov_b32 v24, s42
    v_mov_b32 v25, 8
    v_and_b32 v4, 31, v0
    v_bfe_u32 v5, v0, 5, 1
    v_mul_u32_u24 v5, 1280, v5
    v_lshl_add_u32 v5, v4, 2, v5
    s_mul_i32 s42, s46, 2560
    s_add_u32 s42, s42, 14491648
    s_lshl_b32 s41, s31, 8
    s_add_u32 s41, s41, s47
    v_mov_b32 v20, s41
    v_mov_b32 v21, 3
    s_add_u32 m0, s61, 0
    s_add_u32 s65, s60, 4096
    s_add_u32 s67, s61, 4096
    s_barrier
    buffer_load_dwordx4 v9, s[20:23], s60 offen offset:0 sc1 lds
    buffer_load_dwordx4 v9, s[20:23], s60 offen offset:1024 sc1 lds
    buffer_load_dwordx4 v9, s[20:23], s60 offen offset:2048 sc1 lds
    buffer_load_dwordx4 v9, s[20:23], s60 offen offset:3072 sc1 lds
    s_mov_b32 m0, s67
    s_add_u32 s60, s60, 16384
    buffer_load_dwordx4 v9, s[20:23], s65 offen offset:0 sc1 lds
    buffer_load_dwordx4 v9, s[20:23], s65 offen offset:1024 sc1 lds
    buffer_load_dwordx4 v9, s[20:23], s65 offen offset:2048 sc1 lds
    buffer_load_dwordx4 v9, s[20:23], s65 offen offset:3072 sc1 lds
    s_add_u32 m0, s61, 36864
    s_add_u32 s65, s60, 4096
    s_add_u32 s67, s61, 40960
    s_waitcnt vmcnt(8)
    s_barrier
    buffer_load_dwordx4 v9, s[20:23], s60 offen offset:0 sc1 lds
    buffer_load_dwordx4 v9, s[20:23], s60 offen offset:1024 sc1 lds
    buffer_load_dwordx4 v9, s[20:23], s60 offen offset:2048 sc1 lds
    buffer_load_dwordx4 v9, s[20:23], s60 offen offset:3072 sc1 lds
    s_mov_b32 m0, s67
    s_add_u32 s60, s60, 16384
    buffer_load_dwordx4 v9, s[20:23], s65 offen offset:0 sc1 lds
    buffer_load_dwordx4 v9, s[20:23], s65 offen offset:1024 sc1 lds
    buffer_load_dwordx4 v9, s[20:23], s65 offen offset:2048 sc1 lds
    buffer_load_dwordx4 v9, s[20:23], s65 offen offset:3072 sc1 lds
    buffer_load_dword v28, v24, s[20:23], 0 offen sc1
    s_add_u32 m0, s61, 71680
    s_add_u32 s65, s60, 4096
    s_add_u32 s67, s61, 75776
    s_waitcnt vmcnt(9)
    s_barrier
    buffer_load_dwordx4 v9, s[20:23], s60 offen offset:0 sc1 lds
    buffer_load_dwordx4 v9, s[20:23], s60 offen offset:1024 sc1 lds
    buffer_load_dwordx4 v9, s[20:23], s60 offen offset:2048 sc1 lds
    buffer_load_dwordx4 v9, s[20:23], s60 offen offset:3072 sc1 lds
    s_mov_b32 m0, s67
    s_add_u32 s60, s60, 16384
    buffer_load_dwordx4 v9, s[20:23], s65 offen offset:0 sc1 lds
    buffer_load_dwordx4 v9, s[20:23], s65 offen offset:1024 sc1 lds
    buffer_load_dwordx4 v9, s[20:23], s65 offen offset:2048 sc1 lds
    buffer_load_dwordx4 v9, s[20:23], s65 offen offset:3072 sc1 lds
    s_waitcnt vmcnt(8)
    s_mov_b32 s59, 0
    s_branch POLLC_64
POLL_62:
    buffer_load_dword v28, v24, s[20:23], 0 offen sc1
    s_waitcnt vmcnt(0)
POLLC_64:
    v_cmp_lt_u32 vcc, v28, v25
    s_add_u32 s59, s59, 1
    s_cbranch_vccz POLLD_63
    s_sleep 1
    s_cmp_lt_u32 s59, 2000000
    s_cbranch_scc1 POLL_62
POLLD_63:
    v_add_u32 v24, 256, v24
    s_add_u32 m0, s61, 106496
    s_add_u32 s65, s60, 4096
    s_add_u32 s67, s61, 110592
    s_barrier
    buffer_load_dwordx4 v9, s[20:23], s60 offen offset:0 sc1 lds
    buffer_load_dwordx4 v9, s[20:23], s60 offen offset:1024 sc1 lds
    buffer_load_dwordx4 v9, s[20:23], s60 offen offset:2048 sc1 lds
    buffer_load_dwordx4 v9, s[20:23], s60 offen offset:3072 sc1 lds
    s_mov_b32 m0, s67
    s_add_u32 s60, s60, 16384
    buffer_load_dwordx4 v9, s[20:23], s65 offen offset:0 sc1 lds
    buffer_load_dwordx4 v9, s[20:23], s65 offen offset:1024 sc1 lds
    buffer_load_dwordx4 v9, s[20:23], s65 offen offset:2048 sc1 lds
    buffer_load_dwordx4 v9, s[20:23], s65 offen offset:3072 sc1 lds
    s_add_u32 m0, s61, 0
    s_add_u32 s65, s60, 4096
    s_add_u32 s67, s61, 4096
    buffer_load_dword v22, v20, s[20:23], 0 offen sc1
    s_waitcnt vmcnt(9)
    s_barrier
    buffer_load_dwordx4 v9, s[20:23], s60 offen offset:0 sc1 lds
    buffer_load_dwordx4 v9, s[20:23], s60 offen offset:1024 sc1 lds
    buffer_load_dwordx4 v9, s[20:23], s60 offen offset:2048 sc1 lds
    buffer_load_dwordx4 v9, s[20:23], s60 offen offset:3072 sc1 lds
    s_mov_b32 m0, s67
    s_add_u32 s60, s60, 16384
    buffer_load_dwordx4 v9, s[20:23], s65 offen offset:0 sc1 lds
    buffer_load_dwordx4 v9, s[20:23], s65 offen offset:1024 sc1 lds
    buffer_load_dwordx4 v9, s[20:23], s65 offen offset:2048 sc1 lds
    buffer_load_dwordx4 v9, s[20:23], s65 offen offset:3072 sc1 lds
    s_add_u32 m0, s61, 36864
    s_add_u32 s65, s60, 4096
    s_add_u32 s67, s61, 40960
    buffer_load_dword v40, v5, s[20:23], s42 offen offset:0 sc1
    s_waitcnt vmcnt(10)
    s_barrier
    buffer_load_dwordx4 v9, s[20:23], s60 offen offset:0 sc1 lds
    buffer_load_dwordx4 v9, s[20:23], s60 offen offset:1024 sc1 lds
    buffer_load_dwordx4 v9, s[20:23], s60 offen offset:2048 sc1 lds
    buffer_load_dwordx4 v9, s[20:23], s60 offen offset:3072 sc1 lds
    s_mov_b32 m0, s67
    s_add_u32 s60, s60, 16384
    buffer_load_dwordx4 v9, s[20:23], s65 offen offset:0 sc1 lds
    buffer_load_dwordx4 v9, s[20:23], s65 offen offset:1024 sc1 lds
    buffer_load_dwordx4 v9, s[20:23], s65 offen offset:2048 sc1 lds
    buffer_load_dwordx4 v9, s[20:23], s65 offen offset:3072 sc1 lds
    s_add_u32 m0, s61, 71680
    s_add_u32 s65, s60, 4096
    s_add_u32 s67, s61, 75776
    buffer_load_dword v41, v5, s[20:23], s42 offen offset:128 sc1
    s_waitcnt vmcnt(10)
    s_barrier
    buffer_load_dwordx4 v9, s[20:23], s60 offen offset:0 sc1 lds
    buffer_load_dwordx4 v9, s[20:23], s60 offen offset:1024 sc1 lds
    buffer_load_dwordx4 v9, s[20:23], s60 offen offset:2048 sc1 lds
    buffer_load_dwordx4 v9, s[20:23], s60 offen offset:3072 sc1 lds
    s_mov_b32 m0, s67
    s_add_u32 s60, s60, 16384
    buffer_load_dwordx4 v9, s[20:23], s65 offen offset:0 sc1 lds
    buffer_load_dwordx4 v9, s[20:23], s65 offen offset:1024 sc1 lds
    buffer_load_dwordx4 v9, s[20:23], s65 offen offset:2048 sc1 lds
    buffer_load_dwordx4 v9, s[20:23], s65 offen offset:3072 sc1 lds
    s_add_u32 m0, s61, 106496
    s_add_u32 s65, s60, 4096
    s_add_u32 s67, s61, 110592
    buffer_load_dword v42, v5, s[20:23], s42 offen offset:256 sc1
    s_waitcnt vmcnt(10)
    s_barrier
    buffer_load_dwordx4 v9, s[20:23], s60 offen offset:0 sc1 lds
    buffer_load_dwordx4 v9, s[20:23], s60 offen offset:1024 sc1 lds
    buffer_load_dwordx4 v9, s[20:23], s60 offen offset:2048 sc1 lds
    buffer_load_dwordx4 v9, s[20:23], s60 offen offset:3072 sc1 lds
    s_mov_b32 m0, s67
    s_add_u32 s60, s60, 16384
    buffer_load_dwordx4 v9, s[20:23], s65 offen offset:0 sc1 lds
    buffer_load_dwordx4 v9, s[20:23], s65 offen offset:1024 sc1 lds
    buffer_load_dwordx4 v9, s[20:23], s65 offen offset:2048 sc1 lds
    buffer_load_dwordx4 v9, s[20:23], s65 offen offset:3072 sc1 lds
    buffer_load_dword v28, v24, s[20:23], 0 offen sc1
    s_add_u32 m0, s61, 0
    s_add_u32 s65, s60, 4096
    s_add_u32 s67, s61, 4096
    buffer_load_dword v43, v5, s[20:23], s42 offen offset:384 sc1
    s_waitcnt vmcnt(11)
    s_barrier
    buffer_load_dwordx4 v9, s[20:23], s60 offen offset:0 sc1 lds
    buffer_load_dwordx4 v9, s[20:23], s60 offen offset:1024 sc1 lds
    buffer_load_dwordx4 v9, s[20:23], s60 offen offset:2048 sc1 lds
    buffer_load_dwordx4 v9, s[20:23], s60 offen offset:3072 sc1 lds
    s_mov_b32 m0, s67
    s_add_u32 s60, s60, 16384
    buffer_load_dwordx4 v9, s[20:23], s65 offen offset:0 sc1 lds
    buffer_load_dwordx4 v9, s[20:23], s65 offen offset:1024 sc1 lds
    buffer_load_dwordx4 v9, s[20:23], s65 offen offset:2048 sc1 lds
    buffer_load_dwordx4 v9, s[20:23], s65 offen offset:3072 sc1 lds
    s_waitcnt vmcnt(9)
    s_mov_b32 s59, 0
    s_branch POLLC_67
POLL_65:
    buffer_load_dword v28, v24, s[20:23], 0 offen sc1
    s_waitcnt vmcnt(0)
POLLC_67:
    v_cmp_lt_u32 vcc, v28, v25
    s_add_u32 s59, s59, 1
    s_cbranch_vccz POLLD_66
    s_sleep 1
    s_cmp_lt_u32 s59, 2000000
    s_cbranch_scc1 POLL_65
POLLD_66:
    v_add_u32 v24, 256, v24
    s_add_u32 m0, s61, 36864
    s_add_u32 s65, s60, 4096
    s_add_u32 s67, s61, 40960
    s_barrier
    buffer_load_dwordx4 v9, s[20:23], s60 offen offset:0 sc1 lds
    buffer_load_dwordx4 v9, s[20:23], s60 offen offset:1024 sc1 lds
    buffer_load_dwordx4 v9, s[20:23], s60 offen offset:2048 sc1 lds
    buffer_load_dwordx4 v9, s[20:23], s60 offen offset:3072 sc1 lds
    s_mov_b32 m0, s67
    s_add_u32 s60, s60, 16384
    buffer_load_dwordx4 v9, s[20:23], s65 offen offset:0 sc1 lds
    buffer_load_dwordx4 v9, s[20:23], s65 offen offset:1024 sc1 lds
    buffer_load_dwordx4 v9, s[20:23], s65 offen offset:2048 sc1 lds
    buffer_load_dwordx4 v9, s[20:23], s65 offen offset:3072 sc1 lds
    s_add_u32 m0, s61, 71680
    s_add_u32 s65, s60, 4096
    s_add_u32 s67, s61, 75776
    buffer_load_dword v44, v5, s[20:23], s42 offen offset:512 sc1
    s_waitcnt vmcnt(9)
    s_barrier
    buffer_load_dwordx4 v9, s[20:23], s60 offen offset:0 sc1 lds
    buffer_load_dwordx4 v9, s[20:23], s60 offen offset:1024 sc1 lds
    buffer_load_dwordx4 v9, s[20:23], s60 offen offset:2048 sc1 lds
    buffer_load_dwordx4 v9, s[20:23], s60 offen offset:3072 sc1 lds
    s_mov_b32 m0, s67
    s_add_u32 s60, s60, 16384
    buffer_load_dwordx4 v9, s[20:23], s65 offen offset:0 sc1 lds
    buffer_load_dwordx4 v9, s[20:23], s65 offen offset:1024 sc1 lds
    buffer_load_dwordx4 v9, s[20:23], s65 offen offset:2048 sc1 lds
    buffer_load_dwordx4 v9, s[20:23], s65 offen offset:3072 sc1 lds
    s_add_u32 m0, s61, 106496
    s_add_u32 s65, s60, 4096
    s_add_u32 s67, s61, 110592
    buffer_load_dword v45, v5, s[20:23], s42 offen offset:640 sc1
    s_waitcnt vmcnt(10)
    s_barrier
    buffer_load_dwordx4 v9, s[20:23], s60 offen offset:0 sc1 lds
    buffer_load_dwordx4 v9, s[20:23], s60 offen offset:1024 sc1 lds
    buffer_load_dwordx4 v9, s[20:23], s60 offen offset:2048 sc1 lds
    buffer_load_dwordx4 v9, s[20:23], s60 offen offset:3072 sc1 lds
    s_mov_b32 m0, s67
    s_add_u32 s60, s60, 16384
    buffer_load_dwordx4 v9, s[20:23], s65 offen offset:0 sc1 lds
    buffer_load_dwordx4 v9, s[20:23], s65 offen offset:1024 sc1 lds
    buffer_load_dwordx4 v9, s[20:23], s65 offen offset:2048 sc1 lds
    buffer_load_dwordx4 v9, s[20:23], s65 offen offset:3072 sc1 lds
    s_add_u32 m0, s61, 0
    s_add_u32 s65, s60, 4096
    s_add_u32 s67, s61, 4096
    buffer_load_dword v46, v5, s[20:23], s42 offen offset:768 sc1
    s_waitcnt vmcnt(10)
    s_barrier
    buffer_load_dwordx4 v9, s[20:23], s60 offen offset:0 sc1 lds
    buffer_load_dwordx4 v9, s[20:23], s60 offen offset:1024 sc1 lds
    buffer_load_dwordx4 v9, s[20:23], s60 offen offset:2048 sc1 lds
    buffer_load_dwordx4 v9, s[20:23], s60 offen offset:3072 sc1 lds
    s_mov_b32 m0, s67
    s_add_u32 s60, s60, 16384
    buffer_load_dwordx4 v9, s[20:23], s65 offen offset:0 sc1 lds
    buffer_load_dwordx4 v9, s[20:23], s65 offen offset:1024 sc1 lds
    buffer_load_dwordx4 v9, s[20:23], s65 offen offset:2048 sc1 lds
    buffer_load_dwordx4 v9, s[20:23], s65 offen offset:3072 sc1 lds
    s_add_u32 m0, s61, 36864
    s_add_u32 s65, s60, 4096
    s_add_u32 s67, s61, 40960
    buffer_load_dword v47, v5, s[20:23], s42 offen offset:896 sc1
    s_waitcnt vmcnt(10)
    s_barrier
    buffer_load_dwordx4 v9, s[20:23], s60 offen offset:0 sc1 lds
    buffer_load_dwordx4 v9, s[20:23], s60 offen offset:1024 sc1 lds
    buffer_load_dwordx4 v9, s[20:23], s60 offen offset:2048 sc1 lds
    buffer_load_dwordx4 v9, s[20:23], s60 offen offset:3072 sc1 lds
    s_mov_b32 m0, s67
    s_add_u32 s60, s60, 16384
    buffer_load_dwordx4 v9, s[20:23], s65 offen offset:0 sc1 lds
    buffer_load_dwordx4 v9, s[20:23], s65 offen offset:1024 sc1 lds
    buffer_load_dwordx4 v9, s[20:23], s65 offen offset:2048 sc1 lds
    buffer_load_dwordx4 v9, s[20:23], s65 offen offset:3072 sc1 lds
    s_add_u32 m0, s61, 71680
    s_add_u32 s65, s60, 4096
    s_add_u32 s67, s61, 75776
    buffer_load_dword v48, v5, s[20:23], s42 offen offset:1024 sc1
    s_waitcnt vmcnt(10)
    s_barrier
    buffer_load_dwordx4 v9, s[20:23], s60 offen offset:0 sc1 lds
    buffer_load_dwordx4 v9, s[20:23], s60 offen offset:1024 sc1 lds
    buffer_load_dwordx4 v9, s[20:23], s60 offen offset:2048 sc1 lds
    buffer_load_dwordx4 v9, s[20:23], s60 offen offset:3072 sc1 lds
    s_mov_b32 m0, s67
    s_add_u32 s60, s60, 16384
    buffer_load_dwordx4 v9, s[20:23], s65 offen offset:0 sc1 lds
    buffer_load_dwordx4 v9, s[20:23], s65 offen offset:1024 sc1 lds
    buffer_load_dwordx4 v9, s[20:23], s65 offen offset:2048 sc1 lds
    buffer_load_dwordx4 v9, s[20:23], s65 offen offset:3072 sc1 lds
    buffer_load_dword v49, v5, s[20:23], s42 offen offset:1152 sc1
    s_waitcnt vmcnt(10)
    s_barrier
    s_waitcnt vmcnt(1)
    s_barrier
    s_waitcnt vmcnt(0)
    s_cmp_eq_u32 s3, 6
    s_cbranch_scc0 SKIP_68
    s_mov_b32 s59, 0
    s_branch POLLC_71
POLL_69:
    buffer_load_dword v22, v20, s[20:23], 0 offen sc1
    s_waitcnt vmcnt(0)
POLLC_71:
    v_cmp_lt_u32 vcc, v22, v21
    s_add_u32 s59, s59, 1
    s_cbranch_vccz POLLD_70
    s_sleep 1
    s_cmp_lt_u32 s59, 2000000
    s_cbranch_scc1 POLL_69
POLLD_70:
    v_add_f32 v40, v40, v41
    v_add_f32 v40, v40, v42
    v_add_f32 v40, v40, v43
    v_add_f32 v40, v40, v44
    v_add_f32 v40, v40, v45
    v_add_f32 v40, v40, v46
    v_add_f32 v40, v40, v47
    v_add_f32 v40, v40, v48
    v_add_f32 v40, v40, v49
    v_mov_b32 v41, v40
    s_nop 1
    v_permlane32_swap_b32 v40, v41
    s_nop 0
    v_add_f32 v40, v40, v41
    v_mul_f32 v40, 0x3ae38e39, v40
    v_cvt_pk_bf16_f32 v40, v40, v40
    v_lshlrev_b32 v40, 16, v40
    v_add_f32 v40, 0x3727c5ac, v40
    v_cvt_pk_bf16_f32 v40, v40, v40
    v_lshlrev_b32 v40, 16, v40
    v_sqrt_f32 v40, v40
    s_nop 0
    v_cvt_pk_bf16_f32 v40, v40, v40
    v_lshlrev_b32 v40, 16, v40
    v_mul_f32 v40, v40, v40
    v_rcp_f32 v40, v40
    v_lshlrev_b32 v4, 2, v4
    v_add_u32 v4, 163584, v4
    ds_write_b32 v4, v40
SKIP_68:
    s_branch E_JOIN
E_CONS:
    v_add_u32 v11, 71680, v9
    s_lshl_b32 s36, s34, 11
    s_add_u32 s36, s36, 9216
    v_add_u32 v24, s36, v9
    v_add_u32 v25, 71680, v24
    s_lshl_b32 s42, s35, 2
    s_add_u32 s42, s42, s34
    s_mul_i32 s42, s42, 36864
    s_mul_i32 s43, s33, 4608
    s_add_u32 s42, s42, s43
    s_mul_i32 s43, s31, 2359296
    s_add_u32 s42, s42, s43
    s_add_u32 s42, s42, 33529856
    s_cmp_eq_u32 s34, s31
    s_cmov_b32 s42, 0x20000000
    s_add_u32 s44, s42, 4096
    v_lshrrev_b32 v7, 1, v4
    v_lshlrev_b32 v26, 8, v7
    v_lshl_add_u32 v26, v3, 4, v26
    v_and_b32 v7, 1, v4
    v_mul_u32_u24 v7, 18432, v7
    v_add_u32 v26, v7, v26
    ds_read_b128 v[176:179], v24 offset:36864
    ds_read_b128 v[180:183], v24 offset:37888
    ds_read_b128 v[104:107], v9 offset:36864
    ds_read_b128 v[108:111], v9 offset:37888
    ds_read_b128 v[112:115], v9 offset:38912
    ds_read_b128 v[116:119], v9 offset:39936
    ds_read_b128 v[120:123], v9 offset:40960
    ds_read_b128 v[124:127], v9 offset:41984
    ds_read_b128 v[128:131], v9 offset:43008
    ds_read_b128 v[132:135], v9 offset:44032
    ds_read_b128 v[136:139], v9 offset:45056
    s_waitcnt lgkmcnt(5)
    v_mfma_f32_16x16x32_bf16 v[32:35], v[104:107], v[176:179], 0
    ds_read_b128 v[184:187], v24 offset:54272
    v_mfma_f32_16x16x32_bf16 v[36:39], v[104:107], v[180:183], 0
    ds_read_b128 v[188:191], v24 offset:55296
    v_mfma_f32_16x16x32_bf16 v[40:43], v[108:111], v[176:179], 0
    ds_read_b128 v[140:143], v9 offset:54272
    v_mfma_f32_16x16x32_bf16 v[44:47], v[108:111], v[180:183], 0
    v_mfma_f32_16x16x32_bf16 v[48:51], v[112:115], v[176:179], 0
    ds_read_b128 v[144:147], v9 offset:55296
    v_mfma_f32_16x16x32_bf16 v[52:55], v[112:115], v[180:183], 0
    ds_read_b128 v[148:151], v9 offset:56320
    v_mfma_f32_16x16x32_bf16 v[56:59], v[116:119], v[176:179], 0
    ds_read_b128 v[152:155], v9 offset:57344
    v_mfma_f32_16x16x32_bf16 v[60:63], v[116:119], v[180:183], 0
    s_waitcnt lgkmcnt(6)
    v_mfma_f32_16x16x32_bf16 v[64:67], v[120:123], v[176:179], 0
    ds_read_b128 v[156:159], v9 offset:58368
    v_mfma_f32_16x16x32_bf16 v[68:71], v[120:123], v[180:183], 0
    ds_read_b128 v[160:163], v9 offset:59392
    v_mfma_f32_16x16x32_bf16 v[72:75], v[124:127], v[176:179], 0
    ds_read_b128 v[164:167], v9 offset:60416
    v_mfma_f32_16x16x32_bf16 v[76:79], v[124:127], v[180:183], 0
    v_mfma_f32_16x16x32_bf16 v[80:83], v[128:131], v[176:179], 0
    ds_read_b128 v[168:171], v9 offset:61440
    v_mfma_f32_16x16x32_bf16 v[84:87], v[128:131], v[180:183], 0
    ds_read_b128 v[172:175], v9 offset:62464
    v_mfma_f32_16x16x32_bf16 v[88:91], v[132:135], v[176:179], 0
    v_mfma_f32_16x16x32_bf16 v[92:95], v[132:135], v[180:183], 0
    v_mfma_f32_16x16x32_bf16 v[96:99], v[136:139], v[176:179], 0
    v_mfma_f32_16x16x32_bf16 v[100:103], v[136:139], v[180:183], 0
    s_waitcnt lgkmcnt(5)
    v_mfma_f32_16x16x32_bf16 v[32:35], v[140:143], v[184:187], v[32:35]
    v_mfma_f32_16x16x32_bf16 v[36:39], v[140:143], v[188:191], v[36:39]
    s_waitcnt lgkmcnt(0)
    s_barrier
    ds_read_b128 v[176:179], v25 offset:0
    v_mfma_f32_16x16x32_bf16 v[40:43], v[144:147], v[184:187], v[40:43]
    ds_read_b128 v[180:183], v25 offset:1024
    v_mfma_f32_16x16x32_bf16 v[44:47], v[144:147], v[188:191], v[44:47]
    ds_read_b128 v[104:107], v11 offset:0
    v_mfma_f32_16x16x32_bf16 v[48:51], v[148:151], v[184:187], v[48:51]
    ds_read_b128 v[108:111], v11 offset:1024
    v_mfma_f32_16x16x32_bf16 v[52:55], v[148:151], v[188:191], v[52:55]
    v_mfma_f32_16x16x32_bf16 v[56:59], v[152:155], v[184:187], v[56:59]
    ds_read_b128 v[112:115], v11 offset:2048
    v_mfma_f32_16x16x32_bf16 v[60:63], v[152:155], v[188:191], v[60:63]
    ds_read_b128 v[116:119], v11 offset:3072
    v_mfma_f32_16x16x32_bf16 v[64:67], v[156:159], v[184:187], v[64:67]
    ds_read_b128 v[120:123], v11 offset:4096
    v_mfma_f32_16x16x32_bf16 v[68:71], v[156:159], v[188:191], v[68:71]
    ds_read_b128 v[124:127], v11 offset:5120
    v_mfma_f32_16x16x32_bf16 v[72:75], v[160:163], v[184:187], v[72:75]
    v_mfma_f32_16x16x32_bf16 v[76:79], v[160:163], v[188:191], v[76:79]
    ds_read_b128 v[128:131], v11 offset:6144
    v_mfma_f32_16x16x32_bf16 v[80:83], v[164:167], v[184:187], v[80:83]
    ds_read_b128 v[132:135], v11 offset:7168
    v_mfma_f32_16x16x32_bf16 v[84:87], v[164:167], v[188:191], v[84:87]
    ds_read_b128 v[136:139], v11 offset:8192
    v_mfma_f32_16x16x32_bf16 v[88:91], v[168:171], v[184:187], v[88:91]
    v_mfma_f32_16x16x32_bf16 v[92:95], v[168:171], v[188:191], v[92:95]
    v_mfma_f32_16x16x32_bf16 v[96:99], v[172:175], v[184:187], v[96:99]
    v_mfma_f32_16x16x32_bf16 v[100:103], v[172:175], v[188:191], v[100:103]
    s_waitcnt lgkmcnt(5)
    v_mfma_f32_16x16x32_bf16 v[32:35], v[104:107], v[176:179], v[32:35]
    ds_read_b128 v[184:187], v25 offset:17408
    v_mfma_f32_16x16x32_bf16 v[36:39], v[104:107], v[180:183], v[36:39]
    ds_read_b128 v[188:191], v25 offset:18432
    v_mfma_f32_16x16x32_bf16 v[40:43], v[108:111], v[176:179], v[40:43]
    ds_read_b128 v[140:143], v11 offset:17408
    v_mfma_f32_16x16x32_bf16 v[44:47], v[108:111], v[180:183], v[44:47]
    v_mfma_f32_16x16x32_bf16 v[48:51], v[112:115], v[176:179], v[48:51]
    ds_read_b128 v[144:147], v11 offset:18432
    v_mfma_f32_16x16x32_bf16 v[52:55], v[112:115], v[180:183], v[52:55]
    ds_read_b128 v[148:151], v11 offset:19456
    v_mfma_f32_16x16x32_bf16 v[56:59], v[116:119], v[176:179], v[56:59]
    ds_read_b128 v[152:155], v11 offset:20480
    v_mfma_f32_16x16x32_bf16 v[60:63], v[116:119], v[180:183], v[60:63]
    s_waitcnt lgkmcnt(6)
    v_mfma_f32_16x16x32_bf16 v[64:67], v[120:123], v[176:179], v[64:67]
    ds_read_b128 v[156:159], v11 offset:21504
    v_mfma_f32_16x16x32_bf16 v[68:71], v[120:123], v[180:183], v[68:71]
    ds_read_b128 v[160:163], v11 offset:22528
    v_mfma_f32_16x16x32_bf16 v[72:75], v[124:127], v[176:179], v[72:75]
    ds_read_b128 v[164:167], v11 offset:23552
    v_mfma_f32_16x16x32_bf16 v[76:79], v[124:127], v[180:183], v[76:79]
    v_mfma_f32_16x16x32_bf16 v[80:83], v[128:131], v[176:179], v[80:83]
    ds_read_b128 v[168:171], v11 offset:24576
    v_mfma_f32_16x16x32_bf16 v[84:87], v[128:131], v[180:183], v[84:87]
    ds_read_b128 v[172:175], v11 offset:25600
    v_mfma_f32_16x16x32_bf16 v[88:91], v[132:135], v[176:179], v[88:91]
    v_mfma_f32_16x16x32_bf16 v[92:95], v[132:135], v[180:183], v[92:95]
    v_mfma_f32_16x16x32_bf16 v[96:99], v[136:139], v[176:179], v[96:99]
    v_mfma_f32_16x16x32_bf16 v[100:103], v[136:139], v[180:183], v[100:103]
    s_waitcnt lgkmcnt(5)
    v_mfma_f32_16x16x32_bf16 v[32:35], v[140:143], v[184:187], v[32:35]
    v_mfma_f32_16x16x32_bf16 v[36:39], v[140:143], v[188:191], v[36:39]
    s_waitcnt lgkmcnt(0)
    s_waitcnt vmcnt(0)
    s_barrier
    ds_read_b128 v[176:179], v25 offset:34816
    v_mfma_f32_16x16x32_bf16 v[40:43], v[144:147], v[184:187], v[40:43]
    ds_read_b128 v[180:183], v25 offset:35840
    v_mfma_f32_16x16x32_bf16 v[44:47], v[144:147], v[188:191], v[44:47]
    ds_read_b128 v[104:107], v11 offset:34816
    v_mfma_f32_16x16x32_bf16 v[48:51], v[148:151], v[184:187], v[48:51]
    ds_read_b128 v[108:111], v11 offset:35840
    v_mfma_f32_16x16x32_bf16 v[52:55], v[148:151], v[188:191], v[52:55]
    v_mfma_f32_16x16x32_bf16 v[56:59], v[152:155], v[184:187], v[56:59]
    ds_read_b128 v[112:115], v11 offset:36864
    v_mfma_f32_16x16x32_bf16 v[60:63], v[152:155], v[188:191], v[60:63]
    ds_read_b128 v[116:119], v11 offset:37888
    v_mfma_f32_16x16x32_bf16 v[64:67], v[156:159], v[184:187], v[64:67]
    ds_read_b128 v[120:123], v11 offset:38912
    v_mfma_f32_16x16x32_bf16 v[68:71], v[156:159], v[188:191], v[68:71]
    ds_read_b128 v[124:127], v11 offset:39936
    v_mfma_f32_16x16x32_bf16 v[72:75], v[160:163], v[184:187], v[72:75]
    v_mfma_f32_16x16x32_bf16 v[76:79], v[160:163], v[188:191], v[76:79]
    ds_read_b128 v[128:131], v11 offset:40960
    v_mfma_f32_16x16x32_bf16 v[80:83], v[164:167], v[184:187], v[80:83]
    ds_read_b128 v[132:135], v11 offset:41984
    v_mfma_f32_16x16x32_bf16 v[84:87], v[164:167], v[188:191], v[84:87]
    ds_read_b128 v[136:139], v11 offset:43008
    v_mfma_f32_16x16x32_bf16 v[88:91], v[168:171], v[184:187], v[88:91]
    v_mfma_f32_16x16x32_bf16 v[92:95], v[168:171], v[188:191], v[92:95]
    v_mfma_f32_16x16x32_bf16 v[96:99], v[172:175], v[184:187], v[96:99]
    v_mfma_f32_16x16x32_bf16 v[100:103], v[172:175], v[188:191], v[100:103]
    s_waitcnt lgkmcnt(5)
    v_mfma_f32_16x16x32_bf16 v[32:35], v[104:107], v[176:179], v[32:35]
    ds_read_b128 v[184:187], v25 offset:52224
    v_mfma_f32_16x16x32_bf16 v[36:39], v[104:107], v[180:183], v[36:39]
    ds_read_b128 v[188:191], v25 offset:53248
    v_mfma_f32_16x16x32_bf16 v[40:43], v[108:111], v[176:179], v[40:43]
    ds_read_b128 v[140:143], v11 offset:52224
    v_mfma_f32_16x16x32_bf16 v[44:47], v[108:111], v[180:183], v[44:47]
    v_mfma_f32_16x16x32_bf16 v[48:51], v[112:115], v[176:179], v[48:51]
    ds_read_b128 v[144:147], v11 offset:53248
    v_mfma_f32_16x16x32_bf16 v[52:55], v[112:115], v[180:183], v[52:55]
    ds_read_b128 v[148:151], v11 offset:54272
    v_mfma_f32_16x16x32_bf16 v[56:59], v[116:119], v[176:179], v[56:59]
    ds_read_b128 v[152:155], v11 offset:55296
    v_mfma_f32_16x16x32_bf16 v[60:63], v[116:119], v[180:183], v[60:63]
    s_waitcnt lgkmcnt(6)
    v_mfma_f32_16x16x32_bf16 v[64:67], v[120:123], v[176:179], v[64:67]
    ds_read_b128 v[156:159], v11 offset:56320
    v_mfma_f32_16x16x32_bf16 v[68:71], v[120:123], v[180:183], v[68:71]
    ds_read_b128 v[160:163], v11 offset:57344
    v_mfma_f32_16x16x32_bf16 v[72:75], v[124:127], v[176:179], v[72:75]
    ds_read_b128 v[164:167], v11 offset:58368
    v_mfma_f32_16x16x32_bf16 v[76:79], v[124:127], v[180:183], v[76:79]
    v_mfma_f32_16x16x32_bf16 v[80:83], v[128:131], v[176:179], v[80:83]
    ds_read_b128 v[168:171], v11 offset:59392
    v_mfma_f32_16x16x32_bf16 v[84:87], v[128:131], v[180:183], v[84:87]
    ds_read_b128 v[172:175], v11 offset:60416
    v_mfma_f32_16x16x32_bf16 v[88:91], v[132:135], v[176:179], v[88:91]
    v_mfma_f32_16x16x32_bf16 v[92:95], v[132:135], v[180:183], v[92:95]
    v_mfma_f32_16x16x32_bf16 v[96:99], v[136:139], v[176:179], v[96:99]
    v_mfma_f32_16x16x32_bf16 v[100:103], v[136:139], v[180:183], v[100:103]
    s_waitcnt lgkmcnt(5)
    v_mfma_f32_16x16x32_bf16 v[32:35], v[140:143], v[184:187], v[32:35]
    v_mfma_f32_16x16x32_bf16 v[36:39], v[140:143], v[188:191], v[36:39]
    s_waitcnt lgkmcnt(0)
    s_barrier
    ds_read_b128 v[176:179], v24 offset:0
    v_mfma_f32_16x16x32_bf16 v[40:43], v[144:147], v[184:187], v[40:43]
    ds_read_b128 v[180:183], v24 offset:1024
    v_mfma_f32_16x16x32_bf16 v[44:47], v[144:147], v[188:191], v[44:47]
    ds_read_b128 v[104:107], v9 offset:0
    v_mfma_f32_16x16x32_bf16 v[48:51], v[148:151], v[184:187], v[48:51]
    ds_read_b128 v[108:111], v9 offset:1024
    v_mfma_f32_16x16x32_bf16 v[52:55], v[148:151], v[188:191], v[52:55]
    v_mfma_f32_16x16x32_bf16 v[56:59], v[152:155], v[184:187], v[56:59]
    ds_read_b128 v[112:115], v9 offset:2048
    v_mfma_f32_16x16x32_bf16 v[60:63], v[152:155], v[188:191], v[60:63]
    ds_read_b128 v[116:119], v9 offset:3072
    v_mfma_f32_16x16x32_bf16 v[64:67], v[156:159], v[184:187], v[64:67]
    ds_read_b128 v[120:123], v9 offset:4096
    v_mfma_f32_16x16x32_bf16 v[68:71], v[156:159], v[188:191], v[68:71]
    ds_read_b128 v[124:127], v9 offset:5120
    v_mfma_f32_16x16x32_bf16 v[72:75], v[160:163], v[184:187], v[72:75]
    v_mfma_f32_16x16x32_bf16 v[76:79], v[160:163], v[188:191], v[76:79]
    ds_read_b128 v[128:131], v9 offset:6144
    v_mfma_f32_16x16x32_bf16 v[80:83], v[164:167], v[184:187], v[80:83]
    ds_read_b128 v[132:135], v9 offset:7168
    v_mfma_f32_16x16x32_bf16 v[84:87], v[164:167], v[188:191], v[84:87]
    ds_read_b128 v[136:139], v9 offset:8192
    v_mfma_f32_16x16x32_bf16 v[88:91], v[168:171], v[184:187], v[88:91]
    v_mfma_f32_16x16x32_bf16 v[92:95], v[168:171], v[188:191], v[92:95]
    v_mfma_f32_16x16x32_bf16 v[96:99], v[172:175], v[184:187], v[96:99]
    v_mfma_f32_16x16x32_bf16 v[100:103], v[172:175], v[188:191], v[100:103]
    s_waitcnt lgkmcnt(5)
    v_mfma_f32_16x16x32_bf16 v[32:35], v[104:107], v[176:179], v[32:35]
    ds_read_b128 v[184:187], v24 offset:17408
    v_mfma_f32_16x16x32_bf16 v[36:39], v[104:107], v[180:183], v[36:39]
    ds_read_b128 v[188:191], v24 offset:18432
    v_mfma_f32_16x16x32_bf16 v[40:43], v[108:111], v[176:179], v[40:43]
    ds_read_b128 v[140:143], v9 offset:17408
    v_mfma_f32_16x16x32_bf16 v[44:47], v[108:111], v[180:183], v[44:47]
    v_mfma_f32_16x16x32_bf16 v[48:51], v[112:115], v[176:179], v[48:51]
    ds_read_b128 v[144:147], v9 offset:18432
    v_mfma_f32_16x16x32_bf16 v[52:55], v[112:115], v[180:183], v[52:55]
    ds_read_b128 v[148:151], v9 offset:19456
    v_mfma_f32_16x16x32_bf16 v[56:59], v[116:119], v[176:179], v[56:59]
    ds_read_b128 v[152:155], v9 offset:20480
    v_mfma_f32_16x16x32_bf16 v[60:63], v[116:119], v[180:183], v[60:63]
    s_waitcnt lgkmcnt(6)
    v_mfma_f32_16x16x32_bf16 v[64:67], v[120:123], v[176:179], v[64:67]
    ds_read_b128 v[156:159], v9 offset:21504
    v_mfma_f32_16x16x32_bf16 v[68:71], v[120:123], v[180:183], v[68:71]
    ds_read_b128 v[160:163], v9 offset:22528
    v_mfma_f32_16x16x32_bf16 v[72:75], v[124:127], v[176:179], v[72:75]
    ds_read_b128 v[164:167], v9 offset:23552
    v_mfma_f32_16x16x32_bf16 v[76:79], v[124:127], v[180:183], v[76:79]
    v_mfma_f32_16x16x32_bf16 v[80:83], v[128:131], v[176:179], v[80:83]
    ds_read_b128 v[168:171], v9 offset:24576
    v_mfma_f32_16x16x32_bf16 v[84:87], v[128:131], v[180:183], v[84:87]
    ds_read_b128 v[172:175], v9 offset:25600
    v_mfma_f32_16x16x32_bf16 v[88:91], v[132:135], v[176:179], v[88:91]
    v_mfma_f32_16x16x32_bf16 v[92:95], v[132:135], v[180:183], v[92:95]
    v_mfma_f32_16x16x32_bf16 v[96:99], v[136:139], v[176:179], v[96:99]
    v_mfma_f32_16x16x32_bf16 v[100:103], v[136:139], v[180:183], v[100:103]
    s_waitcnt lgkmcnt(5)
    v_mfma_f32_16x16x32_bf16 v[32:35], v[140:143], v[184:187], v[32:35]
    v_mfma_f32_16x16x32_bf16 v[36:39], v[140:143], v[188:191], v[36:39]
    s_waitcnt lgkmcnt(0)
    s_barrier
    ds_read_b128 v[176:179], v24 offset:36864
    v_mfma_f32_16x16x32_bf16 v[40:43], v[144:147], v[184:187], v[40:43]
    ds_read_b128 v[180:183], v24 offset:37888
    v_mfma_f32_16x16x32_bf16 v[44:47], v[144:147], v[188:191], v[44:47]
    ds_read_b128 v[104:107], v9 offset:36864
    v_mfma_f32_16x16x32_bf16 v[48:51], v[148:151], v[184:187], v[48:51]
    ds_read_b128 v[108:111], v9 offset:37888
    v_mfma_f32_16x16x32_bf16 v[52:55], v[148:151], v[188:191], v[52:55]
    v_mfma_f32_16x16x32_bf16 v[56:59], v[152:155], v[184:187], v[56:59]
    ds_read_b128 v[112:115], v9 offset:38912
    v_mfma_f32_16x16x32_bf16 v[60:63], v[152:155], v[188:191], v[60:63]
    ds_read_b128 v[116:119], v9 offset:39936
    v_mfma_f32_16x16x32_bf16 v[64:67], v[156:159], v[184:187], v[64:67]
    ds_read_b128 v[120:123], v9 offset:40960
    v_mfma_f32_16x16x32_bf16 v[68:71], v[156:159], v[188:191], v[68:71]
    ds_read_b128 v[124:127], v9 offset:41984
    v_mfma_f32_16x16x32_bf16 v[72:75], v[160:163], v[184:187], v[72:75]
    v_mfma_f32_16x16x32_bf16 v[76:79], v[160:163], v[188:191], v[76:79]
    ds_read_b128 v[128:131], v9 offset:43008
    v_mfma_f32_16x16x32_bf16 v[80:83], v[164:167], v[184:187], v[80:83]
    ds_read_b128 v[132:135], v9 offset:44032
    v_mfma_f32_16x16x32_bf16 v[84:87], v[164:167], v[188:191], v[84:87]
    ds_read_b128 v[136:139], v9 offset:45056
    v_mfma_f32_16x16x32_bf16 v[88:91], v[168:171], v[184:187], v[88:91]
    v_mfma_f32_16x16x32_bf16 v[92:95], v[168:171], v[188:191], v[92:95]
    v_mfma_f32_16x16x32_bf16 v[96:99], v[172:175], v[184:187], v[96:99]
    v_mfma_f32_16x16x32_bf16 v[100:103], v[172:175], v[188:191], v[100:103]
    s_waitcnt lgkmcnt(5)
    v_mfma_f32_16x16x32_bf16 v[32:35], v[104:107], v[176:179], v[32:35]
    ds_read_b128 v[184:187], v24 offset:54272
    v_mfma_f32_16x16x32_bf16 v[36:39], v[104:107], v[180:183], v[36:39]
    ds_read_b128 v[188:191], v24 offset:55296
    v_mfma_f32_16x16x32_bf16 v[40:43], v[108:111], v[176:179], v[40:43]
    ds_read_b128 v[140:143], v9 offset:54272
    v_mfma_f32_16x16x32_bf16 v[44:47], v[108:111], v[180:183], v[44:47]
    v_mfma_f32_16x16x32_bf16 v[48:51], v[112:115], v[176:179], v[48:51]
    ds_read_b128 v[144:147], v9 offset:55296
    v_mfma_f32_16x16x32_bf16 v[52:55], v[112:115], v[180:183], v[52:55]
    ds_read_b128 v[148:151], v9 offset:56320
    v_mfma_f32_16x16x32_bf16 v[56:59], v[116:119], v[176:179], v[56:59]
    ds_read_b128 v[152:155], v9 offset:57344
    v_mfma_f32_16x16x32_bf16 v[60:63], v[116:119], v[180:183], v[60:63]
    s_waitcnt lgkmcnt(6)
    v_mfma_f32_16x16x32_bf16 v[64:67], v[120:123], v[176:179], v[64:67]
    ds_read_b128 v[156:159], v9 offset:58368
    v_mfma_f32_16x16x32_bf16 v[68:71], v[120:123], v[180:183], v[68:71]
    ds_read_b128 v[160:163], v9 offset:59392
    v_mfma_f32_16x16x32_bf16 v[72:75], v[124:127], v[176:179], v[72:75]
    ds_read_b128 v[164:167], v9 offset:60416
    v_mfma_f32_16x16x32_bf16 v[76:79], v[124:127], v[180:183], v[76:79]
    v_mfma_f32_16x16x32_bf16 v[80:83], v[128:131], v[176:179], v[80:83]
    ds_read_b128 v[168:171], v9 offset:61440
    v_mfma_f32_16x16x32_bf16 v[84:87], v[128:131], v[180:183], v[84:87]
    ds_read_b128 v[172:175], v9 offset:62464
    v_mfma_f32_16x16x32_bf16 v[88:91], v[132:135], v[176:179], v[88:91]
    v_mfma_f32_16x16x32_bf16 v[92:95], v[132:135], v[180:183], v[92:95]
    v_mfma_f32_16x16x32_bf16 v[96:99], v[136:139], v[176:179], v[96:99]
    v_mfma_f32_16x16x32_bf16 v[100:103], v[136:139], v[180:183], v[100:103]
    s_waitcnt lgkmcnt(5)
    v_mfma_f32_16x16x32_bf16 v[32:35], v[140:143], v[184:187], v[32:35]
    v_mfma_f32_16x16x32_bf16 v[36:39], v[140:143], v[188:191], v[36:39]
    s_waitcnt lgkmcnt(0)
    s_barrier
    ds_read_b128 v[176:179], v25 offset:0
    v_mfma_f32_16x16x32_bf16 v[40:43], v[144:147], v[184:187], v[40:43]
    ds_read_b128 v[180:183], v25 offset:1024
    v_mfma_f32_16x16x32_bf16 v[44:47], v[144:147], v[188:191], v[44:47]
    ds_read_b128 v[104:107], v11 offset:0
    v_mfma_f32_16x16x32_bf16 v[48:51], v[148:151], v[184:187], v[48:51]
    ds_read_b128 v[108:111], v11 offset:1024
    v_mfma_f32_16x16x32_bf16 v[52:55], v[148:151], v[188:191], v[52:55]
    v_mfma_f32_16x16x32_bf16 v[56:59], v[152:155], v[184:187], v[56:59]
    ds_read_b128 v[112:115], v11 offset:2048
    v_mfma_f32_16x16x32_bf16 v[60:63], v[152:155], v[188:191], v[60:63]
    ds_read_b128 v[116:119], v11 offset:3072
    v_mfma_f32_16x16x32_bf16 v[64:67], v[156:159], v[184:187], v[64:67]
    ds_read_b128 v[120:123], v11 offset:4096
    v_mfma_f32_16x16x32_bf16 v[68:71], v[156:159], v[188:191], v[68:71]
    ds_read_b128 v[124:127], v11 offset:5120
    v_mfma_f32_16x16x32_bf16 v[72:75], v[160:163], v[184:187], v[72:75]
    v_mfma_f32_16x16x32_bf16 v[76:79], v[160:163], v[188:191], v[76:79]
    ds_read_b128 v[128:131], v11 offset:6144
    v_mfma_f32_16x16x32_bf16 v[80:83], v[164:167], v[184:187], v[80:83]
    ds_read_b128 v[132:135], v11 offset:7168
    v_mfma_f32_16x16x32_bf16 v[84:87], v[164:167], v[188:191], v[84:87]
    ds_read_b128 v[136:139], v11 offset:8192
    v_mfma_f32_16x16x32_bf16 v[88:91], v[168:171], v[184:187], v[88:91]
    v_mfma_f32_16x16x32_bf16 v[92:95], v[168:171], v[188:191], v[92:95]
    v_mfma_f32_16x16x32_bf16 v[96:99], v[172:175], v[184:187], v[96:99]
    v_mfma_f32_16x16x32_bf16 v[100:103], v[172:175], v[188:191], v[100:103]
    s_waitcnt lgkmcnt(5)
    v_mfma_f32_16x16x32_bf16 v[32:35], v[104:107], v[176:179], v[32:35]
    ds_read_b128 v[184:187], v25 offset:17408
    v_mfma_f32_16x16x32_bf16 v[36:39], v[104:107], v[180:183], v[36:39]
    ds_read_b128 v[188:191], v25 offset:18432
    v_mfma_f32_16x16x32_bf16 v[40:43], v[108:111], v[176:179], v[40:43]
    ds_read_b128 v[140:143], v11 offset:17408
    v_mfma_f32_16x16x32_bf16 v[44:47], v[108:111], v[180:183], v[44:47]
    v_mfma_f32_16x16x32_bf16 v[48:51], v[112:115], v[176:179], v[48:51]
    ds_read_b128 v[144:147], v11 offset:18432
    v_mfma_f32_16x16x32_bf16 v[52:55], v[112:115], v[180:183], v[52:55]
    ds_read_b128 v[148:151], v11 offset:19456
    v_mfma_f32_16x16x32_bf16 v[56:59], v[116:119], v[176:179], v[56:59]
    ds_read_b128 v[152:155], v11 offset:20480
    v_mfma_f32_16x16x32_bf16 v[60:63], v[116:119], v[180:183], v[60:63]
    s_waitcnt lgkmcnt(6)
    v_mfma_f32_16x16x32_bf16 v[64:67], v[120:123], v[176:179], v[64:67]
    ds_read_b128 v[156:159], v11 offset:21504
    v_mfma_f32_16x16x32_bf16 v[68:71], v[120:123], v[180:183], v[68:71]
    ds_read_b128 v[160:163], v11 offset:22528
    v_mfma_f32_16x16x32_bf16 v[72:75], v[124:127], v[176:179], v[72:75]
    ds_read_b128 v[164:167], v11 offset:23552
    v_mfma_f32_16x16x32_bf16 v[76:79], v[124:127], v[180:183], v[76:79]
    v_mfma_f32_16x16x32_bf16 v[80:83], v[128:131], v[176:179], v[80:83]
    ds_read_b128 v[168:171], v11 offset:24576
    v_mfma_f32_16x16x32_bf16 v[84:87], v[128:131], v[180:183], v[84:87]
    ds_read_b128 v[172:175], v11 offset:25600
    v_mfma_f32_16x16x32_bf16 v[88:91], v[132:135], v[176:179], v[88:91]
    v_mfma_f32_16x16x32_bf16 v[92:95], v[132:135], v[180:183], v[92:95]
    v_mfma_f32_16x16x32_bf16 v[96:99], v[136:139], v[176:179], v[96:99]
    v_mfma_f32_16x16x32_bf16 v[100:103], v[136:139], v[180:183], v[100:103]
    s_waitcnt lgkmcnt(5)
    v_mfma_f32_16x16x32_bf16 v[32:35], v[140:143], v[184:187], v[32:35]
    v_mfma_f32_16x16x32_bf16 v[36:39], v[140:143], v[188:191], v[36:39]
    s_waitcnt lgkmcnt(0)
    s_barrier
    ds_read_b128 v[176:179], v25 offset:34816
    v_mfma_f32_16x16x32_bf16 v[40:43], v[144:147], v[184:187], v[40:43]
    ds_read_b128 v[180:183], v25 offset:35840
    v_mfma_f32_16x16x32_bf16 v[44:47], v[144:147], v[188:191], v[44:47]
    ds_read_b128 v[104:107], v11 offset:34816
    v_mfma_f32_16x16x32_bf16 v[48:51], v[148:151], v[184:187], v[48:51]
    ds_read_b128 v[108:111], v11 offset:35840
    v_mfma_f32_16x16x32_bf16 v[52:55], v[148:151], v[188:191], v[52:55]
    v_mfma_f32_16x16x32_bf16 v[56:59], v[152:155], v[184:187], v[56:59]
    ds_read_b128 v[112:115], v11 offset:36864
    v_mfma_f32_16x16x32_bf16 v[60:63], v[152:155], v[188:191], v[60:63]
    ds_read_b128 v[116:119], v11 offset:37888
    v_mfma_f32_16x16x32_bf16 v[64:67], v[156:159], v[184:187], v[64:67]
    ds_read_b128 v[120:123], v11 offset:38912
    v_mfma_f32_16x16x32_bf16 v[68:71], v[156:159], v[188:191], v[68:71]
    ds_read_b128 v[124:127], v11 offset:39936
    v_mfma_f32_16x16x32_bf16 v[72:75], v[160:163], v[184:187], v[72:75]
    v_mfma_f32_16x16x32_bf16 v[76:79], v[160:163], v[188:191], v[76:79]
    ds_read_b128 v[128:131], v11 offset:40960
    v_mfma_f32_16x16x32_bf16 v[80:83], v[164:167], v[184:187], v[80:83]
    ds_read_b128 v[132:135], v11 offset:41984
    v_mfma_f32_16x16x32_bf16 v[84:87], v[164:167], v[188:191], v[84:87]
    ds_read_b128 v[136:139], v11 offset:43008
    v_mfma_f32_16x16x32_bf16 v[88:91], v[168:171], v[184:187], v[88:91]
    v_mfma_f32_16x16x32_bf16 v[92:95], v[168:171], v[188:191], v[92:95]
    v_mfma_f32_16x16x32_bf16 v[96:99], v[172:175], v[184:187], v[96:99]
    v_mfma_f32_16x16x32_bf16 v[100:103], v[172:175], v[188:191], v[100:103]
    s_waitcnt lgkmcnt(5)
    v_mfma_f32_16x16x32_bf16 v[32:35], v[104:107], v[176:179], v[32:35]
    ds_read_b128 v[184:187], v25 offset:52224
    v_mfma_f32_16x16x32_bf16 v[36:39], v[104:107], v[180:183], v[36:39]
    ds_read_b128 v[188:191], v25 offset:53248
    v_mfma_f32_16x16x32_bf16 v[40:43], v[108:111], v[176:179], v[40:43]
    ds_read_b128 v[140:143], v11 offset:52224
    v_mfma_f32_16x16x32_bf16 v[44:47], v[108:111], v[180:183], v[44:47]
    v_mfma_f32_16x16x32_bf16 v[48:51], v[112:115], v[176:179], v[48:51]
    ds_read_b128 v[144:147], v11 offset:53248
    v_mfma_f32_16x16x32_bf16 v[52:55], v[112:115], v[180:183], v[52:55]
    ds_read_b128 v[148:151], v11 offset:54272
    v_mfma_f32_16x16x32_bf16 v[56:59], v[116:119], v[176:179], v[56:59]
    ds_read_b128 v[152:155], v11 offset:55296
    v_mfma_f32_16x16x32_bf16 v[60:63], v[116:119], v[180:183], v[60:63]
    s_waitcnt lgkmcnt(6)
    v_mfma_f32_16x16x32_bf16 v[64:67], v[120:123], v[176:179], v[64:67]
    ds_read_b128 v[156:159], v11 offset:56320
    v_mfma_f32_16x16x32_bf16 v[68:71], v[120:123], v[180:183], v[68:71]
    ds_read_b128 v[160:163], v11 offset:57344
    v_mfma_f32_16x16x32_bf16 v[72:75], v[124:127], v[176:179], v[72:75]
    ds_read_b128 v[164:167], v11 offset:58368
    v_mfma_f32_16x16x32_bf16 v[76:79], v[124:127], v[180:183], v[76:79]
    v_mfma_f32_16x16x32_bf16 v[80:83], v[128:131], v[176:179], v[80:83]
    ds_read_b128 v[168:171], v11 offset:59392
    v_mfma_f32_16x16x32_bf16 v[84:87], v[128:131], v[180:183], v[84:87]
    ds_read_b128 v[172:175], v11 offset:60416
    v_mfma_f32_16x16x32_bf16 v[88:91], v[132:135], v[176:179], v[88:91]
    v_mfma_f32_16x16x32_bf16 v[92:95], v[132:135], v[180:183], v[92:95]
    v_mfma_f32_16x16x32_bf16 v[96:99], v[136:139], v[176:179], v[96:99]
    v_mfma_f32_16x16x32_bf16 v[100:103], v[136:139], v[180:183], v[100:103]
    s_waitcnt lgkmcnt(5)
    v_mfma_f32_16x16x32_bf16 v[32:35], v[140:143], v[184:187], v[32:35]
    v_mfma_f32_16x16x32_bf16 v[36:39], v[140:143], v[188:191], v[36:39]
    s_waitcnt lgkmcnt(0)
    s_barrier
    ds_read_b128 v[176:179], v24 offset:0
    v_mfma_f32_16x16x32_bf16 v[40:43], v[144:147], v[184:187], v[40:43]
    ds_read_b128 v[180:183], v24 offset:1024
    v_mfma_f32_16x16x32_bf16 v[44:47], v[144:147], v[188:191], v[44:47]
    ds_read_b128 v[104:107], v9 offset:0
    v_mfma_f32_16x16x32_bf16 v[48:51], v[148:151], v[184:187], v[48:51]
    ds_read_b128 v[108:111], v9 offset:1024
    v_mfma_f32_16x16x32_bf16 v[52:55], v[148:151], v[188:191], v[52:55]
    v_mfma_f32_16x16x32_bf16 v[56:59], v[152:155], v[184:187], v[56:59]
    ds_read_b128 v[112:115], v9 offset:2048
    v_mfma_f32_16x16x32_bf16 v[60:63], v[152:155], v[188:191], v[60:63]
    ds_read_b128 v[116:119], v9 offset:3072
    v_mfma_f32_16x16x32_bf16 v[64:67], v[156:159], v[184:187], v[64:67]
    ds_read_b128 v[120:123], v9 offset:4096
    v_mfma_f32_16x16x32_bf16 v[68:71], v[156:159], v[188:191], v[68:71]
    ds_read_b128 v[124:127], v9 offset:5120
    v_mfma_f32_16x16x32_bf16 v[72:75], v[160:163], v[184:187], v[72:75]
    v_mfma_f32_16x16x32_bf16 v[76:79], v[160:163], v[188:191], v[76:79]
    ds_read_b128 v[128:131], v9 offset:6144
    v_mfma_f32_16x16x32_bf16 v[80:83], v[164:167], v[184:187], v[80:83]
    ds_read_b128 v[132:135], v9 offset:7168
    v_mfma_f32_16x16x32_bf16 v[84:87], v[164:167], v[188:191], v[84:87]
    ds_read_b128 v[136:139], v9 offset:8192
    v_mfma_f32_16x16x32_bf16 v[88:91], v[168:171], v[184:187], v[88:91]
    v_mfma_f32_16x16x32_bf16 v[92:95], v[168:171], v[188:191], v[92:95]
    v_mfma_f32_16x16x32_bf16 v[96:99], v[172:175], v[184:187], v[96:99]
    v_mfma_f32_16x16x32_bf16 v[100:103], v[172:175], v[188:191], v[100:103]
    s_waitcnt lgkmcnt(5)
    v_mfma_f32_16x16x32_bf16 v[32:35], v[104:107], v[176:179], v[32:35]
    ds_read_b128 v[184:187], v24 offset:17408
    v_mfma_f32_16x16x32_bf16 v[36:39], v[104:107], v[180:183], v[36:39]
    ds_read_b128 v[188:191], v24 offset:18432
    v_mfma_f32_16x16x32_bf16 v[40:43], v[108:111], v[176:179], v[40:43]
    ds_read_b128 v[140:143], v9 offset:17408
    v_mfma_f32_16x16x32_bf16 v[44:47], v[108:111], v[180:183], v[44:47]
    v_mfma_f32_16x16x32_bf16 v[48:51], v[112:115], v[176:179], v[48:51]
    ds_read_b128 v[144:147], v9 offset:18432
    v_mfma_f32_16x16x32_bf16 v[52:55], v[112:115], v[180:183], v[52:55]
    ds_read_b128 v[148:151], v9 offset:19456
    v_mfma_f32_16x16x32_bf16 v[56:59], v[116:119], v[176:179], v[56:59]
    ds_read_b128 v[152:155], v9 offset:20480
    v_mfma_f32_16x16x32_bf16 v[60:63], v[116:119], v[180:183], v[60:63]
    s_waitcnt lgkmcnt(6)
    v_mfma_f32_16x16x32_bf16 v[64:67], v[120:123], v[176:179], v[64:67]
    ds_read_b128 v[156:159], v9 offset:21504
    v_mfma_f32_16x16x32_bf16 v[68:71], v[120:123], v[180:183], v[68:71]
    ds_read_b128 v[160:163], v9 offset:22528
    v_mfma_f32_16x16x32_bf16 v[72:75], v[124:127], v[176:179], v[72:75]
    ds_read_b128 v[164:167], v9 offset:23552
    v_mfma_f32_16x16x32_bf16 v[76:79], v[124:127], v[180:183], v[76:79]
    v_mfma_f32_16x16x32_bf16 v[80:83], v[128:131], v[176:179], v[80:83]
    ds_read_b128 v[168:171], v9 offset:24576
    v_mfma_f32_16x16x32_bf16 v[84:87], v[128:131], v[180:183], v[84:87]
    ds_read_b128 v[172:175], v9 offset:25600
    v_mfma_f32_16x16x32_bf16 v[88:91], v[132:135], v[176:179], v[88:91]
    v_mfma_f32_16x16x32_bf16 v[92:95], v[132:135], v[180:183], v[92:95]
    v_mfma_f32_16x16x32_bf16 v[96:99], v[136:139], v[176:179], v[96:99]
    v_mfma_f32_16x16x32_bf16 v[100:103], v[136:139], v[180:183], v[100:103]
    s_waitcnt lgkmcnt(5)
    v_mfma_f32_16x16x32_bf16 v[32:35], v[140:143], v[184:187], v[32:35]
    v_mfma_f32_16x16x32_bf16 v[36:39], v[140:143], v[188:191], v[36:39]
    s_waitcnt lgkmcnt(0)
    s_barrier
    ds_read_b128 v[176:179], v24 offset:36864
    v_mfma_f32_16x16x32_bf16 v[40:43], v[144:147], v[184:187], v[40:43]
    ds_read_b128 v[180:183], v24 offset:37888
    v_mfma_f32_16x16x32_bf16 v[44:47], v[144:147], v[188:191], v[44:47]
    ds_read_b128 v[104:107], v9 offset:36864
    v_mfma_f32_16x16x32_bf16 v[48:51], v[148:151], v[184:187], v[48:51]
    ds_read_b128 v[108:111], v9 offset:37888
    v_mfma_f32_16x16x32_bf16 v[52:55], v[148:151], v[188:191], v[52:55]
    v_mfma_f32_16x16x32_bf16 v[56:59], v[152:155], v[184:187], v[56:59]
    ds_read_b128 v[112:115], v9 offset:38912
    v_mfma_f32_16x16x32_bf16 v[60:63], v[152:155], v[188:191], v[60:63]
    ds_read_b128 v[116:119], v9 offset:39936
    v_mfma_f32_16x16x32_bf16 v[64:67], v[156:159], v[184:187], v[64:67]
    ds_read_b128 v[120:123], v9 offset:40960
    v_mfma_f32_16x16x32_bf16 v[68:71], v[156:159], v[188:191], v[68:71]
    ds_read_b128 v[124:127], v9 offset:41984
    v_mfma_f32_16x16x32_bf16 v[72:75], v[160:163], v[184:187], v[72:75]
    v_mfma_f32_16x16x32_bf16 v[76:79], v[160:163], v[188:191], v[76:79]
    ds_read_b128 v[128:131], v9 offset:43008
    v_mfma_f32_16x16x32_bf16 v[80:83], v[164:167], v[184:187], v[80:83]
    ds_read_b128 v[132:135], v9 offset:44032
    v_mfma_f32_16x16x32_bf16 v[84:87], v[164:167], v[188:191], v[84:87]
    ds_read_b128 v[136:139], v9 offset:45056
    v_mfma_f32_16x16x32_bf16 v[88:91], v[168:171], v[184:187], v[88:91]
    v_mfma_f32_16x16x32_bf16 v[92:95], v[168:171], v[188:191], v[92:95]
    v_mfma_f32_16x16x32_bf16 v[96:99], v[172:175], v[184:187], v[96:99]
    v_mfma_f32_16x16x32_bf16 v[100:103], v[172:175], v[188:191], v[100:103]
    s_waitcnt lgkmcnt(5)
    v_mfma_f32_16x16x32_bf16 v[32:35], v[104:107], v[176:179], v[32:35]
    ds_read_b128 v[184:187], v24 offset:54272
    v_mfma_f32_16x16x32_bf16 v[36:39], v[104:107], v[180:183], v[36:39]
    ds_read_b128 v[188:191], v24 offset:55296
    v_mfma_f32_16x16x32_bf16 v[40:43], v[108:111], v[176:179], v[40:43]
    ds_read_b128 v[140:143], v9 offset:54272
    v_mfma_f32_16x16x32_bf16 v[44:47], v[108:111], v[180:183], v[44:47]
    v_mfma_f32_16x16x32_bf16 v[48:51], v[112:115], v[176:179], v[48:51]
    ds_read_b128 v[144:147], v9 offset:55296
    v_mfma_f32_16x16x32_bf16 v[52:55], v[112:115], v[180:183], v[52:55]
    ds_read_b128 v[148:151], v9 offset:56320
    v_mfma_f32_16x16x32_bf16 v[56:59], v[116:119], v[176:179], v[56:59]
    ds_read_b128 v[152:155], v9 offset:57344
    v_mfma_f32_16x16x32_bf16 v[60:63], v[116:119], v[180:183], v[60:63]
    s_waitcnt lgkmcnt(6)
    v_mfma_f32_16x16x32_bf16 v[64:67], v[120:123], v[176:179], v[64:67]
    ds_read_b128 v[156:159], v9 offset:58368
    v_mfma_f32_16x16x32_bf16 v[68:71], v[120:123], v[180:183], v[68:71]
    ds_read_b128 v[160:163], v9 offset:59392
    v_mfma_f32_16x16x32_bf16 v[72:75], v[124:127], v[176:179], v[72:75]
    ds_read_b128 v[164:167], v9 offset:60416
    v_mfma_f32_16x16x32_bf16 v[76:79], v[124:127], v[180:183], v[76:79]
    v_mfma_f32_16x16x32_bf16 v[80:83], v[128:131], v[176:179], v[80:83]
    ds_read_b128 v[168:171], v9 offset:61440
    v_mfma_f32_16x16x32_bf16 v[84:87], v[128:131], v[180:183], v[84:87]
    ds_read_b128 v[172:175], v9 offset:62464
    v_mfma_f32_16x16x32_bf16 v[88:91], v[132:135], v[176:179], v[88:91]
    v_mfma_f32_16x16x32_bf16 v[92:95], v[132:135], v[180:183], v[92:95]
    v_mfma_f32_16x16x32_bf16 v[96:99], v[136:139], v[176:179], v[96:99]
    v_mfma_f32_16x16x32_bf16 v[100:103], v[136:139], v[180:183], v[100:103]
    s_waitcnt lgkmcnt(5)
    v_mfma_f32_16x16x32_bf16 v[32:35], v[140:143], v[184:187], v[32:35]
    v_mfma_f32_16x16x32_bf16 v[36:39], v[140:143], v[188:191], v[36:39]
    s_waitcnt lgkmcnt(0)
    s_barrier
    ds_read_b128 v[176:179], v25 offset:0
    v_mfma_f32_16x16x32_bf16 v[40:43], v[144:147], v[184:187], v[40:43]
    ds_read_b128 v[180:183], v25 offset:1024
    v_mfma_f32_16x16x32_bf16 v[44:47], v[144:147], v[188:191], v[44:47]
    ds_read_b128 v[104:107], v11 offset:0
    v_mfma_f32_16x16x32_bf16 v[48:51], v[148:151], v[184:187], v[48:51]
    ds_read_b128 v[108:111], v11 offset:1024
    v_mfma_f32_16x16x32_bf16 v[52:55], v[148:151], v[188:191], v[52:55]
    v_mfma_f32_16x16x32_bf16 v[56:59], v[152:155], v[184:187], v[56:59]
    ds_read_b128 v[112:115], v11 offset:2048
    v_mfma_f32_16x16x32_bf16 v[60:63], v[152:155], v[188:191], v[60:63]
    ds_read_b128 v[116:119], v11 offset:3072
    v_mfma_f32_16x16x32_bf16 v[64:67], v[156:159], v[184:187], v[64:67]
    ds_read_b128 v[120:123], v11 offset:4096
    v_mfma_f32_16x16x32_bf16 v[68:71], v[156:159], v[188:191], v[68:71]
    ds_read_b128 v[124:127], v11 offset:5120
    v_mfma_f32_16x16x32_bf16 v[72:75], v[160:163], v[184:187], v[72:75]
    v_mfma_f32_16x16x32_bf16 v[76:79], v[160:163], v[188:191], v[76:79]
    ds_read_b128 v[128:131], v11 offset:6144
    v_mfma_f32_16x16x32_bf16 v[80:83], v[164:167], v[184:187], v[80:83]
    ds_read_b128 v[132:135], v11 offset:7168
    v_mfma_f32_16x16x32_bf16 v[84:87], v[164:167], v[188:191], v[84:87]
    ds_read_b128 v[136:139], v11 offset:8192
    v_mfma_f32_16x16x32_bf16 v[88:91], v[168:171], v[184:187], v[88:91]
    v_mfma_f32_16x16x32_bf16 v[92:95], v[168:171], v[188:191], v[92:95]
    v_mfma_f32_16x16x32_bf16 v[96:99], v[172:175], v[184:187], v[96:99]
    v_mfma_f32_16x16x32_bf16 v[100:103], v[172:175], v[188:191], v[100:103]
    s_waitcnt lgkmcnt(5)
    v_mfma_f32_16x16x32_bf16 v[32:35], v[104:107], v[176:179], v[32:35]
    ds_read_b128 v[184:187], v25 offset:17408
    v_mfma_f32_16x16x32_bf16 v[36:39], v[104:107], v[180:183], v[36:39]
    ds_read_b128 v[188:191], v25 offset:18432
    v_mfma_f32_16x16x32_bf16 v[40:43], v[108:111], v[176:179], v[40:43]
    ds_read_b128 v[140:143], v11 offset:17408
    v_mfma_f32_16x16x32_bf16 v[44:47], v[108:111], v[180:183], v[44:47]
    v_mfma_f32_16x16x32_bf16 v[48:51], v[112:115], v[176:179], v[48:51]
    ds_read_b128 v[144:147], v11 offset:18432
    v_mfma_f32_16x16x32_bf16 v[52:55], v[112:115], v[180:183], v[52:55]
    ds_read_b128 v[148:151], v11 offset:19456
    v_mfma_f32_16x16x32_bf16 v[56:59], v[116:119], v[176:179], v[56:59]
    ds_read_b128 v[152:155], v11 offset:20480
    v_mfma_f32_16x16x32_bf16 v[60:63], v[116:119], v[180:183], v[60:63]
    s_waitcnt lgkmcnt(6)
    v_mfma_f32_16x16x32_bf16 v[64:67], v[120:123], v[176:179], v[64:67]
    ds_read_b128 v[156:159], v11 offset:21504
    v_mfma_f32_16x16x32_bf16 v[68:71], v[120:123], v[180:183], v[68:71]
    ds_read_b128 v[160:163], v11 offset:22528
    v_mfma_f32_16x16x32_bf16 v[72:75], v[124:127], v[176:179], v[72:75]
    ds_read_b128 v[164:167], v11 offset:23552
    v_mfma_f32_16x16x32_bf16 v[76:79], v[124:127], v[180:183], v[76:79]
    v_mfma_f32_16x16x32_bf16 v[80:83], v[128:131], v[176:179], v[80:83]
    ds_read_b128 v[168:171], v11 offset:24576
    v_mfma_f32_16x16x32_bf16 v[84:87], v[128:131], v[180:183], v[84:87]
    ds_read_b128 v[172:175], v11 offset:25600
    v_mfma_f32_16x16x32_bf16 v[88:91], v[132:135], v[176:179], v[88:91]
    v_mfma_f32_16x16x32_bf16 v[92:95], v[132:135], v[180:183], v[92:95]
    v_mfma_f32_16x16x32_bf16 v[96:99], v[136:139], v[176:179], v[96:99]
    v_mfma_f32_16x16x32_bf16 v[100:103], v[136:139], v[180:183], v[100:103]
    s_waitcnt lgkmcnt(5)
    v_mfma_f32_16x16x32_bf16 v[32:35], v[140:143], v[184:187], v[32:35]
    v_mfma_f32_16x16x32_bf16 v[36:39], v[140:143], v[188:191], v[36:39]
    s_waitcnt lgkmcnt(0)
    s_barrier
    ds_read_b128 v[176:179], v25 offset:34816
    v_mfma_f32_16x16x32_bf16 v[40:43], v[144:147], v[184:187], v[40:43]
    ds_read_b128 v[180:183], v25 offset:35840
    v_mfma_f32_16x16x32_bf16 v[44:47], v[144:147], v[188:191], v[44:47]
    ds_read_b128 v[104:107], v11 offset:34816
    v_mfma_f32_16x16x32_bf16 v[48:51], v[148:151], v[184:187], v[48:51]
    ds_read_b128 v[108:111], v11 offset:35840
    v_mfma_f32_16x16x32_bf16 v[52:55], v[148:151], v[188:191], v[52:55]
    v_mfma_f32_16x16x32_bf16 v[56:59], v[152:155], v[184:187], v[56:59]
    ds_read_b128 v[112:115], v11 offset:36864
    v_mfma_f32_16x16x32_bf16 v[60:63], v[152:155], v[188:191], v[60:63]
    ds_read_b128 v[116:119], v11 offset:37888
    v_mfma_f32_16x16x32_bf16 v[64:67], v[156:159], v[184:187], v[64:67]
    ds_read_b128 v[120:123], v11 offset:38912
    v_mfma_f32_16x16x32_bf16 v[68:71], v[156:159], v[188:191], v[68:71]
    ds_read_b128 v[124:127], v11 offset:39936
    v_mfma_f32_16x16x32_bf16 v[72:75], v[160:163], v[184:187], v[72:75]
    v_mfma_f32_16x16x32_bf16 v[76:79], v[160:163], v[188:191], v[76:79]
    ds_read_b128 v[128:131], v11 offset:40960
    v_mfma_f32_16x16x32_bf16 v[80:83], v[164:167], v[184:187], v[80:83]
    ds_read_b128 v[132:135], v11 offset:41984
    v_mfma_f32_16x16x32_bf16 v[84:87], v[164:167], v[188:191], v[84:87]
    ds_read_b128 v[136:139], v11 offset:43008
    v_mfma_f32_16x16x32_bf16 v[88:91], v[168:171], v[184:187], v[88:91]
    v_mfma_f32_16x16x32_bf16 v[92:95], v[168:171], v[188:191], v[92:95]
    v_mfma_f32_16x16x32_bf16 v[96:99], v[172:175], v[184:187], v[96:99]
    v_mfma_f32_16x16x32_bf16 v[100:103], v[172:175], v[188:191], v[100:103]
    s_waitcnt lgkmcnt(5)
    v_mfma_f32_16x16x32_bf16 v[32:35], v[104:107], v[176:179], v[32:35]
    ds_read_b128 v[184:187], v25 offset:52224
    v_mfma_f32_16x16x32_bf16 v[36:39], v[104:107], v[180:183], v[36:39]
    ds_read_b128 v[188:191], v25 offset:53248
    v_mfma_f32_16x16x32_bf16 v[40:43], v[108:111], v[176:179], v[40:43]
    ds_read_b128 v[140:143], v11 offset:52224
    v_mfma_f32_16x16x32_bf16 v[44:47], v[108:111], v[180:183], v[44:47]
    v_mfma_f32_16x16x32_bf16 v[48:51], v[112:115], v[176:179], v[48:51]
    ds_read_b128 v[144:147], v11 offset:53248
    v_mfma_f32_16x16x32_bf16 v[52:55], v[112:115], v[180:183], v[52:55]
    ds_read_b128 v[148:151], v11 offset:54272
    v_mfma_f32_16x16x32_bf16 v[56:59], v[116:119], v[176:179], v[56:59]
    ds_read_b128 v[152:155], v11 offset:55296
    v_mfma_f32_16x16x32_bf16 v[60:63], v[116:119], v[180:183], v[60:63]
    s_waitcnt lgkmcnt(6)
    v_mfma_f32_16x16x32_bf16 v[64:67], v[120:123], v[176:179], v[64:67]
    ds_read_b128 v[156:159], v11 offset:56320
    v_mfma_f32_16x16x32_bf16 v[68:71], v[120:123], v[180:183], v[68:71]
    ds_read_b128 v[160:163], v11 offset:57344
    v_mfma_f32_16x16x32_bf16 v[72:75], v[124:127], v[176:179], v[72:75]
    ds_read_b128 v[164:167], v11 offset:58368
    v_mfma_f32_16x16x32_bf16 v[76:79], v[124:127], v[180:183], v[76:79]
    v_mfma_f32_16x16x32_bf16 v[80:83], v[128:131], v[176:179], v[80:83]
    ds_read_b128 v[168:171], v11 offset:59392
    v_mfma_f32_16x16x32_bf16 v[84:87], v[128:131], v[180:183], v[84:87]
    ds_read_b128 v[172:175], v11 offset:60416
    v_mfma_f32_16x16x32_bf16 v[88:91], v[132:135], v[176:179], v[88:91]
    v_mfma_f32_16x16x32_bf16 v[92:95], v[132:135], v[180:183], v[92:95]
    v_mfma_f32_16x16x32_bf16 v[96:99], v[136:139], v[176:179], v[96:99]
    v_mfma_f32_16x16x32_bf16 v[100:103], v[136:139], v[180:183], v[100:103]
    s_waitcnt lgkmcnt(5)
    v_mfma_f32_16x16x32_bf16 v[32:35], v[140:143], v[184:187], v[32:35]
    v_mfma_f32_16x16x32_bf16 v[36:39], v[140:143], v[188:191], v[36:39]
    s_waitcnt lgkmcnt(0)
    s_barrier
    ds_read_b128 v[176:179], v24 offset:0
    v_mfma_f32_16x16x32_bf16 v[40:43], v[144:147], v[184:187], v[40:43]
    ds_read_b128 v[180:183], v24 offset:1024
    v_mfma_f32_16x16x32_bf16 v[44:47], v[144:147], v[188:191], v[44:47]
    ds_read_b128 v[104:107], v9 offset:0
    v_mfma_f32_16x16x32_bf16 v[48:51], v[148:151], v[184:187], v[48:51]
    ds_read_b128 v[108:111], v9 offset:1024
    v_mfma_f32_16x16x32_bf16 v[52:55], v[148:151], v[188:191], v[52:55]
    v_mfma_f32_16x16x32_bf16 v[56:59], v[152:155], v[184:187], v[56:59]
    ds_read_b128 v[112:115], v9 offset:2048
    v_mfma_f32_16x16x32_bf16 v[60:63], v[152:155], v[188:191], v[60:63]
    ds_read_b128 v[116:119], v9 offset:3072
    v_mfma_f32_16x16x32_bf16 v[64:67], v[156:159], v[184:187], v[64:67]
    ds_read_b128 v[120:123], v9 offset:4096
    v_mfma_f32_16x16x32_bf16 v[68:71], v[156:159], v[188:191], v[68:71]
    ds_read_b128 v[124:127], v9 offset:5120
    v_mfma_f32_16x16x32_bf16 v[72:75], v[160:163], v[184:187], v[72:75]
    v_mfma_f32_16x16x32_bf16 v[76:79], v[160:163], v[188:191], v[76:79]
    ds_read_b128 v[128:131], v9 offset:6144
    v_mfma_f32_16x16x32_bf16 v[80:83], v[164:167], v[184:187], v[80:83]
    ds_read_b128 v[132:135], v9 offset:7168
    v_mfma_f32_16x16x32_bf16 v[84:87], v[164:167], v[188:191], v[84:87]
    ds_read_b128 v[136:139], v9 offset:8192
    v_mfma_f32_16x16x32_bf16 v[88:91], v[168:171], v[184:187], v[88:91]
    v_mfma_f32_16x16x32_bf16 v[92:95], v[168:171], v[188:191], v[92:95]
    v_mfma_f32_16x16x32_bf16 v[96:99], v[172:175], v[184:187], v[96:99]
    v_mfma_f32_16x16x32_bf16 v[100:103], v[172:175], v[188:191], v[100:103]
    s_waitcnt lgkmcnt(5)
    v_mfma_f32_16x16x32_bf16 v[32:35], v[104:107], v[176:179], v[32:35]
    ds_read_b128 v[184:187], v24 offset:17408
    v_mfma_f32_16x16x32_bf16 v[36:39], v[104:107], v[180:183], v[36:39]
    ds_read_b128 v[188:191], v24 offset:18432
    v_mfma_f32_16x16x32_bf16 v[40:43], v[108:111], v[176:179], v[40:43]
    ds_read_b128 v[140:143], v9 offset:17408
    v_mfma_f32_16x16x32_bf16 v[44:47], v[108:111], v[180:183], v[44:47]
    v_mfma_f32_16x16x32_bf16 v[48:51], v[112:115], v[176:179], v[48:51]
    ds_read_b128 v[144:147], v9 offset:18432
    v_mfma_f32_16x16x32_bf16 v[52:55], v[112:115], v[180:183], v[52:55]
    ds_read_b128 v[148:151], v9 offset:19456
    v_mfma_f32_16x16x32_bf16 v[56:59], v[116:119], v[176:179], v[56:59]
    ds_read_b128 v[152:155], v9 offset:20480
    v_mfma_f32_16x16x32_bf16 v[60:63], v[116:119], v[180:183], v[60:63]
    s_waitcnt lgkmcnt(6)
    v_mfma_f32_16x16x32_bf16 v[64:67], v[120:123], v[176:179], v[64:67]
    ds_read_b128 v[156:159], v9 offset:21504
    v_mfma_f32_16x16x32_bf16 v[68:71], v[120:123], v[180:183], v[68:71]
    ds_read_b128 v[160:163], v9 offset:22528
    v_mfma_f32_16x16x32_bf16 v[72:75], v[124:127], v[176:179], v[72:75]
    ds_read_b128 v[164:167], v9 offset:23552
    v_mfma_f32_16x16x32_bf16 v[76:79], v[124:127], v[180:183], v[76:79]
    v_mfma_f32_16x16x32_bf16 v[80:83], v[128:131], v[176:179], v[80:83]
    ds_read_b128 v[168:171], v9 offset:24576
    v_mfma_f32_16x16x32_bf16 v[84:87], v[128:131], v[180:183], v[84:87]
    ds_read_b128 v[172:175], v9 offset:25600
    v_mfma_f32_16x16x32_bf16 v[88:91], v[132:135], v[176:179], v[88:91]
    v_mfma_f32_16x16x32_bf16 v[92:95], v[132:135], v[180:183], v[92:95]
    v_mfma_f32_16x16x32_bf16 v[96:99], v[136:139], v[176:179], v[96:99]
    v_mfma_f32_16x16x32_bf16 v[100:103], v[136:139], v[180:183], v[100:103]
    s_waitcnt lgkmcnt(5)
    v_mfma_f32_16x16x32_bf16 v[32:35], v[140:143], v[184:187], v[32:35]
    v_mfma_f32_16x16x32_bf16 v[36:39], v[140:143], v[188:191], v[36:39]
    s_waitcnt lgkmcnt(0)
    s_barrier
    ds_read_b128 v[176:179], v24 offset:36864
    v_mfma_f32_16x16x32_bf16 v[40:43], v[144:147], v[184:187], v[40:43]
    ds_read_b128 v[180:183], v24 offset:37888
    v_mfma_f32_16x16x32_bf16 v[44:47], v[144:147], v[188:191], v[44:47]
    ds_read_b128 v[104:107], v9 offset:36864
    v_mfma_f32_16x16x32_bf16 v[48:51], v[148:151], v[184:187], v[48:51]
    ds_read_b128 v[108:111], v9 offset:37888
    v_mfma_f32_16x16x32_bf16 v[52:55], v[148:151], v[188:191], v[52:55]
    v_mfma_f32_16x16x32_bf16 v[56:59], v[152:155], v[184:187], v[56:59]
    ds_read_b128 v[112:115], v9 offset:38912
    v_mfma_f32_16x16x32_bf16 v[60:63], v[152:155], v[188:191], v[60:63]
    ds_read_b128 v[116:119], v9 offset:39936
    v_mfma_f32_16x16x32_bf16 v[64:67], v[156:159], v[184:187], v[64:67]
    ds_read_b128 v[120:123], v9 offset:40960
    v_mfma_f32_16x16x32_bf16 v[68:71], v[156:159], v[188:191], v[68:71]
    ds_read_b128 v[124:127], v9 offset:41984
    v_mfma_f32_16x16x32_bf16 v[72:75], v[160:163], v[184:187], v[72:75]
    v_mfma_f32_16x16x32_bf16 v[76:79], v[160:163], v[188:191], v[76:79]
    ds_read_b128 v[128:131], v9 offset:43008
    v_mfma_f32_16x16x32_bf16 v[80:83], v[164:167], v[184:187], v[80:83]
    ds_read_b128 v[132:135], v9 offset:44032
    v_mfma_f32_16x16x32_bf16 v[84:87], v[164:167], v[188:191], v[84:87]
    ds_read_b128 v[136:139], v9 offset:45056
    v_mfma_f32_16x16x32_bf16 v[88:91], v[168:171], v[184:187], v[88:91]
    v_mfma_f32_16x16x32_bf16 v[92:95], v[168:171], v[188:191], v[92:95]
    v_mfma_f32_16x16x32_bf16 v[96:99], v[172:175], v[184:187], v[96:99]
    v_mfma_f32_16x16x32_bf16 v[100:103], v[172:175], v[188:191], v[100:103]
    s_waitcnt lgkmcnt(5)
    v_mfma_f32_16x16x32_bf16 v[32:35], v[104:107], v[176:179], v[32:35]
    ds_read_b128 v[184:187], v24 offset:54272
    v_mfma_f32_16x16x32_bf16 v[36:39], v[104:107], v[180:183], v[36:39]
    ds_read_b128 v[188:191], v24 offset:55296
    v_mfma_f32_16x16x32_bf16 v[40:43], v[108:111], v[176:179], v[40:43]
    ds_read_b128 v[140:143], v9 offset:54272
    v_mfma_f32_16x16x32_bf16 v[44:47], v[108:111], v[180:183], v[44:47]
    v_mfma_f32_16x16x32_bf16 v[48:51], v[112:115], v[176:179], v[48:51]
    ds_read_b128 v[144:147], v9 offset:55296
    v_mfma_f32_16x16x32_bf16 v[52:55], v[112:115], v[180:183], v[52:55]
    ds_read_b128 v[148:151], v9 offset:56320
    v_mfma_f32_16x16x32_bf16 v[56:59], v[116:119], v[176:179], v[56:59]
    ds_read_b128 v[152:155], v9 offset:57344
    v_mfma_f32_16x16x32_bf16 v[60:63], v[116:119], v[180:183], v[60:63]
    s_waitcnt lgkmcnt(6)
    v_mfma_f32_16x16x32_bf16 v[64:67], v[120:123], v[176:179], v[64:67]
    ds_read_b128 v[156:159], v9 offset:58368
    v_mfma_f32_16x16x32_bf16 v[68:71], v[120:123], v[180:183], v[68:71]
    ds_read_b128 v[160:163], v9 offset:59392
    v_mfma_f32_16x16x32_bf16 v[72:75], v[124:127], v[176:179], v[72:75]
    ds_read_b128 v[164:167], v9 offset:60416
    v_mfma_f32_16x16x32_bf16 v[76:79], v[124:127], v[180:183], v[76:79]
    v_mfma_f32_16x16x32_bf16 v[80:83], v[128:131], v[176:179], v[80:83]
    ds_read_b128 v[168:171], v9 offset:61440
    v_mfma_f32_16x16x32_bf16 v[84:87], v[128:131], v[180:183], v[84:87]
    ds_read_b128 v[172:175], v9 offset:62464
    v_mfma_f32_16x16x32_bf16 v[88:91], v[132:135], v[176:179], v[88:91]
    v_mfma_f32_16x16x32_bf16 v[92:95], v[132:135], v[180:183], v[92:95]
    v_mfma_f32_16x16x32_bf16 v[96:99], v[136:139], v[176:179], v[96:99]
    v_mfma_f32_16x16x32_bf16 v[100:103], v[136:139], v[180:183], v[100:103]
    s_waitcnt lgkmcnt(5)
    v_mfma_f32_16x16x32_bf16 v[32:35], v[140:143], v[184:187], v[32:35]
    v_mfma_f32_16x16x32_bf16 v[36:39], v[140:143], v[188:191], v[36:39]
    s_waitcnt lgkmcnt(0)
    s_barrier
    ds_read_b128 v[176:179], v25 offset:0
    v_mfma_f32_16x16x32_bf16 v[40:43], v[144:147], v[184:187], v[40:43]
    ds_read_b128 v[180:183], v25 offset:1024
    v_mfma_f32_16x16x32_bf16 v[44:47], v[144:147], v[188:191], v[44:47]
    ds_read_b128 v[104:107], v11 offset:0
    v_mfma_f32_16x16x32_bf16 v[48:51], v[148:151], v[184:187], v[48:51]
    ds_read_b128 v[108:111], v11 offset:1024
    v_mfma_f32_16x16x32_bf16 v[52:55], v[148:151], v[188:191], v[52:55]
    v_mfma_f32_16x16x32_bf16 v[56:59], v[152:155], v[184:187], v[56:59]
    ds_read_b128 v[112:115], v11 offset:2048
    v_mfma_f32_16x16x32_bf16 v[60:63], v[152:155], v[188:191], v[60:63]
    ds_read_b128 v[116:119], v11 offset:3072
    v_mfma_f32_16x16x32_bf16 v[64:67], v[156:159], v[184:187], v[64:67]
    ds_read_b128 v[120:123], v11 offset:4096
    v_mfma_f32_16x16x32_bf16 v[68:71], v[156:159], v[188:191], v[68:71]
    ds_read_b128 v[124:127], v11 offset:5120
    v_mfma_f32_16x16x32_bf16 v[72:75], v[160:163], v[184:187], v[72:75]
    v_mfma_f32_16x16x32_bf16 v[76:79], v[160:163], v[188:191], v[76:79]
    ds_read_b128 v[128:131], v11 offset:6144
    v_mfma_f32_16x16x32_bf16 v[80:83], v[164:167], v[184:187], v[80:83]
    ds_read_b128 v[132:135], v11 offset:7168
    v_mfma_f32_16x16x32_bf16 v[84:87], v[164:167], v[188:191], v[84:87]
    ds_read_b128 v[136:139], v11 offset:8192
    v_mfma_f32_16x16x32_bf16 v[88:91], v[168:171], v[184:187], v[88:91]
    v_mfma_f32_16x16x32_bf16 v[92:95], v[168:171], v[188:191], v[92:95]
    v_mfma_f32_16x16x32_bf16 v[96:99], v[172:175], v[184:187], v[96:99]
    v_mfma_f32_16x16x32_bf16 v[100:103], v[172:175], v[188:191], v[100:103]
    s_waitcnt lgkmcnt(5)
    v_mfma_f32_16x16x32_bf16 v[32:35], v[104:107], v[176:179], v[32:35]
    ds_read_b128 v[184:187], v25 offset:17408
    v_mfma_f32_16x16x32_bf16 v[36:39], v[104:107], v[180:183], v[36:39]
    ds_read_b128 v[188:191], v25 offset:18432
    v_mfma_f32_16x16x32_bf16 v[40:43], v[108:111], v[176:179], v[40:43]
    ds_read_b128 v[140:143], v11 offset:17408
    v_mfma_f32_16x16x32_bf16 v[44:47], v[108:111], v[180:183], v[44:47]
    v_mfma_f32_16x16x32_bf16 v[48:51], v[112:115], v[176:179], v[48:51]
    ds_read_b128 v[144:147], v11 offset:18432
    v_mfma_f32_16x16x32_bf16 v[52:55], v[112:115], v[180:183], v[52:55]
    ds_read_b128 v[148:151], v11 offset:19456
    v_mfma_f32_16x16x32_bf16 v[56:59], v[116:119], v[176:179], v[56:59]
    ds_read_b128 v[152:155], v11 offset:20480
    v_mfma_f32_16x16x32_bf16 v[60:63], v[116:119], v[180:183], v[60:63]
    s_waitcnt lgkmcnt(6)
    v_mfma_f32_16x16x32_bf16 v[64:67], v[120:123], v[176:179], v[64:67]
    ds_read_b128 v[156:159], v11 offset:21504
    v_mfma_f32_16x16x32_bf16 v[68:71], v[120:123], v[180:183], v[68:71]
    ds_read_b128 v[160:163], v11 offset:22528
    v_mfma_f32_16x16x32_bf16 v[72:75], v[124:127], v[176:179], v[72:75]
    ds_read_b128 v[164:167], v11 offset:23552
    v_mfma_f32_16x16x32_bf16 v[76:79], v[124:127], v[180:183], v[76:79]
    v_mfma_f32_16x16x32_bf16 v[80:83], v[128:131], v[176:179], v[80:83]
    ds_read_b128 v[168:171], v11 offset:24576
    v_mfma_f32_16x16x32_bf16 v[84:87], v[128:131], v[180:183], v[84:87]
    ds_read_b128 v[172:175], v11 offset:25600
    v_mfma_f32_16x16x32_bf16 v[88:91], v[132:135], v[176:179], v[88:91]
    v_mfma_f32_16x16x32_bf16 v[92:95], v[132:135], v[180:183], v[92:95]
    v_mfma_f32_16x16x32_bf16 v[96:99], v[136:139], v[176:179], v[96:99]
    v_mfma_f32_16x16x32_bf16 v[100:103], v[136:139], v[180:183], v[100:103]
    s_waitcnt lgkmcnt(5)
    v_mfma_f32_16x16x32_bf16 v[32:35], v[140:143], v[184:187], v[32:35]
    v_mfma_f32_16x16x32_bf16 v[36:39], v[140:143], v[188:191], v[36:39]
    s_waitcnt lgkmcnt(0)
    s_barrier
    ds_read_b128 v[176:179], v25 offset:34816
    v_mfma_f32_16x16x32_bf16 v[40:43], v[144:147], v[184:187], v[40:43]
    ds_read_b128 v[180:183], v25 offset:35840
    v_mfma_f32_16x16x32_bf16 v[44:47], v[144:147], v[188:191], v[44:47]
    ds_read_b128 v[104:107], v11 offset:34816
    v_mfma_f32_16x16x32_bf16 v[48:51], v[148:151], v[184:187], v[48:51]
    ds_read_b128 v[108:111], v11 offset:35840
    v_mfma_f32_16x16x32_bf16 v[52:55], v[148:151], v[188:191], v[52:55]
    v_mfma_f32_16x16x32_bf16 v[56:59], v[152:155], v[184:187], v[56:59]
    ds_read_b128 v[112:115], v11 offset:36864
    v_mfma_f32_16x16x32_bf16 v[60:63], v[152:155], v[188:191], v[60:63]
    ds_read_b128 v[116:119], v11 offset:37888
    v_mfma_f32_16x16x32_bf16 v[64:67], v[156:159], v[184:187], v[64:67]
    ds_read_b128 v[120:123], v11 offset:38912
    v_mfma_f32_16x16x32_bf16 v[68:71], v[156:159], v[188:191], v[68:71]
    ds_read_b128 v[124:127], v11 offset:39936
    v_mfma_f32_16x16x32_bf16 v[72:75], v[160:163], v[184:187], v[72:75]
    v_mfma_f32_16x16x32_bf16 v[76:79], v[160:163], v[188:191], v[76:79]
    ds_read_b128 v[128:131], v11 offset:40960
    v_mfma_f32_16x16x32_bf16 v[80:83], v[164:167], v[184:187], v[80:83]
    ds_read_b128 v[132:135], v11 offset:41984
    v_mfma_f32_16x16x32_bf16 v[84:87], v[164:167], v[188:191], v[84:87]
    ds_read_b128 v[136:139], v11 offset:43008
    v_mfma_f32_16x16x32_bf16 v[88:91], v[168:171], v[184:187], v[88:91]
    v_mfma_f32_16x16x32_bf16 v[92:95], v[168:171], v[188:191], v[92:95]
    v_mfma_f32_16x16x32_bf16 v[96:99], v[172:175], v[184:187], v[96:99]
    v_mfma_f32_16x16x32_bf16 v[100:103], v[172:175], v[188:191], v[100:103]
    s_waitcnt lgkmcnt(5)
    v_mfma_f32_16x16x32_bf16 v[32:35], v[104:107], v[176:179], v[32:35]
    ds_read_b128 v[184:187], v25 offset:52224
    v_mfma_f32_16x16x32_bf16 v[36:39], v[104:107], v[180:183], v[36:39]
    ds_read_b128 v[188:191], v25 offset:53248
    v_mfma_f32_16x16x32_bf16 v[40:43], v[108:111], v[176:179], v[40:43]
    ds_read_b128 v[140:143], v11 offset:52224
    v_mfma_f32_16x16x32_bf16 v[44:47], v[108:111], v[180:183], v[44:47]
    v_mfma_f32_16x16x32_bf16 v[48:51], v[112:115], v[176:179], v[48:51]
    ds_read_b128 v[144:147], v11 offset:53248
    v_mfma_f32_16x16x32_bf16 v[52:55], v[112:115], v[180:183], v[52:55]
    ds_read_b128 v[148:151], v11 offset:54272
    v_mfma_f32_16x16x32_bf16 v[56:59], v[116:119], v[176:179], v[56:59]
    ds_read_b128 v[152:155], v11 offset:55296
    v_mfma_f32_16x16x32_bf16 v[60:63], v[116:119], v[180:183], v[60:63]
    s_waitcnt lgkmcnt(6)
    v_mfma_f32_16x16x32_bf16 v[64:67], v[120:123], v[176:179], v[64:67]
    ds_read_b128 v[156:159], v11 offset:56320
    v_mfma_f32_16x16x32_bf16 v[68:71], v[120:123], v[180:183], v[68:71]
    ds_read_b128 v[160:163], v11 offset:57344
    v_mfma_f32_16x16x32_bf16 v[72:75], v[124:127], v[176:179], v[72:75]
    ds_read_b128 v[164:167], v11 offset:58368
    v_mfma_f32_16x16x32_bf16 v[76:79], v[124:127], v[180:183], v[76:79]
    v_mfma_f32_16x16x32_bf16 v[80:83], v[128:131], v[176:179], v[80:83]
    ds_read_b128 v[168:171], v11 offset:59392
    v_mfma_f32_16x16x32_bf16 v[84:87], v[128:131], v[180:183], v[84:87]
    ds_read_b128 v[172:175], v11 offset:60416
    v_mfma_f32_16x16x32_bf16 v[88:91], v[132:135], v[176:179], v[88:91]
    v_mfma_f32_16x16x32_bf16 v[92:95], v[132:135], v[180:183], v[92:95]
    v_mfma_f32_16x16x32_bf16 v[96:99], v[136:139], v[176:179], v[96:99]
    v_mfma_f32_16x16x32_bf16 v[100:103], v[136:139], v[180:183], v[100:103]
    s_waitcnt lgkmcnt(5)
    v_mfma_f32_16x16x32_bf16 v[32:35], v[140:143], v[184:187], v[32:35]
    v_mfma_f32_16x16x32_bf16 v[36:39], v[140:143], v[188:191], v[36:39]
    s_waitcnt lgkmcnt(0)
    s_barrier
    ds_read_b128 v[176:179], v24 offset:0
    v_mfma_f32_16x16x32_bf16 v[40:43], v[144:147], v[184:187], v[40:43]
    ds_read_b128 v[180:183], v24 offset:1024
    v_mfma_f32_16x16x32_bf16 v[44:47], v[144:147], v[188:191], v[44:47]
    ds_read_b128 v[104:107], v9 offset:0
    v_mfma_f32_16x16x32_bf16 v[48:51], v[148:151], v[184:187], v[48:51]
    ds_read_b128 v[108:111], v9 offset:1024
    v_mfma_f32_16x16x32_bf16 v[52:55], v[148:151], v[188:191], v[52:55]
    v_mfma_f32_16x16x32_bf16 v[56:59], v[152:155], v[184:187], v[56:59]
    ds_read_b128 v[112:115], v9 offset:2048
    v_mfma_f32_16x16x32_bf16 v[60:63], v[152:155], v[188:191], v[60:63]
    ds_read_b128 v[116:119], v9 offset:3072
    v_mfma_f32_16x16x32_bf16 v[64:67], v[156:159], v[184:187], v[64:67]
    ds_read_b128 v[120:123], v9 offset:4096
    v_mfma_f32_16x16x32_bf16 v[68:71], v[156:159], v[188:191], v[68:71]
    ds_read_b128 v[124:127], v9 offset:5120
    v_mfma_f32_16x16x32_bf16 v[72:75], v[160:163], v[184:187], v[72:75]
    v_mfma_f32_16x16x32_bf16 v[76:79], v[160:163], v[188:191], v[76:79]
    ds_read_b128 v[128:131], v9 offset:6144
    v_mfma_f32_16x16x32_bf16 v[80:83], v[164:167], v[184:187], v[80:83]
    ds_read_b128 v[132:135], v9 offset:7168
    v_mfma_f32_16x16x32_bf16 v[84:87], v[164:167], v[188:191], v[84:87]
    ds_read_b128 v[136:139], v9 offset:8192
    v_mfma_f32_16x16x32_bf16 v[88:91], v[168:171], v[184:187], v[88:91]
    v_mfma_f32_16x16x32_bf16 v[92:95], v[168:171], v[188:191], v[92:95]
    v_mfma_f32_16x16x32_bf16 v[96:99], v[172:175], v[184:187], v[96:99]
    v_mfma_f32_16x16x32_bf16 v[100:103], v[172:175], v[188:191], v[100:103]
    s_waitcnt lgkmcnt(5)
    v_mfma_f32_16x16x32_bf16 v[32:35], v[104:107], v[176:179], v[32:35]
    ds_read_b128 v[184:187], v24 offset:17408
    v_mfma_f32_16x16x32_bf16 v[36:39], v[104:107], v[180:183], v[36:39]
    ds_read_b128 v[188:191], v24 offset:18432
    v_mfma_f32_16x16x32_bf16 v[40:43], v[108:111], v[176:179], v[40:43]
    ds_read_b128 v[140:143], v9 offset:17408
    v_mfma_f32_16x16x32_bf16 v[44:47], v[108:111], v[180:183], v[44:47]
    v_mfma_f32_16x16x32_bf16 v[48:51], v[112:115], v[176:179], v[48:51]
    ds_read_b128 v[144:147], v9 offset:18432
    v_mfma_f32_16x16x32_bf16 v[52:55], v[112:115], v[180:183], v[52:55]
    ds_read_b128 v[148:151], v9 offset:19456
    v_mfma_f32_16x16x32_bf16 v[56:59], v[116:119], v[176:179], v[56:59]
    ds_read_b128 v[152:155], v9 offset:20480
    v_mfma_f32_16x16x32_bf16 v[60:63], v[116:119], v[180:183], v[60:63]
    s_waitcnt lgkmcnt(6)
    v_mfma_f32_16x16x32_bf16 v[64:67], v[120:123], v[176:179], v[64:67]
    ds_read_b128 v[156:159], v9 offset:21504
    v_mfma_f32_16x16x32_bf16 v[68:71], v[120:123], v[180:183], v[68:71]
    ds_read_b128 v[160:163], v9 offset:22528
    v_mfma_f32_16x16x32_bf16 v[72:75], v[124:127], v[176:179], v[72:75]
    ds_read_b128 v[164:167], v9 offset:23552
    v_mfma_f32_16x16x32_bf16 v[76:79], v[124:127], v[180:183], v[76:79]
    v_mfma_f32_16x16x32_bf16 v[80:83], v[128:131], v[176:179], v[80:83]
    ds_read_b128 v[168:171], v9 offset:24576
    v_mfma_f32_16x16x32_bf16 v[84:87], v[128:131], v[180:183], v[84:87]
    ds_read_b128 v[172:175], v9 offset:25600
    v_mfma_f32_16x16x32_bf16 v[88:91], v[132:135], v[176:179], v[88:91]
    v_mfma_f32_16x16x32_bf16 v[92:95], v[132:135], v[180:183], v[92:95]
    v_mfma_f32_16x16x32_bf16 v[96:99], v[136:139], v[176:179], v[96:99]
    v_mfma_f32_16x16x32_bf16 v[100:103], v[136:139], v[180:183], v[100:103]
    s_waitcnt lgkmcnt(5)
    v_mfma_f32_16x16x32_bf16 v[32:35], v[140:143], v[184:187], v[32:35]
    v_mfma_f32_16x16x32_bf16 v[36:39], v[140:143], v[188:191], v[36:39]
    s_waitcnt lgkmcnt(0)
    s_barrier
    ds_read_b128 v[176:179], v24 offset:36864
    v_mfma_f32_16x16x32_bf16 v[40:43], v[144:147], v[184:187], v[40:43]
    ds_read_b128 v[180:183], v24 offset:37888
    v_mfma_f32_16x16x32_bf16 v[44:47], v[144:147], v[188:191], v[44:47]
    ds_read_b128 v[104:107], v9 offset:36864
    v_mfma_f32_16x16x32_bf16 v[48:51], v[148:151], v[184:187], v[48:51]
    ds_read_b128 v[108:111], v9 offset:37888
    v_mfma_f32_16x16x32_bf16 v[52:55], v[148:151], v[188:191], v[52:55]
    v_mfma_f32_16x16x32_bf16 v[56:59], v[152:155], v[184:187], v[56:59]
    ds_read_b128 v[112:115], v9 offset:38912
    v_mfma_f32_16x16x32_bf16 v[60:63], v[152:155], v[188:191], v[60:63]
    ds_read_b128 v[116:119], v9 offset:39936
    v_mfma_f32_16x16x32_bf16 v[64:67], v[156:159], v[184:187], v[64:67]
    ds_read_b128 v[120:123], v9 offset:40960
    v_mfma_f32_16x16x32_bf16 v[68:71], v[156:159], v[188:191], v[68:71]
    ds_read_b128 v[124:127], v9 offset:41984
    v_mfma_f32_16x16x32_bf16 v[72:75], v[160:163], v[184:187], v[72:75]
    v_mfma_f32_16x16x32_bf16 v[76:79], v[160:163], v[188:191], v[76:79]
    ds_read_b128 v[128:131], v9 offset:43008
    v_mfma_f32_16x16x32_bf16 v[80:83], v[164:167], v[184:187], v[80:83]
    ds_read_b128 v[132:135], v9 offset:44032
    v_mfma_f32_16x16x32_bf16 v[84:87], v[164:167], v[188:191], v[84:87]
    ds_read_b128 v[136:139], v9 offset:45056
    v_mfma_f32_16x16x32_bf16 v[88:91], v[168:171], v[184:187], v[88:91]
    v_mfma_f32_16x16x32_bf16 v[92:95], v[168:171], v[188:191], v[92:95]
    v_mfma_f32_16x16x32_bf16 v[96:99], v[172:175], v[184:187], v[96:99]
    v_mfma_f32_16x16x32_bf16 v[100:103], v[172:175], v[188:191], v[100:103]
    s_waitcnt lgkmcnt(5)
    v_mfma_f32_16x16x32_bf16 v[32:35], v[104:107], v[176:179], v[32:35]
    ds_read_b128 v[184:187], v24 offset:54272
    v_mfma_f32_16x16x32_bf16 v[36:39], v[104:107], v[180:183], v[36:39]
    ds_read_b128 v[188:191], v24 offset:55296
    v_mfma_f32_16x16x32_bf16 v[40:43], v[108:111], v[176:179], v[40:43]
    ds_read_b128 v[140:143], v9 offset:54272
    v_mfma_f32_16x16x32_bf16 v[44:47], v[108:111], v[180:183], v[44:47]
    v_mfma_f32_16x16x32_bf16 v[48:51], v[112:115], v[176:179], v[48:51]
    ds_read_b128 v[144:147], v9 offset:55296
    v_mfma_f32_16x16x32_bf16 v[52:55], v[112:115], v[180:183], v[52:55]
    ds_read_b128 v[148:151], v9 offset:56320
    v_mfma_f32_16x16x32_bf16 v[56:59], v[116:119], v[176:179], v[56:59]
    ds_read_b128 v[152:155], v9 offset:57344
    v_mfma_f32_16x16x32_bf16 v[60:63], v[116:119], v[180:183], v[60:63]
    s_waitcnt lgkmcnt(6)
    v_mfma_f32_16x16x32_bf16 v[64:67], v[120:123], v[176:179], v[64:67]
    ds_read_b128 v[156:159], v9 offset:58368
    v_mfma_f32_16x16x32_bf16 v[68:71], v[120:123], v[180:183], v[68:71]
    ds_read_b128 v[160:163], v9 offset:59392
    v_mfma_f32_16x16x32_bf16 v[72:75], v[124:127], v[176:179], v[72:75]
    ds_read_b128 v[164:167], v9 offset:60416
    v_mfma_f32_16x16x32_bf16 v[76:79], v[124:127], v[180:183], v[76:79]
    v_mfma_f32_16x16x32_bf16 v[80:83], v[128:131], v[176:179], v[80:83]
    ds_read_b128 v[168:171], v9 offset:61440
    v_mfma_f32_16x16x32_bf16 v[84:87], v[128:131], v[180:183], v[84:87]
    ds_read_b128 v[172:175], v9 offset:62464
    v_mfma_f32_16x16x32_bf16 v[88:91], v[132:135], v[176:179], v[88:91]
    v_mfma_f32_16x16x32_bf16 v[92:95], v[132:135], v[180:183], v[92:95]
    v_mfma_f32_16x16x32_bf16 v[96:99], v[136:139], v[176:179], v[96:99]
    v_mfma_f32_16x16x32_bf16 v[100:103], v[136:139], v[180:183], v[100:103]
    s_waitcnt lgkmcnt(5)
    v_mfma_f32_16x16x32_bf16 v[32:35], v[140:143], v[184:187], v[32:35]
    v_mfma_f32_16x16x32_bf16 v[36:39], v[140:143], v[188:191], v[36:39]
    s_waitcnt lgkmcnt(0)
    s_barrier
    ds_read_b128 v[176:179], v25 offset:0
    v_mfma_f32_16x16x32_bf16 v[40:43], v[144:147], v[184:187], v[40:43]
    ds_read_b128 v[180:183], v25 offset:1024
    v_mfma_f32_16x16x32_bf16 v[44:47], v[144:147], v[188:191], v[44:47]
    ds_read_b128 v[104:107], v11 offset:0
    v_mfma_f32_16x16x32_bf16 v[48:51], v[148:151], v[184:187], v[48:51]
    ds_read_b128 v[108:111], v11 offset:1024
    v_mfma_f32_16x16x32_bf16 v[52:55], v[148:151], v[188:191], v[52:55]
    v_mfma_f32_16x16x32_bf16 v[56:59], v[152:155], v[184:187], v[56:59]
    ds_read_b128 v[112:115], v11 offset:2048
    v_mfma_f32_16x16x32_bf16 v[60:63], v[152:155], v[188:191], v[60:63]
    ds_read_b128 v[116:119], v11 offset:3072
    v_mfma_f32_16x16x32_bf16 v[64:67], v[156:159], v[184:187], v[64:67]
    ds_read_b128 v[120:123], v11 offset:4096
    v_mfma_f32_16x16x32_bf16 v[68:71], v[156:159], v[188:191], v[68:71]
    ds_read_b128 v[124:127], v11 offset:5120
    v_mfma_f32_16x16x32_bf16 v[72:75], v[160:163], v[184:187], v[72:75]
    v_mfma_f32_16x16x32_bf16 v[76:79], v[160:163], v[188:191], v[76:79]
    ds_read_b128 v[128:131], v11 offset:6144
    v_mfma_f32_16x16x32_bf16 v[80:83], v[164:167], v[184:187], v[80:83]
    ds_read_b128 v[132:135], v11 offset:7168
    v_mfma_f32_16x16x32_bf16 v[84:87], v[164:167], v[188:191], v[84:87]
    ds_read_b128 v[136:139], v11 offset:8192
    v_mfma_f32_16x16x32_bf16 v[88:91], v[168:171], v[184:187], v[88:91]
    v_mfma_f32_16x16x32_bf16 v[92:95], v[168:171], v[188:191], v[92:95]
    v_mfma_f32_16x16x32_bf16 v[96:99], v[172:175], v[184:187], v[96:99]
    v_mfma_f32_16x16x32_bf16 v[100:103], v[172:175], v[188:191], v[100:103]
    s_waitcnt lgkmcnt(5)
    v_mfma_f32_16x16x32_bf16 v[32:35], v[104:107], v[176:179], v[32:35]
    ds_read_b128 v[184:187], v25 offset:17408
    v_mfma_f32_16x16x32_bf16 v[36:39], v[104:107], v[180:183], v[36:39]
    ds_read_b128 v[188:191], v25 offset:18432
    v_mfma_f32_16x16x32_bf16 v[40:43], v[108:111], v[176:179], v[40:43]
    ds_read_b128 v[140:143], v11 offset:17408
    v_mfma_f32_16x16x32_bf16 v[44:47], v[108:111], v[180:183], v[44:47]
    v_mfma_f32_16x16x32_bf16 v[48:51], v[112:115], v[176:179], v[48:51]
    ds_read_b128 v[144:147], v11 offset:18432
    v_mfma_f32_16x16x32_bf16 v[52:55], v[112:115], v[180:183], v[52:55]
    ds_read_b128 v[148:151], v11 offset:19456
    v_mfma_f32_16x16x32_bf16 v[56:59], v[116:119], v[176:179], v[56:59]
    ds_read_b128 v[152:155], v11 offset:20480
    v_mfma_f32_16x16x32_bf16 v[60:63], v[116:119], v[180:183], v[60:63]
    s_waitcnt lgkmcnt(6)
    v_mfma_f32_16x16x32_bf16 v[64:67], v[120:123], v[176:179], v[64:67]
    ds_read_b128 v[156:159], v11 offset:21504
    v_mfma_f32_16x16x32_bf16 v[68:71], v[120:123], v[180:183], v[68:71]
    ds_read_b128 v[160:163], v11 offset:22528
    v_mfma_f32_16x16x32_bf16 v[72:75], v[124:127], v[176:179], v[72:75]
    ds_read_b128 v[164:167], v11 offset:23552
    v_mfma_f32_16x16x32_bf16 v[76:79], v[124:127], v[180:183], v[76:79]
    v_mfma_f32_16x16x32_bf16 v[80:83], v[128:131], v[176:179], v[80:83]
    ds_read_b128 v[168:171], v11 offset:24576
    v_mfma_f32_16x16x32_bf16 v[84:87], v[128:131], v[180:183], v[84:87]
    ds_read_b128 v[172:175], v11 offset:25600
    v_mfma_f32_16x16x32_bf16 v[88:91], v[132:135], v[176:179], v[88:91]
    v_mfma_f32_16x16x32_bf16 v[92:95], v[132:135], v[180:183], v[92:95]
    v_mfma_f32_16x16x32_bf16 v[96:99], v[136:139], v[176:179], v[96:99]
    v_mfma_f32_16x16x32_bf16 v[100:103], v[136:139], v[180:183], v[100:103]
    s_waitcnt lgkmcnt(5)
    v_mfma_f32_16x16x32_bf16 v[32:35], v[140:143], v[184:187], v[32:35]
    v_mfma_f32_16x16x32_bf16 v[36:39], v[140:143], v[188:191], v[36:39]
    v_mfma_f32_16x16x32_bf16 v[40:43], v[144:147], v[184:187], v[40:43]
    v_mfma_f32_16x16x32_bf16 v[44:47], v[144:147], v[188:191], v[44:47]
    v_mfma_f32_16x16x32_bf16 v[48:51], v[148:151], v[184:187], v[48:51]
    v_mfma_f32_16x16x32_bf16 v[52:55], v[148:151], v[188:191], v[52:55]
    v_mfma_f32_16x16x32_bf16 v[56:59], v[152:155], v[184:187], v[56:59]
    v_mfma_f32_16x16x32_bf16 v[60:63], v[152:155], v[188:191], v[60:63]
    s_waitcnt lgkmcnt(0)
    v_mfma_f32_16x16x32_bf16 v[64:67], v[156:159], v[184:187], v[64:67]
    v_cvt_pk_bf16_f32 v104, v32, v33
    v_cvt_pk_bf16_f32 v105, v34, v35
    v_mfma_f32_16x16x32_bf16 v[68:71], v[156:159], v[188:191], v[68:71]
    v_cvt_pk_bf16_f32 v106, v36, v37
    v_cvt_pk_bf16_f32 v107, v38, v39
    v_mfma_f32_16x16x32_bf16 v[72:75], v[160:163], v[184:187], v[72:75]
    v_cvt_pk_bf16_f32 v108, v40, v41
    v_cvt_pk_bf16_f32 v109, v42, v43
    v_mfma_f32_16x16x32_bf16 v[76:79], v[160:163], v[188:191], v[76:79]
    v_cvt_pk_bf16_f32 v110, v44, v45
    v_cvt_pk_bf16_f32 v111, v46, v47
    v_mfma_f32_16x16x32_bf16 v[80:83], v[164:167], v[184:187], v[80:83]
    v_permlane16_swap_b32 v104, v106
    v_permlane16_swap_b32 v105, v107
    v_mfma_f32_16x16x32_bf16 v[84:87], v[164:167], v[188:191], v[84:87]
    buffer_store_dwordx4 v[104:107], v26, s[20:23], s42 offen offset:0 sc1
    v_cvt_pk_bf16_f32 v112, v48, v49
    v_mfma_f32_16x16x32_bf16 v[88:91], v[168:171], v[184:187], v[88:91]
    v_cvt_pk_bf16_f32 v113, v50, v51
    v_cvt_pk_bf16_f32 v114, v52, v53
    v_mfma_f32_16x16x32_bf16 v[92:95], v[168:171], v[188:191], v[92:95]
    v_cvt_pk_bf16_f32 v115, v54, v55
    v_permlane16_swap_b32 v108, v110
    v_mfma_f32_16x16x32_bf16 v[96:99], v[172:175], v[184:187], v[96:99]
    v_permlane16_swap_b32 v109, v111
    buffer_store_dwordx4 v[108:111], v26, s[20:23], s42 offen offset:512 sc1
    v_mfma_f32_16x16x32_bf16 v[100:103], v[172:175], v[188:191], v[100:103]
    v_cvt_pk_bf16_f32 v116, v56, v57
    v_cvt_pk_bf16_f32 v117, v58, v59
    v_cvt_pk_bf16_f32 v118, v60, v61
    v_cvt_pk_bf16_f32 v119, v62, v63
    v_permlane16_swap_b32 v112, v114
    v_permlane16_swap_b32 v113, v115
    buffer_store_dwordx4 v[112:115], v26, s[20:23], s42 offen offset:1024 sc1
    v_cvt_pk_bf16_f32 v120, v64, v65
    v_cvt_pk_bf16_f32 v121, v66, v67
    v_cvt_pk_bf16_f32 v122, v68, v69
    v_cvt_pk_bf16_f32 v123, v70, v71
    v_permlane16_swap_b32 v116, v118
    v_permlane16_swap_b32 v117, v119
    buffer_store_dwordx4 v[116:119], v26, s[20:23], s42 offen offset:1536 sc1
    v_cvt_pk_bf16_f32 v124, v72, v73
    v_cvt_pk_bf16_f32 v125, v74, v75
    v_cvt_pk_bf16_f32 v126, v76, v77
    v_cvt_pk_bf16_f32 v127, v78, v79
    v_permlane16_swap_b32 v120, v122
    v_permlane16_swap_b32 v121, v123
    buffer_store_dwordx4 v[120:123], v26, s[20:23], s42 offen offset:2048 sc1
    v_cvt_pk_bf16_f32 v128, v80, v81
    v_cvt_pk_bf16_f32 v129, v82, v83
    v_cvt_pk_bf16_f32 v130, v84, v85
    v_cvt_pk_bf16_f32 v131, v86, v87
    v_permlane16_swap_b32 v124, v126
    v_permlane16_swap_b32 v125, v127
    buffer_store_dwordx4 v[124:127], v26, s[20:23], s42 offen offset:2560 sc1
    v_cvt_pk_bf16_f32 v132, v88, v89
    v_cvt_pk_bf16_f32 v133, v90, v91
    v_cvt_pk_bf16_f32 v134, v92, v93
    v_cvt_pk_bf16_f32 v135, v94, v95
    v_permlane16_swap_b32 v128, v130
    v_permlane16_swap_b32 v129, v131
    buffer_store_dwordx4 v[128:131], v26, s[20:23], s42 offen offset:3072 sc1
    v_cvt_pk_bf16_f32 v136, v96, v97
    v_cvt_pk_bf16_f32 v137, v98, v99
    v_cvt_pk_bf16_f32 v138, v100, v101
    v_cvt_pk_bf16_f32 v139, v102, v103
    v_permlane16_swap_b32 v132, v134
    v_permlane16_swap_b32 v133, v135
    buffer_store_dwordx4 v[132:135], v26, s[20:23], s42 offen offset:3584 sc1
    s_nop 1
    v_permlane16_swap_b32 v136, v138
    v_permlane16_swap_b32 v137, v139
    buffer_store_dwordx4 v[136:139], v26, s[20:23], s44 offen offset:0 sc1
    s_cmp_eq_u32 s34, s31
    s_cbranch_scc1 E_OWN
    s_lshl_b32 s48, s34, 8
    s_add_u32 s48, s48, s47
    s_branch E_JOIN2
E_OWN:
    v_lshrrev_b32 v7, 1, v4
    v_lshlrev_b32 v22, 8, v7
    v_lshl_add_u32 v22, v3, 4, v22
    v_and_b32 v7, 1, v4
    v_mul_u32_u24 v7, 4608, v7
    v_add_u32 v22, v7, v22
    v_add_u32 v22, 153600, v22
    ds_write_b128 v22, v[104:107] offset:0
    ds_write_b128 v22, v[108:111] offset:512
    ds_write_b128 v22, v[112:115] offset:1024
    ds_write_b128 v22, v[116:119] offset:1536
    ds_write_b128 v22, v[120:123] offset:2048
    ds_write_b128 v22, v[124:127] offset:2560
    ds_write_b128 v22, v[128:131] offset:3072
    ds_write_b128 v22, v[132:135] offset:3584
    ds_write_b128 v22, v[136:139] offset:4096
E_JOIN:
    s_mov_b32 s48, -1
E_JOIN2:
    s_mov_b32 s8, s90
    s_mov_b32 s9, s91
    s_mov_b32 s10, 0x240000
    s_mov_b32 s11, 0x00020000
    s_mul_i32 s40, s46, 36864
    s_mul_i32 s41, s33, 4608
    s_add_u32 s40, s40, s41
    s_mul_i32 s43, s46, 36864
    s_mul_i32 s41, s33, 288
    s_add_u32 s43, s43, s41
    s_add_u32 s44, s40, 9773056
    s_add_u32 s41, s31, 1
    s_and_b32 s41, s41, 3
    s_mul_i32 s41, s41, 2359296
    s_add_u32 s41, s41, s40
    s_add_u32 s51, s41, 33529856
    s_add_u32 s41, s31, 2
    s_and_b32 s41, s41, 3
    s_mul_i32 s41, s41, 2359296
    s_add_u32 s41, s41, s40
    s_add_u32 s52, s41, 33529856
    s_add_u32 s41, s31, 3
    s_and_b32 s41, s41, 3
    s_mul_i32 s41, s41, 2359296
    s_add_u32 s41, s41, s40
    s_add_u32 s53, s41, 33529856
    v_add_u32 v4, 0, v0
    v_cmp_le_u32 vcc, 288, v4
    v_subrev_u32 v5, 288, v4
    v_lshlrev_b32 v196, 4, v4
    v_cndmask_b32 v5, v4, v5, vcc
    v_cndmask_b32 v6, 0, 16, vcc
    v_mul_u32_u24 v7, 1152, v6
    v_lshl_add_u32 v192, v5, 4, v7
    buffer_load_dwordx4 v[212:215], v192, s[20:23], s44 offen sc1
    v_add_u32 v196, 153600, v196
    v_and_b32 v7, 15, v5
    v_add_u32 v6, v6, v7
    v_lshlrev_b32 v193, 2, v6
    v_add_u32 v193, 163584, v193
    v_mul_u32_u24 v6, 1152, v6
    v_and_b32 v7, 0x1f0, v5
    v_add_u32 v194, v6, v7
    s_cmp_eq_u32 s3, 7
    s_cbranch_scc0 SKIP_72
    v_add_u32 v4, 64, v0
    v_cmp_le_u32 vcc, 288, v4
    v_subrev_u32 v5, 288, v4
    v_lshlrev_b32 v52, 4, v4
    v_cndmask_b32 v5, v4, v5, vcc
    v_cndmask_b32 v6, 0, 16, vcc
    v_mul_u32_u24 v7, 1152, v6
    v_lshl_add_u32 v48, v5, 4, v7
    buffer_load_dwordx4 v[68:71], v48, s[20:23], s44 offen sc1
    v_add_u32 v52, 153600, v52
    v_and_b32 v7, 15, v5
    v_add_u32 v6, v6, v7
    v_lshlrev_b32 v49, 2, v6
    v_add_u32 v49, 163584, v49
    v_mul_u32_u24 v6, 1152, v6
    v_and_b32 v7, 0x1f0, v5
    v_add_u32 v50, v6, v7
SKIP_72:
    s_lshl_b32 s41, s31, 8
    s_add_u32 s41, s41, s47
    s_waitcnt lgkmcnt(0)
    s_barrier
    s_cmp_eq_u32 s3, 7
    s_cbranch_scc0 SKIP_73
    ds_read_b128 v[216:219], v196
    ds_read_b32 v195, v193
    ds_read_b128 v[72:75], v52
    ds_read_b32 v51, v49
    s_mov_b32 s59, 0
F7_L:
    buffer_load_dwordx4 v[220:223], v192, s[20:23], s51 offen sc1
    buffer_load_dwordx4 v[224:227], v192, s[20:23], s52 offen sc1
    buffer_load_dwordx4 v[228:231], v192, s[20:23], s53 offen sc1
    buffer_load_dwordx4 v[76:79], v48, s[20:23], s51 offen sc1
    buffer_load_dwordx4 v[80:83], v48, s[20:23], s52 offen sc1
    buffer_load_dwordx4 v[84:87], v48, s[20:23], s53 offen sc1
    s_waitcnt vmcnt(0)
    s_cmp_eq_u32 s48, -1
    s_cbranch_scc1 F7_NS
    v_mov_b32 v5, 16
    s_mov_b64 exec, 1
    buffer_atomic_add v5, off, s[20:23], s48
    s_mov_b64 exec, -1
    s_mov_b32 s48, -1
F7_NS:
    v_max3_u32 v4, v220, v221, v222
    v_max3_u32 v4, v4, v223, v224
    v_max3_u32 v4, v4, v225, v226
    v_max3_u32 v4, v4, v227, v228
    v_max3_u32 v4, v4, v229, v230
    v_max3_u32 v4, v4, v231, v220
    v_max3_u32 v4, v4, v76, v77
    v_max3_u32 v4, v4, v78, v79
    v_max3_u32 v4, v4, v80, v81
    v_max3_u32 v4, v4, v82, v83
    v_max3_u32 v4, v4, v84, v85
    v_max3_u32 v4, v4, v86, v87
    v_cmp_eq_u32 vcc, -1, v4
    s_add_u32 s59, s59, 1
    s_cbranch_vccz F7_D
    s_sleep 1
    s_cmp_lt_u32 s59, 64
    s_cbranch_scc1 F7_L
    v_mov_b32 v20, s41
    v_mov_b32 v21, 51
    s_mov_b32 s59, 0
POLL_74:
    buffer_load_dword v22, v20, s[20:23], 0 offen sc1
    s_waitcnt vmcnt(0)
POLLC_76:
    v_cmp_lt_u32 vcc, v22, v21
    s_add_u32 s59, s59, 1
    s_cbranch_vccz POLLD_75
    s_sleep 1
    s_cmp_lt_u32 s59, 2000000
    s_cbranch_scc1 POLL_74
POLLD_75:
    buffer_load_dwordx4 v[220:223], v192, s[20:23], s51 offen sc1
    buffer_load_dwordx4 v[224:227], v192, s[20:23], s52 offen sc1
    buffer_load_dwordx4 v[228:231], v192, s[20:23], s53 offen sc1
    buffer_load_dwordx4 v[76:79], v48, s[20:23], s51 offen sc1
    buffer_load_dwordx4 v[80:83], v48, s[20:23], s52 offen sc1
    buffer_load_dwordx4 v[84:87], v48, s[20:23], s53 offen sc1
    s_waitcnt vmcnt(0)
F7_D:
    s_waitcnt lgkmcnt(0)
    v_lshlrev_b32 v4, 16, v216
    v_and_b32 v5, 0xffff0000, v216
    v_lshlrev_b32 v6, 16, v220
    v_and_b32 v7, 0xffff0000, v220
    v_pk_add_f32 v[4:5], v[4:5], v[6:7]
    v_lshlrev_b32 v6, 16, v224
    v_and_b32 v7, 0xffff0000, v224
    v_pk_add_f32 v[4:5], v[4:5], v[6:7]
    v_lshlrev_b32 v6, 16, v228
    v_and_b32 v7, 0xffff0000, v228
    v_pk_add_f32 v[4:5], v[4:5], v[6:7]
    v_lshlrev_b32 v6, 16, v212
    v_and_b32 v7, 0xffff0000, v212
    v_fma_f32 v4, v4, v195, v6
    v_fma_f32 v5, v5, v195, v7
    v_cvt_pk_bf16_f32 v200, v4, v5
    v_lshlrev_b32 v4, 16, v217
    v_and_b32 v5, 0xffff0000, v217
    v_lshlrev_b32 v6, 16, v221
    v_and_b32 v7, 0xffff0000, v221
    v_pk_add_f32 v[4:5], v[4:5], v[6:7]
    v_lshlrev_b32 v6, 16, v225
    v_and_b32 v7, 0xffff0000, v225
    v_pk_add_f32 v[4:5], v[4:5], v[6:7]
    v_lshlrev_b32 v6, 16, v229
    v_and_b32 v7, 0xffff0000, v229
    v_pk_add_f32 v[4:5], v[4:5], v[6:7]
    v_lshlrev_b32 v6, 16, v213
    v_and_b32 v7, 0xffff0000, v213
    v_fma_f32 v4, v4, v195, v6
    v_fma_f32 v5, v5, v195, v7
    v_cvt_pk_bf16_f32 v201, v4, v5
    v_lshlrev_b32 v4, 16, v218
    v_and_b32 v5, 0xffff0000, v218
    v_lshlrev_b32 v6, 16, v222
    v_and_b32 v7, 0xffff0000, v222
    v_pk_add_f32 v[4:5], v[4:5], v[6:7]
    v_lshlrev_b32 v6, 16, v226
    v_and_b32 v7, 0xffff0000, v226
    v_pk_add_f32 v[4:5], v[4:5], v[6:7]
    v_lshlrev_b32 v6, 16, v230
    v_and_b32 v7, 0xffff0000, v230
    v_pk_add_f32 v[4:5], v[4:5], v[6:7]
    v_lshlrev_b32 v6, 16, v214
    v_and_b32 v7, 0xffff0000, v214
    v_fma_f32 v4, v4, v195, v6
    v_fma_f32 v5, v5, v195, v7
    v_cvt_pk_bf16_f32 v202, v4, v5
    v_lshlrev_b32 v4, 16, v219
    v_and_b32 v5, 0xffff0000, v219
    v_lshlrev_b32 v6, 16, v223
    v_and_b32 v7, 0xffff0000, v223
    v_pk_add_f32 v[4:5], v[4:5], v[6:7]
    v_lshlrev_b32 v6, 16, v227
    v_and_b32 v7, 0xffff0000, v227
    v_pk_add_f32 v[4:5], v[4:5], v[6:7]
    v_lshlrev_b32 v6, 16, v231
    v_and_b32 v7, 0xffff0000, v231
    v_pk_add_f32 v[4:5], v[4:5], v[6:7]
    v_lshlrev_b32 v6, 16, v215
    v_and_b32 v7, 0xffff0000, v215
    v_fma_f32 v4, v4, v195, v6
    v_fma_f32 v5, v5, v195, v7
    v_cvt_pk_bf16_f32 v203, v4, v5
    buffer_store_dwordx4 v[200:203], v194, s[8:11], s43 offen
    v_lshlrev_b32 v4, 16, v72
    v_and_b32 v5, 0xffff0000, v72
    v_lshlrev_b32 v6, 16, v76
    v_and_b32 v7, 0xffff0000, v76
    v_pk_add_f32 v[4:5], v[4:5], v[6:7]
    v_lshlrev_b32 v6, 16, v80
    v_and_b32 v7, 0xffff0000, v80
    v_pk_add_f32 v[4:5], v[4:5], v[6:7]
    v_lshlrev_b32 v6, 16, v84
    v_and_b32 v7, 0xffff0000, v84
    v_pk_add_f32 v[4:5], v[4:5], v[6:7]
    v_lshlrev_b32 v6, 16, v68
    v_and_b32 v7, 0xffff0000, v68
    v_fma_f32 v4, v4, v51, v6
    v_fma_f32 v5, v5, v51, v7
    v_cvt_pk_bf16_f32 v56, v4, v5
    v_lshlrev_b32 v4, 16, v73
    v_and_b32 v5, 0xffff0000, v73
    v_lshlrev_b32 v6, 16, v77
    v_and_b32 v7, 0xffff0000, v77
    v_pk_add_f32 v[4:5], v[4:5], v[6:7]
    v_lshlrev_b32 v6, 16, v81
    v_and_b32 v7, 0xffff0000, v81
    v_pk_add_f32 v[4:5], v[4:5], v[6:7]
    v_lshlrev_b32 v6, 16, v85
    v_and_b32 v7, 0xffff0000, v85
    v_pk_add_f32 v[4:5], v[4:5], v[6:7]
    v_lshlrev_b32 v6, 16, v69
    v_and_b32 v7, 0xffff0000, v69
    v_fma_f32 v4, v4, v51, v6
    v_fma_f32 v5, v5, v51, v7
    v_cvt_pk_bf16_f32 v57, v4, v5
    v_lshlrev_b32 v4, 16, v74
    v_and_b32 v5, 0xffff0000, v74
    v_lshlrev_b32 v6, 16, v78
    v_and_b32 v7, 0xffff0000, v78
    v_pk_add_f32 v[4:5], v[4:5], v[6:7]
    v_lshlrev_b32 v6, 16, v82
    v_and_b32 v7, 0xffff0000, v82
    v_pk_add_f32 v[4:5], v[4:5], v[6:7]
    v_lshlrev_b32 v6, 16, v86
    v_and_b32 v7, 0xffff0000, v86
    v_pk_add_f32 v[4:5], v[4:5], v[6:7]
    v_lshlrev_b32 v6, 16, v70
    v_and_b32 v7, 0xffff0000, v70
    v_fma_f32 v4, v4, v51, v6
    v_fma_f32 v5, v5, v51, v7
    v_cvt_pk_bf16_f32 v58, v4, v5
    v_lshlrev_b32 v4, 16, v75
    v_and_b32 v5, 0xffff0000, v75
    v_lshlrev_b32 v6, 16, v79
    v_and_b32 v7, 0xffff0000, v79
    v_pk_add_f32 v[4:5], v[4:5], v[6:7]
    v_lshlrev_b32 v6, 16, v83
    v_and_b32 v7, 0xffff0000, v83
    v_pk_add_f32 v[4:5], v[4:5], v[6:7]
    v_lshlrev_b32 v6, 16, v87
    v_and_b32 v7, 0xffff0000, v87
    v_pk_add_f32 v[4:5], v[4:5], v[6:7]
    v_lshlrev_b32 v6, 16, v71
    v_and_b32 v7, 0xffff0000, v71
    v_fma_f32 v4, v4, v51, v6
    v_fma_f32 v5, v5, v51, v7
    v_cvt_pk_bf16_f32 v59, v4, v5
    buffer_store_dwordx4 v[56:59], v50, s[8:11], s43 offen
    s_branch F_END
SKIP_73:
    ds_read_b128 v[216:219], v196
    ds_read_b32 v195, v193
    s_mov_b32 s59, 0
F0_L:
    buffer_load_dwordx4 v[220:223], v192, s[20:23], s51 offen sc1
    buffer_load_dwordx4 v[224:227], v192, s[20:23], s52 offen sc1
    buffer_load_dwordx4 v[228:231], v192, s[20:23], s53 offen sc1
    s_waitcnt vmcnt(0)
    s_cmp_eq_u32 s48, -1
    s_cbranch_scc1 F0_NS
    v_mov_b32 v5, 16
    s_mov_b64 exec, 1
    buffer_atomic_add v5, off, s[20:23], s48
    s_mov_b64 exec, -1
    s_mov_b32 s48, -1
F0_NS:
    v_max3_u32 v4, v220, v221, v222
    v_max3_u32 v4, v4, v223, v224
    v_max3_u32 v4, v4, v225, v226
    v_max3_u32 v4, v4, v227, v228
    v_max3_u32 v4, v4, v229, v230
    v_max3_u32 v4, v4, v231, v220
    v_cmp_eq_u32 vcc, -1, v4
    s_add_u32 s59, s59, 1
    s_cbranch_vccz F0_D
    s_sleep 1
    s_cmp_lt_u32 s59, 64
    s_cbranch_scc1 F0_L
    v_mov_b32 v20, s41
    v_mov_b32 v21, 51
    s_mov_b32 s59, 0
POLL_77:
    buffer_load_dword v22, v20, s[20:23], 0 offen sc1
    s_waitcnt vmcnt(0)
POLLC_79:
    v_cmp_lt_u32 vcc, v22, v21
    s_add_u32 s59, s59, 1
    s_cbranch_vccz POLLD_78
    s_sleep 1
    s_cmp_lt_u32 s59, 2000000
    s_cbranch_scc1 POLL_77
POLLD_78:
    buffer_load_dwordx4 v[220:223], v192, s[20:23], s51 offen sc1
    buffer_load_dwordx4 v[224:227], v192, s[20:23], s52 offen sc1
    buffer_load_dwordx4 v[228:231], v192, s[20:23], s53 offen sc1
    s_waitcnt vmcnt(0)
F0_D:
    s_waitcnt lgkmcnt(0)
    v_lshlrev_b32 v4, 16, v216
    v_and_b32 v5, 0xffff0000, v216
    v_lshlrev_b32 v6, 16, v220
    v_and_b32 v7, 0xffff0000, v220
    v_pk_add_f32 v[4:5], v[4:5], v[6:7]
    v_lshlrev_b32 v6, 16, v224
    v_and_b32 v7, 0xffff0000, v224
    v_pk_add_f32 v[4:5], v[4:5], v[6:7]
    v_lshlrev_b32 v6, 16, v228
    v_and_b32 v7, 0xffff0000, v228
    v_pk_add_f32 v[4:5], v[4:5], v[6:7]
    v_lshlrev_b32 v6, 16, v212
    v_and_b32 v7, 0xffff0000, v212
    v_fma_f32 v4, v4, v195, v6
    v_fma_f32 v5, v5, v195, v7
    v_cvt_pk_bf16_f32 v200, v4, v5
    v_lshlrev_b32 v4, 16, v217
    v_and_b32 v5, 0xffff0000, v217
    v_lshlrev_b32 v6, 16, v221
    v_and_b32 v7, 0xffff0000, v221
    v_pk_add_f32 v[4:5], v[4:5], v[6:7]
    v_lshlrev_b32 v6, 16, v225
    v_and_b32 v7, 0xffff0000, v225
    v_pk_add_f32 v[4:5], v[4:5], v[6:7]
    v_lshlrev_b32 v6, 16, v229
    v_and_b32 v7, 0xffff0000, v229
    v_pk_add_f32 v[4:5], v[4:5], v[6:7]
    v_lshlrev_b32 v6, 16, v213
    v_and_b32 v7, 0xffff0000, v213
    v_fma_f32 v4, v4, v195, v6
    v_fma_f32 v5, v5, v195, v7
    v_cvt_pk_bf16_f32 v201, v4, v5
    v_lshlrev_b32 v4, 16, v218
    v_and_b32 v5, 0xffff0000, v218
    v_lshlrev_b32 v6, 16, v222
    v_and_b32 v7, 0xffff0000, v222
    v_pk_add_f32 v[4:5], v[4:5], v[6:7]
    v_lshlrev_b32 v6, 16, v226
    v_and_b32 v7, 0xffff0000, v226
    v_pk_add_f32 v[4:5], v[4:5], v[6:7]
    v_lshlrev_b32 v6, 16, v230
    v_and_b32 v7, 0xffff0000, v230
    v_pk_add_f32 v[4:5], v[4:5], v[6:7]
    v_lshlrev_b32 v6, 16, v214
    v_and_b32 v7, 0xffff0000, v214
    v_fma_f32 v4, v4, v195, v6
    v_fma_f32 v5, v5, v195, v7
    v_cvt_pk_bf16_f32 v202, v4, v5
    v_lshlrev_b32 v4, 16, v219
    v_and_b32 v5, 0xffff0000, v219
    v_lshlrev_b32 v6, 16, v223
    v_and_b32 v7, 0xffff0000, v223
    v_pk_add_f32 v[4:5], v[4:5], v[6:7]
    v_lshlrev_b32 v6, 16, v227
    v_and_b32 v7, 0xffff0000, v227
    v_pk_add_f32 v[4:5], v[4:5], v[6:7]
    v_lshlrev_b32 v6, 16, v231
    v_and_b32 v7, 0xffff0000, v231
    v_pk_add_f32 v[4:5], v[4:5], v[6:7]
    v_lshlrev_b32 v6, 16, v215
    v_and_b32 v7, 0xffff0000, v215
    v_fma_f32 v4, v4, v195, v6
    v_fma_f32 v5, v5, v195, v7
    v_cvt_pk_bf16_f32 v203, v4, v5
    buffer_store_dwordx4 v[200:203], v194, s[8:11], s43 offen
F_END:
PH_END:
    s_endpgm

.section .rodata,"a"
.p2align 6
.amdhsa_kernel sequential_preLN__softmax_full_mha__glu_gated_reglu__prompt_kernel
  .amdhsa_next_free_vgpr 256
  .amdhsa_next_free_sgpr 102
  .amdhsa_accum_offset 256
  .amdhsa_group_segment_fixed_size 0
  .amdhsa_kernarg_size 80
  .amdhsa_user_sgpr_count 2
  .amdhsa_user_sgpr_kernarg_segment_ptr 1
  .amdhsa_system_sgpr_workgroup_id_x 1
.end_amdhsa_kernel
```
